```python
import torch

def _softmax(x, axis=-1):
    return torch.softmax(x, dim=axis)
def _gelu(x):
    return torch.nn.functional.gelu(x, approximate="tanh")
def _silu(x):
    return torch.nn.functional.silu(x)
def _sigmoid(x):
    return torch.sigmoid(x)
def _layernorm(x, axis=-1, eps=1e-5):
    m = x.mean(dim=axis, keepdim=True)
    v = x.var(dim=axis, keepdim=True, unbiased=False)
    return (x - m) / torch.sqrt(v + eps)
def _scatter_add(tgt, idx, src, axis=0):
    return tgt.clone().index_add_(axis, idx, src)
def _segment_sum(src, seg, n):
    out = torch.zeros((n,) + src.shape[1:], dtype=src.dtype)
    return out.index_add_(0, seg, src)
def _pad(x, pw):
    flat = tuple(v for pair in reversed(pw) for v in pair)
    return torch.nn.functional.pad(x, flat)

kernel_name = 'parallel_sum__linear_attn_block__glu_gated_bilinear__prompt'

def setup_inputs():

    _w = (lambda a: (lambda t: t.to(torch.bfloat16) if t.is_floating_point() else t)(torch.as_tensor(a)))
    def _A_setup():
        B, S, D = 1, 2048, 640
        return {
            "x": _w((lambda *s: torch.randn(*s, dtype=torch.bfloat16) * 0.05)(B, S, D)),
            "wqkv": _w((lambda *s: torch.randn(*s, dtype=torch.bfloat16) * 0.05)(D, 3 * D)),
            "wo": _w((lambda *s: torch.randn(*s, dtype=torch.bfloat16) * 0.05)(D, D)),
        }
    _A_in = _A_setup()

    def _B_setup():
        B, S, D, F = 1, 2048, 640, 1728
        return {
            "x": _w((lambda *s: torch.randn(*s, dtype=torch.bfloat16) * 0.05)(B, S, D)),
            "w_gate": _w((lambda *s: torch.randn(*s, dtype=torch.bfloat16) * 0.2)(D, F) * (D ** -0.5)),
            "w_up": _w((lambda *s: torch.randn(*s, dtype=torch.bfloat16) * 0.2)(D, F) * (D ** -0.5)),
            "w_down": _w((lambda *s: torch.randn(*s, dtype=torch.bfloat16) * 0.2)(F, D) * (F ** -0.5)),
        }
    _B_in = _B_setup()

    return {
        "A_x": _A_in["x"],
        "A_wqkv": _A_in["wqkv"],
        "A_wo": _A_in["wo"],
        "B_x": _B_in["x"],
        "B_w_gate": _B_in["w_gate"],
        "B_w_up": _B_in["w_up"],
        "B_w_down": _B_in["w_down"],
    }

def reference(A_x, A_wqkv, A_wo, B_x, B_w_gate, B_w_up, B_w_down):
    def _A_ref(x, wqkv, wo):
        B, S, D = x.shape
        H = 32; Dh = D // H
        qkv = (lambda x, *d: x.permute(*d))((x @ wqkv).reshape(B, S, 3, H, Dh), 2, 0, 3, 1, 4)
        q, k, v = qkv[0], qkv[1], qkv[2]
        phi = lambda t: torch.where(t > 0, t + 1, torch.exp(t)) + 1e-6
        pq, pk = phi(q), phi(k)
        kv = torch.einsum("bhsd,bhse->bhde", pk, v)
        z = torch.einsum("bhsd->bhd", pk)
        num = torch.einsum("bhqd,bhde->bhqe", pq, kv)
        den = torch.einsum("bhqd,bhd->bhq", pq, z)[..., None] + 1e-6
        o = num / den
        return (lambda x, *d: x.permute(*d))(o, 0, 2, 1, 3).reshape(B, S, D) @ wo

    def _B_ref(x, w_gate, w_up, w_down):
        g = torch.einsum("bsd,df->bsf", x, w_gate)
        u = torch.einsum("bsd,df->bsf", x, w_up)
        h = g * u
        return torch.einsum("bsf,fd->bsd", h, w_down)

    x = A_x
    xn = _layernorm(x, axis=-1)
    return x + _A_ref(xn, A_wqkv, A_wo) + _B_ref(xn, B_w_gate, B_w_up, B_w_down)
```

```asm
; @launch grid=(256,1,1) block=(512,1,1) lds=163840
.amdgcn_target "amdgcn-amd-amdhsa--gfx950"
.text
.globl parallel_sum__linear_attn_block__glu_gated_bilinear__prompt_kernel
.p2align 8
.type parallel_sum__linear_attn_block__glu_gated_bilinear__prompt_kernel,@function
parallel_sum__linear_attn_block__glu_gated_bilinear__prompt_kernel:
    s_cmp_ge_u32 s2, 256
    s_cbranch_scc1 L_end_parallel_sum__linear_attn_block__glu_gated_bilinear__prompt_kernel
    s_load_dwordx4 s[36:39], s[0:1], 0
    s_load_dwordx4 s[40:43], s[0:1], 32
    s_load_dwordx4 s[44:47], s[0:1], 64
    s_load_dwordx2 s[60:61], s[0:1], 16
    s_load_dwordx2 s[62:63], s[0:1], 48
    s_load_dwordx2 s[64:65], s[0:1], 56
    v_and_b32 v1, 63, v0
    v_lshrrev_b32 v2, 6, v0
    s_nop 0
    v_readfirstlane_b32 s3, v2
    s_getpc_b64 s[68:69]
L_pc_parallel_sum__linear_attn_block__glu_gated_bilinear__prompt_kernel:
    s_lshr_b32 s32, s2, 3
    s_lshl_b32 s32, s32, 3
    s_add_u32 s32, s32, s3
    s_lshl_b32 s32, s32, 1
    v_add_u32 v88, s32, v1
    v_lshlrev_b32 v88, 7, v88
    v_min_u32 v88, L_end_parallel_sum__linear_attn_block__glu_gated_bilinear__prompt_kernel-L_pc_parallel_sum__linear_attn_block__glu_gated_bilinear__prompt_kernel, v88
    v_add_co_u32 v86, vcc, s68, v88
    v_mov_b32 v87, s69
    s_nop 0
    v_addc_co_u32 v87, vcc, 0, v87, vcc
    s_mov_b64 exec, 3
    global_load_dword v88, v[86:87], off
    s_mov_b64 exec, -1
    s_and_b32 s32, s2, 7
    s_lshr_b32 s33, s2, 3
    s_and_b32 s34, s32, 1
    s_lshl_b32 s20, s34, 3
    s_and_b32 s34, s33, 7
    s_add_u32 s20, s20, s34
    s_lshr_b32 s34, s32, 1
    s_lshl_b32 s34, s34, 2
    s_lshr_b32 s35, s33, 3
    s_add_u32 s34, s34, s35
    s_lshl_b32 s34, s34, 2
    s_mov_b32 s68, 0x9d32cb10
    s_mov_b32 s69, 0xf876ae54
    s_lshr_b64 s[68:69], s[68:69], s34
    s_and_b32 s21, s68, 15
    s_lshl_b32 s58, s32, 2
    s_and_b32 s34, s33, 3
    s_add_u32 s58, s58, s34
    s_lshr_b32 s59, s33, 2
    s_lshr_b32 s67, s20, 3
    s_mov_b32 s68, 0x0
    s_mov_b32 s69, 0x55555555
    s_lshl_b32 s34, s20, 2
    s_lshr_b64 s[68:69], s[68:69], s34
    s_and_b32 s34, s68, 15
    s_lshl_b32 s35, s35, 2
    s_lshr_b32 s35, 0x0, s35
    s_and_b32 s35, s35, 15
    s_add_u32 s34, s34, s35
    s_cmp_ge_u32 s34, 10
    s_cselect_b32 s35, 10, 0
    s_sub_u32 s67, s34, s35
    s_waitcnt lgkmcnt(0)
    s_mov_b32 s12, s46
    s_mov_b32 s13, s47
    s_mov_b32 s14, 19922944
    s_mov_b32 s15, 0x20000
    s_mov_b32 s16, s44
    s_mov_b32 s17, s45
    s_mov_b32 s18, 256
    s_mov_b32 s19, 0x20000
    s_cmp_eq_u32 s21, 15
    s_cbranch_scc1 L_side
    s_mov_b32 s22, 0
    s_mov_b32 s33, 0
    s_cmp_ge_u32 s21, 9
    s_cselect_b32 s22, 1, s22
    s_cselect_b32 s33, 9, s33
    s_cmp_ge_u32 s21, 11
    s_cselect_b32 s22, 2, s22
    s_cselect_b32 s33, 11, s33
    s_sub_u32 s23, s21, s33
    s_lshr_b32 s32, s3, 2
    s_and_b32 s50, s3, 1
    s_mov_b32 s8, s36
    s_mov_b32 s9, s37
    s_mov_b32 s10, 2621440
    s_mov_b32 s11, 0x20000
    s_lshl_b32 s32, s2, 3
    s_add_u32 s32, s32, s3
    s_mul_i32 s33, s32, 1280
    v_lshlrev_b32 v6, 4, v1
    v_lshlrev_b32 v7, 2, v1
    buffer_load_dwordx4 v[32:35], v6, s[8:11], s33 offen
    buffer_load_dword v36, v7, s[8:11], s33 offen offset:1024
    s_lshr_b32 s32, s3, 2
    s_mul_i32 s70, s20, 163840
    s_mul_i32 s34, s67, 128
    s_add_u32 s70, s70, s34
    s_sub_u32 s29, 10, s67
    s_lshl_b32 s28, s3, 11
    s_add_u32 s28, s28, 99328
    v_lshrrev_b32 v2, 3, v1
    s_lshl_b32 s34, s3, 4
    v_add_u32 v2, s34, v2
    v_mul_u32_u24 v3, 1280, v2
    v_lshrrev_b32 v4, 4, v1
    v_xor_b32 v4, v4, v1
    v_and_b32 v4, 7, v4
    v_lshl_add_u32 v98, v4, 4, v3
    v_xor_b32 v4, 4, v4
    v_lshl_add_u32 v4, v4, 4, v3
    v_add_u32 v99, 10240, v4
    s_mov_b32 s53, s70
    s_mov_b32 s54, 128
    s_add_u32 m0, s28, 0
    s_nop 0
    buffer_load_dwordx4 v98, s[8:11], s53 offen lds
    s_add_u32 m0, s28, 1024
    s_nop 0
    buffer_load_dwordx4 v99, s[8:11], s53 offen lds
    s_cmp_eq_u32 s29, 1
    s_cselect_b32 s49, -1152, s54
    s_add_u32 s53, s53, s49
    s_cmp_eq_u32 s22, 0
    s_cbranch_scc0 L_setup_qkv
    s_cmp_eq_u32 s32, 0
    s_cselect_b32 s4, s40, s42
    s_cselect_b32 s5, s41, s43
    s_mov_b32 s6, 2211840
    s_mov_b32 s33, 3456
    s_mul_i32 s24, s23, 384
    s_mov_b32 s68, 24
    s_mov_b32 s69, 3
    s_branch L_setup_done
L_setup_qkv:
    s_mov_b32 s4, s38
    s_mov_b32 s5, s39
    s_mov_b32 s6, 2457600
    s_mov_b32 s33, 3840
    s_mov_b32 s68, 20
    s_mov_b32 s69, 2
    s_cmp_eq_u32 s22, 1
    s_cbranch_scc0 L_setup_kv
    s_mul_i32 s24, s23, 640
    s_mul_i32 s34, s32, 320
    s_add_u32 s24, s24, s34
    s_branch L_setup_done
L_setup_kv:
    s_mul_i32 s24, s23, 320
    s_mul_i32 s34, s32, 1280
    s_add_u32 s24, s24, s34
    s_add_u32 s24, s24, 1280
L_setup_done:
    s_mov_b32 s7, 0x20000
    s_mov_b32 s71, s24
    s_lshl_b32 s25, s33, 5
    s_and_b32 s34, s3, 3
    s_lshl_b32 s35, s34, 3
    s_mul_i32 s35, s35, s33
    s_add_u32 s24, s24, s35
    s_mul_i32 s35, s25, 2
    s_mul_i32 s35, s35, s67
    s_add_u32 s24, s24, s35
    s_mul_i32 s26, s32, 12416
    s_mul_i32 s34, s34, 3072
    s_add_u32 s26, s26, s34
    s_mov_b32 s35, -24
    v_add_u32 v2, 0, v1
    v_mul_u32_u24 v3, 2731, v2
    v_lshrrev_b32 v3, 16, v3
    v_mad_i32_i24 v4, v3, s35, v2
    v_and_b32 v5, 3, v3
    v_lshlrev_b32 v5, 1, v5
    v_xor_b32 v4, v5, v4
    v_lshlrev_b32 v5, 4, v4
    v_mad_u32_u24 v5, v3, s33, v5
    v_subrev_u32 v5, 0, v5
    v_cmp_gt_u32 vcc, s68, v4
    v_mov_b32 v6, 0x40000000
    s_nop 0
    v_cndmask_b32 v108, v6, v5, vcc
    v_add_u32 v2, 64, v1
    v_mul_u32_u24 v3, 2731, v2
    v_lshrrev_b32 v3, 16, v3
    v_mad_i32_i24 v4, v3, s35, v2
    v_and_b32 v5, 3, v3
    v_lshlrev_b32 v5, 1, v5
    v_xor_b32 v4, v5, v4
    v_lshlrev_b32 v5, 4, v4
    v_mad_u32_u24 v5, v3, s33, v5
    v_subrev_u32 v5, 1024, v5
    v_cmp_gt_u32 vcc, s68, v4
    v_mov_b32 v6, 0x40000000
    s_nop 0
    v_cndmask_b32 v109, v6, v5, vcc
    v_add_u32 v2, 128, v1
    v_mul_u32_u24 v3, 2731, v2
    v_lshrrev_b32 v3, 16, v3
    v_mad_i32_i24 v4, v3, s35, v2
    v_and_b32 v5, 3, v3
    v_lshlrev_b32 v5, 1, v5
    v_xor_b32 v4, v5, v4
    v_lshlrev_b32 v5, 4, v4
    v_mad_u32_u24 v5, v3, s33, v5
    v_subrev_u32 v5, 2048, v5
    v_cmp_gt_u32 vcc, s68, v4
    v_mov_b32 v6, 0x40000000
    s_nop 0
    v_cndmask_b32 v110, v6, v5, vcc
    s_mul_i32 s48, s25, -19
    s_add_u32 m0, s26, 0
    s_nop 0
    buffer_load_dwordx4 v108, s[4:7], s24 offen offset:0 lds
    buffer_load_dwordx4 v109, s[4:7], s24 offen offset:1024 lds
    buffer_load_dwordx4 v110, s[4:7], s24 offen offset:2048 lds
    s_add_u32 s24, s24, s25
    s_add_u32 m0, s26, 24832
    s_nop 0
    buffer_load_dwordx4 v108, s[4:7], s24 offen offset:0 lds
    buffer_load_dwordx4 v109, s[4:7], s24 offen offset:1024 lds
    buffer_load_dwordx4 v110, s[4:7], s24 offen offset:2048 lds
    s_cmp_eq_u32 s29, 1
    s_cselect_b32 s49, s48, s25
    s_add_u32 s24, s24, s49
    s_add_u32 m0, s28, 16384
    s_nop 0
    buffer_load_dwordx4 v98, s[8:11], s53 offen lds
    s_add_u32 m0, s26, 49664
    s_nop 0
    buffer_load_dwordx4 v108, s[4:7], s24 offen offset:0 lds
    buffer_load_dwordx4 v109, s[4:7], s24 offen offset:1024 lds
    buffer_load_dwordx4 v110, s[4:7], s24 offen offset:2048 lds
    s_add_u32 s24, s24, s25
    s_add_u32 m0, s28, 17408
    s_nop 0
    buffer_load_dwordx4 v99, s[8:11], s53 offen lds
    s_cmp_eq_u32 s29, 2
    s_cselect_b32 s49, -1152, s54
    s_add_u32 s53, s53, s49
    s_add_u32 m0, s26, 74496
    s_nop 0
    buffer_load_dwordx4 v108, s[4:7], s24 offen offset:0 lds
    buffer_load_dwordx4 v109, s[4:7], s24 offen offset:1024 lds
    buffer_load_dwordx4 v110, s[4:7], s24 offen offset:2048 lds
    s_cmp_eq_u32 s29, 2
    s_cselect_b32 s49, s48, s25
    s_add_u32 s24, s24, s49
    s_add_u32 m0, s28, 32768
    s_nop 0
    buffer_load_dwordx4 v98, s[8:11], s53 offen lds
    s_lshr_b32 s34, s3, 1
    s_and_b32 s34, s34, 1
    s_cmp_eq_u32 s32, 0
    s_cselect_b32 s35, 3, s69
    s_mov_b32 s66, s35
    s_mul_i32 s34, s34, s35
    s_cselect_b32 s35, 0, 6
    s_add_u32 s51, s34, s35
    s_and_b32 s57, s20, 7
    s_mov_b32 s34, 0xfff01234
    s_mov_b32 s35, 0xfff01234
    s_lshl_b32 s57, s20, 2
    s_lshr_b64 s[34:35], s[34:35], s57
    s_and_b32 s57, s34, 15
    s_cmp_eq_u32 s50, s32
    s_cselect_b32 s57, s57, 30
    s_cmp_gt_u32 s57, 4
    s_cselect_b32 s57, 30, s57
    s_mov_b32 s52, 0x3f803f80
    v_lshlrev_b32 v6, 2, v1
    v_add_u32 v6, 163584, v6
    v_mov_b32 v7, 0
    ds_write_b32 v6, v7
    v_lshrrev_b32 v2, 4, v1
    v_and_b32 v3, 1, v2
    v_lshrrev_b32 v2, 1, v2
    v_bfe_u32 v4, v1, 2, 2
    v_lshl_add_u32 v5, v2, 3, v4
    v_mul_u32_u24 v5, 384, v5
    v_mul_u32_u24 v3, 12416, v3
    v_add_u32 v5, v5, v3
    v_and_b32 v6, 1, v1
    v_bfe_u32 v7, v1, 1, 1
    v_lshl_add_u32 v5, v7, 3, v5
    v_lshlrev_b32 v4, 1, v4
    s_add_u32 s34, s51, 0
    s_lshl_b32 s34, s34, 1
    v_add_u32 v8, s34, v6
    v_xor_b32 v8, v8, v4
    v_lshl_add_u32 v100, v8, 4, v5
    s_add_u32 s34, s51, 1
    s_lshl_b32 s34, s34, 1
    v_add_u32 v8, s34, v6
    v_xor_b32 v8, v8, v4
    v_lshl_add_u32 v101, v8, 4, v5
    s_add_u32 s34, s51, 2
    s_lshl_b32 s34, s34, 1
    v_add_u32 v8, s34, v6
    v_xor_b32 v8, v8, v4
    v_lshl_add_u32 v102, v8, 4, v5
    v_and_b32 v2, 31, v1
    s_lshl_b32 s34, s50, 6
    v_add_u32 v3, s34, v2
    v_lshlrev_b32 v3, 7, v3
    v_add_u32 v3, 99328, v3
    v_bfe_u32 v4, v1, 1, 3
    v_lshrrev_b32 v5, 5, v1
    v_add_u32 v6, 0, v5
    v_xor_b32 v6, v6, v4
    v_lshl_add_u32 v104, v6, 4, v3
    v_add_u32 v6, 2, v5
    v_xor_b32 v6, v6, v4
    v_lshl_add_u32 v105, v6, 4, v3
    v_add_u32 v6, 4, v5
    v_xor_b32 v6, v6, v4
    v_lshl_add_u32 v106, v6, 4, v3
    v_add_u32 v6, 6, v5
    v_xor_b32 v6, v6, v4
    v_lshl_add_u32 v107, v6, 4, v3
    v_mov_b32 v160, 0
    v_mov_b32 v161, 0
    v_mov_b32 v162, 0
    v_mov_b32 v163, 0
    v_mov_b32 v164, 0
    v_mov_b32 v165, 0
    v_mov_b32 v166, 0
    v_mov_b32 v167, 0
    v_mov_b32 v168, 0
    v_mov_b32 v169, 0
    v_mov_b32 v170, 0
    v_mov_b32 v171, 0
    v_mov_b32 v172, 0
    v_mov_b32 v173, 0
    v_mov_b32 v174, 0
    v_mov_b32 v175, 0
    v_mov_b32 v176, 0
    v_mov_b32 v177, 0
    v_mov_b32 v178, 0
    v_mov_b32 v179, 0
    v_mov_b32 v180, 0
    v_mov_b32 v181, 0
    v_mov_b32 v182, 0
    v_mov_b32 v183, 0
    v_mov_b32 v184, 0
    v_mov_b32 v185, 0
    v_mov_b32 v186, 0
    v_mov_b32 v187, 0
    v_mov_b32 v188, 0
    v_mov_b32 v189, 0
    v_mov_b32 v190, 0
    v_mov_b32 v191, 0
    v_mov_b32 v192, 0
    v_mov_b32 v193, 0
    v_mov_b32 v194, 0
    v_mov_b32 v195, 0
    v_mov_b32 v196, 0
    v_mov_b32 v197, 0
    v_mov_b32 v198, 0
    v_mov_b32 v199, 0
    v_mov_b32 v200, 0
    v_mov_b32 v201, 0
    v_mov_b32 v202, 0
    v_mov_b32 v203, 0
    v_mov_b32 v204, 0
    v_mov_b32 v205, 0
    v_mov_b32 v206, 0
    v_mov_b32 v207, 0
    v_mov_b32 v208, 0
    v_mov_b32 v209, 0
    v_mov_b32 v210, 0
    v_mov_b32 v211, 0
    v_mov_b32 v212, 0
    v_mov_b32 v213, 0
    v_mov_b32 v214, 0
    v_mov_b32 v215, 0
    v_mov_b32 v216, 0
    v_mov_b32 v217, 0
    v_mov_b32 v218, 0
    v_mov_b32 v219, 0
    v_mov_b32 v220, 0
    v_mov_b32 v221, 0
    v_mov_b32 v222, 0
    v_mov_b32 v223, 0
    v_mov_b32 v224, 0
    v_mov_b32 v225, 0
    v_mov_b32 v226, 0
    v_mov_b32 v227, 0
    v_mov_b32 v228, 0
    v_mov_b32 v229, 0
    v_mov_b32 v230, 0
    v_mov_b32 v231, 0
    v_mov_b32 v232, 0
    v_mov_b32 v233, 0
    v_mov_b32 v234, 0
    v_mov_b32 v235, 0
    v_mov_b32 v236, 0
    v_mov_b32 v237, 0
    v_mov_b32 v238, 0
    v_mov_b32 v239, 0
    v_mov_b32 v240, 0
    v_mov_b32 v241, 0
    v_mov_b32 v242, 0
    v_mov_b32 v243, 0
    v_mov_b32 v244, 0
    v_mov_b32 v245, 0
    v_mov_b32 v246, 0
    v_mov_b32 v247, 0
    v_mov_b32 v248, 0
    v_mov_b32 v249, 0
    v_mov_b32 v250, 0
    v_mov_b32 v251, 0
    v_mov_b32 v252, 0
    v_mov_b32 v253, 0
    v_mov_b32 v254, 0
    v_mov_b32 v255, 0
    v_mov_b32 v92, 0
    v_mov_b32 v93, 0
    v_mov_b32 v94, 0
    v_add_u32 v152, 49664, v100
    v_add_u32 v153, 49664, v101
    v_add_u32 v154, 49664, v102
    v_lshlrev_b32 v155, 4, v1
    s_and_b32 s33, s3, 3
    s_mul_i32 s34, s33, 14
    s_cmp_eq_u32 s33, 3
    s_cselect_b32 s35, 1, 0
    s_sub_u32 s34, s34, s35
    s_mul_i32 s35, s59, 74
    s_add_u32 s34, s34, s35
    s_mul_i32 s55, s34, 5120
    s_add_u32 s55, s55, 10485760
    s_lshr_b32 s34, s3, 2
    s_mul_i32 s34, s34, 3072
    s_add_u32 s55, s55, s34
    s_lshr_b32 s33, s3, 1
    s_mul_i32 s34, s33, 14
    s_cmp_eq_u32 s33, 3
    s_cselect_b32 s35, 1, 0
    s_sub_u32 s34, s34, s35
    s_mul_i32 s35, s59, 74
    s_add_u32 s34, s34, s35
    s_mul_i32 s56, s34, 5120
    s_add_u32 s56, s56, 10485760
    s_and_b32 s34, s3, 1
    s_lshl_b32 s34, s34, 11
    s_add_u32 s56, s56, s34
    s_add_u32 s56, s56, 24576
    s_mov_b32 s52, 0x3f803f80
    s_waitcnt vmcnt(17)
    v_mov_b32 v8, 0
    v_mov_b32 v9, 0
    v_dot2c_f32_bf16 v8, s52, v32
    v_dot2c_f32_bf16 v9, v32, v32
    v_dot2c_f32_bf16 v8, s52, v33
    v_dot2c_f32_bf16 v9, v33, v33
    v_dot2c_f32_bf16 v8, s52, v34
    v_dot2c_f32_bf16 v9, v34, v34
    v_dot2c_f32_bf16 v8, s52, v35
    v_dot2c_f32_bf16 v9, v35, v35
    v_dot2c_f32_bf16 v8, s52, v36
    v_dot2c_f32_bf16 v9, v36, v36
    s_nop 2
    v_add_f32_dpp v8, v8, v8 row_ror:8 row_mask:0xf bank_mask:0xf
    v_add_f32_dpp v9, v9, v9 row_ror:8 row_mask:0xf bank_mask:0xf
    s_nop 0
    v_add_f32_dpp v8, v8, v8 row_ror:4 row_mask:0xf bank_mask:0xf
    v_add_f32_dpp v9, v9, v9 row_ror:4 row_mask:0xf bank_mask:0xf
    s_nop 0
    v_add_f32_dpp v8, v8, v8 row_ror:2 row_mask:0xf bank_mask:0xf
    v_add_f32_dpp v9, v9, v9 row_ror:2 row_mask:0xf bank_mask:0xf
    s_nop 0
    v_add_f32_dpp v8, v8, v8 row_ror:1 row_mask:0xf bank_mask:0xf
    v_add_f32_dpp v9, v9, v9 row_ror:1 row_mask:0xf bank_mask:0xf
    s_nop 0
    v_mov_b32 v10, v8
    v_mov_b32 v11, v9
    s_nop 1
    v_permlane16_swap_b32 v8, v10
    v_permlane16_swap_b32 v9, v11
    s_nop 1
    v_add_f32 v8, v8, v10
    v_add_f32 v9, v9, v11
    v_mov_b32 v10, v8
    v_mov_b32 v11, v9
    s_nop 1
    v_permlane32_swap_b32 v8, v10
    v_permlane32_swap_b32 v9, v11
    s_nop 1
    v_add_f32 v8, v8, v10
    v_add_f32 v9, v9, v11
    s_mov_b32 s34, 0x3acccccd
    s_mov_b32 s35, 0x3727c5ac
    v_mul_f32 v8, s34, v8
    v_mul_f32 v9, s34, v9
    v_fma_f32 v9, -v8, v8, v9
    v_max_f32 v9, 0, v9
    v_cvt_pk_bf16_f32 v10, v8, v9
    v_lshlrev_b32 v8, 16, v10
    v_and_b32 v9, 0xffff0000, v10
    v_add_f32 v9, s35, v9
    v_cvt_pk_bf16_f32 v10, v9, v9
    v_lshlrev_b32 v10, 16, v10
    v_sqrt_f32 v10, v10
    s_nop 0
    v_cvt_pk_bf16_f32 v10, v10, v10
    v_lshlrev_b32 v10, 16, v10
    v_rcp_f32 v9, v10
    s_lshl_b32 s32, s2, 3
    s_add_u32 s32, s32, s3
    s_lshl_b32 s32, s32, 3
    s_add_u32 s32, s32, 16777216
    v_mov_b32 v6, 0
    s_mov_b64 exec, 1
    buffer_store_dwordx2 v[8:9], v6, s[12:15], s32 offen sc1
    s_mov_b64 exec, -1
    v_mov_b32 v8, 0
    v_mov_b32 v9, 0
    v_mov_b32 v10, 0
    v_mov_b32 v11, 0
    s_cmp_lg_u32 s3, 0
    s_cbranch_scc1 L_nf_1
    s_lshl_b32 s34, s2, 7
    s_add_u32 s34, s34, 17170432
    v_and_b32 v6, 3, v1
    v_lshlrev_b32 v6, 4, v6
    v_bfe_u32 v7, v1, 2, 1
    v_mul_u32_u24 v7, 65536, v7
    v_add_u32 v6, v6, v7
    s_mov_b64 exec, 0xff
    buffer_store_dwordx4 v[8:11], v6, s[12:15], s34 offen sc1
    s_mov_b64 exec, -1
L_nf_1:
    s_add_u32 s33, s67, s57
    s_cmp_ge_u32 s33, 10
    s_cselect_b32 s34, 10, 0
    s_sub_u32 s33, s33, s34
    s_mul_i32 s34, s21, 10
    s_add_u32 s33, s33, s34
    s_lshl_b32 s33, s33, 2
    s_lshr_b32 s34, s3, 1
    s_add_u32 s33, s33, s34
    s_lshl_b32 s33, s33, 9
    s_add_u32 s27, s33, 18874368
    s_cmp_gt_u32 s57, 4
    s_cbranch_scc1 L_nz_2
    v_lshlrev_b32 v7, 4, v1
    s_mov_b64 exec, 0xffffffff
    buffer_store_dwordx4 v[8:11], v7, s[12:15], s27 offen sc1
    s_mov_b64 exec, -1
L_nz_2:
    s_cmp_lg_u32 s22, 2
    s_cbranch_scc1 L_nk_3
    s_lshl_b32 s33, s23, 3
    s_add_u32 s33, s33, s3
    s_lshl_b32 s33, s33, 4
    s_add_u32 s33, s33, s20
    s_mul_i32 s33, s33, 1792
    s_add_u32 s33, s33, 15728640
    v_lshlrev_b32 v7, 4, v1
    s_mov_b32 s34, -1
    s_mov_b32 s35, 0xffff
    buffer_store_dwordx4 v[8:11], v7, s[12:15], s33 offen sc1
    s_mov_b64 exec, s[34:35]
    buffer_store_dwordx4 v[8:11], v7, s[12:15], s33 offen offset:1024 sc1
    s_mov_b64 exec, -1
L_nk_3:
    s_waitcnt vmcnt(13) lgkmcnt(0)
    s_barrier
    s_cmp_eq_u32 s66, 2
    s_cbranch_scc1 L_b2
    ds_read_b128 v[136:139], v104 offset:0
    ds_read_b128 v[140:143], v104 offset:4096
    ds_read_b64_tr_b16 v[112:113], v100 offset:0
    ds_read_b64_tr_b16 v[114:115], v100 offset:1536
    ds_read_b64_tr_b16 v[116:117], v101 offset:0
    ds_read_b64_tr_b16 v[118:119], v101 offset:1536
    ds_read_b64_tr_b16 v[120:121], v102 offset:0
    ds_read_b64_tr_b16 v[122:123], v102 offset:1536
    s_waitcnt lgkmcnt(4)
    v_mfma_f32_32x32x16_bf16 v[160:175], v[112:115], v[136:139], v[160:175]
    ds_read_b128 v[144:147], v105 offset:0
    ds_read_b128 v[148:151], v105 offset:4096
    v_mfma_f32_32x32x16_bf16 v[208:223], v[112:115], v[140:143], v[208:223]
    ds_read_b64_tr_b16 v[124:125], v100 offset:6144
    ds_read_b64_tr_b16 v[126:127], v100 offset:7680
    s_waitcnt lgkmcnt(6)
    v_mfma_f32_32x32x16_bf16 v[176:191], v[116:119], v[136:139], v[176:191]
    ds_read_b64_tr_b16 v[128:129], v101 offset:6144
    ds_read_b64_tr_b16 v[130:131], v101 offset:7680
    v_mfma_f32_32x32x16_bf16 v[224:239], v[116:119], v[140:143], v[224:239]
    ds_read_b64_tr_b16 v[132:133], v102 offset:6144
    ds_read_b64_tr_b16 v[134:135], v102 offset:7680
    s_waitcnt lgkmcnt(8)
    v_mfma_f32_32x32x16_bf16 v[192:207], v[120:123], v[136:139], v[192:207]
    v_mfma_f32_32x32x16_bf16 v[240:255], v[120:123], v[140:143], v[240:255]
    s_cmp_lg_u32 s57, 0
    s_cbranch_scc1 L_cs_4
    v_dot2c_f32_bf16 v92, s52, v112
    v_dot2c_f32_bf16 v92, s52, v113
    v_dot2c_f32_bf16 v92, s52, v114
    v_dot2c_f32_bf16 v92, s52, v115
    v_dot2c_f32_bf16 v93, s52, v116
    v_dot2c_f32_bf16 v93, s52, v117
    v_dot2c_f32_bf16 v93, s52, v118
    v_dot2c_f32_bf16 v93, s52, v119
    v_dot2c_f32_bf16 v94, s52, v120
    v_dot2c_f32_bf16 v94, s52, v121
    v_dot2c_f32_bf16 v94, s52, v122
    v_dot2c_f32_bf16 v94, s52, v123
L_cs_4:
    s_waitcnt vmcnt(10) lgkmcnt(0)
    s_barrier
    v_mfma_f32_32x32x16_bf16 v[160:175], v[124:127], v[144:147], v[160:175]
    ds_read_b128 v[136:139], v106 offset:0
    ds_read_b128 v[140:143], v106 offset:4096
    s_add_u32 m0, s26, 0
    s_nop 0
    buffer_load_dwordx4 v108, s[4:7], s24 offen offset:0 lds
    v_mfma_f32_32x32x16_bf16 v[208:223], v[124:127], v[148:151], v[208:223]
    ds_read_b64_tr_b16 v[112:113], v100 offset:24832
    ds_read_b64_tr_b16 v[114:115], v100 offset:26368
    buffer_load_dwordx4 v109, s[4:7], s24 offen offset:1024 lds
    v_mfma_f32_32x32x16_bf16 v[176:191], v[128:131], v[144:147], v[176:191]
    ds_read_b64_tr_b16 v[116:117], v101 offset:24832
    ds_read_b64_tr_b16 v[118:119], v101 offset:26368
    v_mfma_f32_32x32x16_bf16 v[224:239], v[128:131], v[148:151], v[224:239]
    ds_read_b64_tr_b16 v[120:121], v102 offset:24832
    ds_read_b64_tr_b16 v[122:123], v102 offset:26368
    v_mfma_f32_32x32x16_bf16 v[192:207], v[132:135], v[144:147], v[192:207]
    v_mfma_f32_32x32x16_bf16 v[240:255], v[132:135], v[148:151], v[240:255]
    s_cmp_lg_u32 s57, 0
    s_cbranch_scc1 L_cs_5
    v_dot2c_f32_bf16 v92, s52, v124
    v_dot2c_f32_bf16 v92, s52, v125
    v_dot2c_f32_bf16 v92, s52, v126
    v_dot2c_f32_bf16 v92, s52, v127
    v_dot2c_f32_bf16 v93, s52, v128
    v_dot2c_f32_bf16 v93, s52, v129
    v_dot2c_f32_bf16 v93, s52, v130
    v_dot2c_f32_bf16 v93, s52, v131
    v_dot2c_f32_bf16 v94, s52, v132
    v_dot2c_f32_bf16 v94, s52, v133
    v_dot2c_f32_bf16 v94, s52, v134
    v_dot2c_f32_bf16 v94, s52, v135
L_cs_5:
    s_waitcnt lgkmcnt(4)
    v_mfma_f32_32x32x16_bf16 v[160:175], v[112:115], v[136:139], v[160:175]
    ds_read_b128 v[144:147], v107 offset:0
    ds_read_b128 v[148:151], v107 offset:4096
    s_add_u32 m0, s26, 0
    s_nop 0
    buffer_load_dwordx4 v110, s[4:7], s24 offen offset:2048 lds
    s_add_u32 s24, s24, s25
    v_mfma_f32_32x32x16_bf16 v[208:223], v[112:115], v[140:143], v[208:223]
    ds_read_b64_tr_b16 v[124:125], v100 offset:30976
    ds_read_b64_tr_b16 v[126:127], v100 offset:32512
    s_add_u32 m0, s28, 33792
    s_nop 0
    buffer_load_dwordx4 v99, s[8:11], s53 offen lds
    s_waitcnt lgkmcnt(6)
    v_mfma_f32_32x32x16_bf16 v[176:191], v[116:119], v[136:139], v[176:191]
    ds_read_b64_tr_b16 v[128:129], v101 offset:30976
    ds_read_b64_tr_b16 v[130:131], v101 offset:32512
    s_cmp_eq_u32 s29, 3
    s_cselect_b32 s49, -1152, s54
    s_add_u32 s53, s53, s49
    v_mfma_f32_32x32x16_bf16 v[224:239], v[116:119], v[140:143], v[224:239]
    ds_read_b64_tr_b16 v[132:133], v102 offset:30976
    ds_read_b64_tr_b16 v[134:135], v102 offset:32512
    s_waitcnt lgkmcnt(8)
    v_mfma_f32_32x32x16_bf16 v[192:207], v[120:123], v[136:139], v[192:207]
    v_mfma_f32_32x32x16_bf16 v[240:255], v[120:123], v[140:143], v[240:255]
    s_cmp_lg_u32 s57, 0
    s_cbranch_scc1 L_cs_6
    v_dot2c_f32_bf16 v92, s52, v112
    v_dot2c_f32_bf16 v92, s52, v113
    v_dot2c_f32_bf16 v92, s52, v114
    v_dot2c_f32_bf16 v92, s52, v115
    v_dot2c_f32_bf16 v93, s52, v116
    v_dot2c_f32_bf16 v93, s52, v117
    v_dot2c_f32_bf16 v93, s52, v118
    v_dot2c_f32_bf16 v93, s52, v119
    v_dot2c_f32_bf16 v94, s52, v120
    v_dot2c_f32_bf16 v94, s52, v121
    v_dot2c_f32_bf16 v94, s52, v122
    v_dot2c_f32_bf16 v94, s52, v123
L_cs_6:
    s_waitcnt vmcnt(9) lgkmcnt(0)
    s_barrier
    v_mfma_f32_32x32x16_bf16 v[160:175], v[124:127], v[144:147], v[160:175]
    ds_read_b128 v[136:139], v104 offset:16384
    ds_read_b128 v[140:143], v104 offset:20480
    s_add_u32 m0, s26, 24832
    s_nop 0
    buffer_load_dwordx4 v108, s[4:7], s24 offen offset:0 lds
    v_mfma_f32_32x32x16_bf16 v[208:223], v[124:127], v[148:151], v[208:223]
    ds_read_b64_tr_b16 v[112:113], v152 offset:0
    ds_read_b64_tr_b16 v[114:115], v152 offset:1536
    buffer_load_dwordx4 v109, s[4:7], s24 offen offset:1024 lds
    v_mfma_f32_32x32x16_bf16 v[176:191], v[128:131], v[144:147], v[176:191]
    ds_read_b64_tr_b16 v[116:117], v153 offset:0
    ds_read_b64_tr_b16 v[118:119], v153 offset:1536
    v_mfma_f32_32x32x16_bf16 v[224:239], v[128:131], v[148:151], v[224:239]
    ds_read_b64_tr_b16 v[120:121], v154 offset:0
    ds_read_b64_tr_b16 v[122:123], v154 offset:1536
    v_mfma_f32_32x32x16_bf16 v[192:207], v[132:135], v[144:147], v[192:207]
    v_mfma_f32_32x32x16_bf16 v[240:255], v[132:135], v[148:151], v[240:255]
    s_cmp_lg_u32 s57, 0
    s_cbranch_scc1 L_cs_7
    v_dot2c_f32_bf16 v92, s52, v124
    v_dot2c_f32_bf16 v92, s52, v125
    v_dot2c_f32_bf16 v92, s52, v126
    v_dot2c_f32_bf16 v92, s52, v127
    v_dot2c_f32_bf16 v93, s52, v128
    v_dot2c_f32_bf16 v93, s52, v129
    v_dot2c_f32_bf16 v93, s52, v130
    v_dot2c_f32_bf16 v93, s52, v131
    v_dot2c_f32_bf16 v94, s52, v132
    v_dot2c_f32_bf16 v94, s52, v133
    v_dot2c_f32_bf16 v94, s52, v134
    v_dot2c_f32_bf16 v94, s52, v135
L_cs_7:
    s_waitcnt lgkmcnt(4)
    v_mfma_f32_32x32x16_bf16 v[160:175], v[112:115], v[136:139], v[160:175]
    ds_read_b128 v[144:147], v105 offset:16384
    ds_read_b128 v[148:151], v105 offset:20480
    s_add_u32 m0, s26, 24832
    s_nop 0
    buffer_load_dwordx4 v110, s[4:7], s24 offen offset:2048 lds
    s_cmp_eq_u32 s29, 3
    s_cselect_b32 s49, s48, s25
    s_add_u32 s24, s24, s49
    v_mfma_f32_32x32x16_bf16 v[208:223], v[112:115], v[140:143], v[208:223]
    ds_read_b64_tr_b16 v[124:125], v152 offset:6144
    ds_read_b64_tr_b16 v[126:127], v152 offset:7680
    s_add_u32 m0, s28, 0
    s_nop 0
    buffer_load_dwordx4 v98, s[8:11], s53 offen lds
    s_waitcnt lgkmcnt(6)
    v_mfma_f32_32x32x16_bf16 v[176:191], v[116:119], v[136:139], v[176:191]
    ds_read_b64_tr_b16 v[128:129], v153 offset:6144
    ds_read_b64_tr_b16 v[130:131], v153 offset:7680
    v_mfma_f32_32x32x16_bf16 v[224:239], v[116:119], v[140:143], v[224:239]
    ds_read_b64_tr_b16 v[132:133], v154 offset:6144
    ds_read_b64_tr_b16 v[134:135], v154 offset:7680
    s_waitcnt lgkmcnt(8)
    v_mfma_f32_32x32x16_bf16 v[192:207], v[120:123], v[136:139], v[192:207]
    v_mfma_f32_32x32x16_bf16 v[240:255], v[120:123], v[140:143], v[240:255]
    s_cmp_lg_u32 s57, 1
    s_cbranch_scc1 L_cs_8
    v_dot2c_f32_bf16 v92, s52, v112
    v_dot2c_f32_bf16 v92, s52, v113
    v_dot2c_f32_bf16 v92, s52, v114
    v_dot2c_f32_bf16 v92, s52, v115
    v_dot2c_f32_bf16 v93, s52, v116
    v_dot2c_f32_bf16 v93, s52, v117
    v_dot2c_f32_bf16 v93, s52, v118
    v_dot2c_f32_bf16 v93, s52, v119
    v_dot2c_f32_bf16 v94, s52, v120
    v_dot2c_f32_bf16 v94, s52, v121
    v_dot2c_f32_bf16 v94, s52, v122
    v_dot2c_f32_bf16 v94, s52, v123
L_cs_8:
    s_waitcnt vmcnt(8) lgkmcnt(0)
    s_barrier
    v_mfma_f32_32x32x16_bf16 v[160:175], v[124:127], v[144:147], v[160:175]
    ds_read_b128 v[136:139], v106 offset:16384
    ds_read_b128 v[140:143], v106 offset:20480
    s_add_u32 m0, s26, 49664
    s_nop 0
    buffer_load_dwordx4 v108, s[4:7], s24 offen offset:0 lds
    v_mfma_f32_32x32x16_bf16 v[208:223], v[124:127], v[148:151], v[208:223]
    ds_read_b64_tr_b16 v[112:113], v152 offset:24832
    ds_read_b64_tr_b16 v[114:115], v152 offset:26368
    buffer_load_dwordx4 v109, s[4:7], s24 offen offset:1024 lds
    v_mfma_f32_32x32x16_bf16 v[176:191], v[128:131], v[144:147], v[176:191]
    ds_read_b64_tr_b16 v[116:117], v153 offset:24832
    ds_read_b64_tr_b16 v[118:119], v153 offset:26368
    s_cmp_lg_u32 s3, 0
    s_cbranch_scc1 L_in3
    s_lshr_b32 s34, s2, 3
    s_and_b32 s34, s34, 3
    s_lshl_b32 s34, s34, 6
    v_mov_b32 v6, s34
    v_mov_b32 v7, 1
    s_mov_b64 exec, 1
    buffer_atomic_add v7, v6, s[16:19], 0 offen sc1
    s_mov_b64 exec, -1
L_in3:
    v_mfma_f32_32x32x16_bf16 v[224:239], v[128:131], v[148:151], v[224:239]
    ds_read_b64_tr_b16 v[120:121], v154 offset:24832
    ds_read_b64_tr_b16 v[122:123], v154 offset:26368
    s_cmp_lg_u32 s57, 0
    s_cbranch_scc1 L_pub3_0_9
    v_mov_b32 v9, v92
    s_nop 1
    v_permlane32_swap_b32 v92, v9
    s_nop 1
    v_add_f32 v9, v9, v92
    v_or_b32 v12, 1, v9
    v_mov_b32 v9, v93
    s_nop 1
    v_permlane32_swap_b32 v93, v9
    s_nop 1
    v_add_f32 v9, v9, v93
    v_or_b32 v13, 1, v9
    v_mov_b32 v9, v94
    s_nop 1
    v_permlane32_swap_b32 v94, v9
    s_nop 1
    v_add_f32 v9, v9, v94
    v_or_b32 v14, 1, v9
    v_and_b32 v6, 31, v1
    v_lshlrev_b32 v6, 4, v6
    buffer_store_dwordx3 v[12:14], v6, s[12:15], s27 offen sc1
L_pub3_0_9:
    v_mfma_f32_32x32x16_bf16 v[192:207], v[132:135], v[144:147], v[192:207]
    v_mfma_f32_32x32x16_bf16 v[240:255], v[132:135], v[148:151], v[240:255]
    s_cmp_lg_u32 s57, 1
    s_cbranch_scc1 L_cs_10
    v_dot2c_f32_bf16 v92, s52, v124
    v_dot2c_f32_bf16 v92, s52, v125
    v_dot2c_f32_bf16 v92, s52, v126
    v_dot2c_f32_bf16 v92, s52, v127
    v_dot2c_f32_bf16 v93, s52, v128
    v_dot2c_f32_bf16 v93, s52, v129
    v_dot2c_f32_bf16 v93, s52, v130
    v_dot2c_f32_bf16 v93, s52, v131
    v_dot2c_f32_bf16 v94, s52, v132
    v_dot2c_f32_bf16 v94, s52, v133
    v_dot2c_f32_bf16 v94, s52, v134
    v_dot2c_f32_bf16 v94, s52, v135
L_cs_10:
    s_waitcnt lgkmcnt(4)
    v_mfma_f32_32x32x16_bf16 v[160:175], v[112:115], v[136:139], v[160:175]
    ds_read_b128 v[144:147], v107 offset:16384
    ds_read_b128 v[148:151], v107 offset:20480
    s_add_u32 m0, s26, 49664
    s_nop 0
    buffer_load_dwordx4 v110, s[4:7], s24 offen offset:2048 lds
    s_add_u32 s24, s24, s25
    v_mfma_f32_32x32x16_bf16 v[208:223], v[112:115], v[140:143], v[208:223]
    ds_read_b64_tr_b16 v[124:125], v152 offset:30976
    ds_read_b64_tr_b16 v[126:127], v152 offset:32512
    s_add_u32 m0, s28, 1024
    s_nop 0
    buffer_load_dwordx4 v99, s[8:11], s53 offen lds
    s_waitcnt lgkmcnt(6)
    v_mfma_f32_32x32x16_bf16 v[176:191], v[116:119], v[136:139], v[176:191]
    ds_read_b64_tr_b16 v[128:129], v153 offset:30976
    ds_read_b64_tr_b16 v[130:131], v153 offset:32512
    s_cmp_eq_u32 s29, 4
    s_cselect_b32 s49, -1152, s54
    s_add_u32 s53, s53, s49
    v_mfma_f32_32x32x16_bf16 v[224:239], v[116:119], v[140:143], v[224:239]
    ds_read_b64_tr_b16 v[132:133], v154 offset:30976
    ds_read_b64_tr_b16 v[134:135], v154 offset:32512
    s_waitcnt lgkmcnt(8)
    v_mfma_f32_32x32x16_bf16 v[192:207], v[120:123], v[136:139], v[192:207]
    v_mfma_f32_32x32x16_bf16 v[240:255], v[120:123], v[140:143], v[240:255]
    s_cmp_lg_u32 s57, 1
    s_cbranch_scc1 L_cs_11
    v_dot2c_f32_bf16 v92, s52, v112
    v_dot2c_f32_bf16 v92, s52, v113
    v_dot2c_f32_bf16 v92, s52, v114
    v_dot2c_f32_bf16 v92, s52, v115
    v_dot2c_f32_bf16 v93, s52, v116
    v_dot2c_f32_bf16 v93, s52, v117
    v_dot2c_f32_bf16 v93, s52, v118
    v_dot2c_f32_bf16 v93, s52, v119
    v_dot2c_f32_bf16 v94, s52, v120
    v_dot2c_f32_bf16 v94, s52, v121
    v_dot2c_f32_bf16 v94, s52, v122
    v_dot2c_f32_bf16 v94, s52, v123
L_cs_11:
    s_waitcnt vmcnt(8) lgkmcnt(0)
    s_barrier
    v_mfma_f32_32x32x16_bf16 v[160:175], v[124:127], v[144:147], v[160:175]
    ds_read_b128 v[136:139], v104 offset:32768
    ds_read_b128 v[140:143], v104 offset:36864
    s_add_u32 m0, s26, 74496
    s_nop 0
    buffer_load_dwordx4 v108, s[4:7], s24 offen offset:0 lds
    v_mfma_f32_32x32x16_bf16 v[208:223], v[124:127], v[148:151], v[208:223]
    ds_read_b64_tr_b16 v[112:113], v100 offset:0
    ds_read_b64_tr_b16 v[114:115], v100 offset:1536
    buffer_load_dwordx4 v109, s[4:7], s24 offen offset:1024 lds
    v_mfma_f32_32x32x16_bf16 v[176:191], v[128:131], v[144:147], v[176:191]
    ds_read_b64_tr_b16 v[116:117], v101 offset:0
    ds_read_b64_tr_b16 v[118:119], v101 offset:1536
    v_mfma_f32_32x32x16_bf16 v[224:239], v[128:131], v[148:151], v[224:239]
    ds_read_b64_tr_b16 v[120:121], v102 offset:0
    ds_read_b64_tr_b16 v[122:123], v102 offset:1536
    v_mfma_f32_32x32x16_bf16 v[192:207], v[132:135], v[144:147], v[192:207]
    v_mfma_f32_32x32x16_bf16 v[240:255], v[132:135], v[148:151], v[240:255]
    s_cmp_lg_u32 s57, 1
    s_cbranch_scc1 L_cs_12
    v_dot2c_f32_bf16 v92, s52, v124
    v_dot2c_f32_bf16 v92, s52, v125
    v_dot2c_f32_bf16 v92, s52, v126
    v_dot2c_f32_bf16 v92, s52, v127
    v_dot2c_f32_bf16 v93, s52, v128
    v_dot2c_f32_bf16 v93, s52, v129
    v_dot2c_f32_bf16 v93, s52, v130
    v_dot2c_f32_bf16 v93, s52, v131
    v_dot2c_f32_bf16 v94, s52, v132
    v_dot2c_f32_bf16 v94, s52, v133
    v_dot2c_f32_bf16 v94, s52, v134
    v_dot2c_f32_bf16 v94, s52, v135
L_cs_12:
    s_waitcnt lgkmcnt(4)
    v_mfma_f32_32x32x16_bf16 v[160:175], v[112:115], v[136:139], v[160:175]
    ds_read_b128 v[144:147], v105 offset:32768
    ds_read_b128 v[148:151], v105 offset:36864
    s_add_u32 m0, s26, 74496
    s_nop 0
    buffer_load_dwordx4 v110, s[4:7], s24 offen offset:2048 lds
    s_cmp_eq_u32 s29, 4
    s_cselect_b32 s49, s48, s25
    s_add_u32 s24, s24, s49
    v_mfma_f32_32x32x16_bf16 v[208:223], v[112:115], v[140:143], v[208:223]
    ds_read_b64_tr_b16 v[124:125], v100 offset:6144
    ds_read_b64_tr_b16 v[126:127], v100 offset:7680
    s_add_u32 m0, s28, 16384
    s_nop 0
    buffer_load_dwordx4 v98, s[8:11], s53 offen lds
    s_waitcnt lgkmcnt(6)
    v_mfma_f32_32x32x16_bf16 v[176:191], v[116:119], v[136:139], v[176:191]
    ds_read_b64_tr_b16 v[128:129], v101 offset:6144
    ds_read_b64_tr_b16 v[130:131], v101 offset:7680
    v_mfma_f32_32x32x16_bf16 v[224:239], v[116:119], v[140:143], v[224:239]
    ds_read_b64_tr_b16 v[132:133], v102 offset:6144
    ds_read_b64_tr_b16 v[134:135], v102 offset:7680
    s_waitcnt lgkmcnt(8)
    v_mfma_f32_32x32x16_bf16 v[192:207], v[120:123], v[136:139], v[192:207]
    v_mfma_f32_32x32x16_bf16 v[240:255], v[120:123], v[140:143], v[240:255]
    s_cmp_lg_u32 s57, 2
    s_cbranch_scc1 L_cs_13
    v_dot2c_f32_bf16 v92, s52, v112
    v_dot2c_f32_bf16 v92, s52, v113
    v_dot2c_f32_bf16 v92, s52, v114
    v_dot2c_f32_bf16 v92, s52, v115
    v_dot2c_f32_bf16 v93, s52, v116
    v_dot2c_f32_bf16 v93, s52, v117
    v_dot2c_f32_bf16 v93, s52, v118
    v_dot2c_f32_bf16 v93, s52, v119
    v_dot2c_f32_bf16 v94, s52, v120
    v_dot2c_f32_bf16 v94, s52, v121
    v_dot2c_f32_bf16 v94, s52, v122
    v_dot2c_f32_bf16 v94, s52, v123
L_cs_13:
    s_waitcnt vmcnt(9) lgkmcnt(0)
    s_barrier
    v_mfma_f32_32x32x16_bf16 v[160:175], v[124:127], v[144:147], v[160:175]
    ds_read_b128 v[136:139], v106 offset:32768
    ds_read_b128 v[140:143], v106 offset:36864
    s_add_u32 m0, s26, 0
    s_nop 0
    buffer_load_dwordx4 v108, s[4:7], s24 offen offset:0 lds
    v_mfma_f32_32x32x16_bf16 v[208:223], v[124:127], v[148:151], v[208:223]
    ds_read_b64_tr_b16 v[112:113], v100 offset:24832
    ds_read_b64_tr_b16 v[114:115], v100 offset:26368
    buffer_load_dwordx4 v109, s[4:7], s24 offen offset:1024 lds
    v_mfma_f32_32x32x16_bf16 v[176:191], v[128:131], v[144:147], v[176:191]
    ds_read_b64_tr_b16 v[116:117], v101 offset:24832
    ds_read_b64_tr_b16 v[118:119], v101 offset:26368
    s_cmp_lg_u32 s57, 1
    s_cbranch_scc1 L_pub3_1_14
    v_mov_b32 v9, v92
    s_nop 1
    v_permlane32_swap_b32 v92, v9
    s_nop 1
    v_add_f32 v9, v9, v92
    v_or_b32 v12, 1, v9
    v_mov_b32 v9, v93
    s_nop 1
    v_permlane32_swap_b32 v93, v9
    s_nop 1
    v_add_f32 v9, v9, v93
    v_or_b32 v13, 1, v9
    v_mov_b32 v9, v94
    s_nop 1
    v_permlane32_swap_b32 v94, v9
    s_nop 1
    v_add_f32 v9, v9, v94
    v_or_b32 v14, 1, v9
    v_and_b32 v6, 31, v1
    v_lshlrev_b32 v6, 4, v6
    buffer_store_dwordx3 v[12:14], v6, s[12:15], s27 offen sc1
L_pub3_1_14:
    v_mfma_f32_32x32x16_bf16 v[224:239], v[128:131], v[148:151], v[224:239]
    ds_read_b64_tr_b16 v[120:121], v102 offset:24832
    ds_read_b64_tr_b16 v[122:123], v102 offset:26368
    v_mfma_f32_32x32x16_bf16 v[192:207], v[132:135], v[144:147], v[192:207]
    v_mfma_f32_32x32x16_bf16 v[240:255], v[132:135], v[148:151], v[240:255]
    s_cmp_lg_u32 s57, 2
    s_cbranch_scc1 L_cs_15
    v_dot2c_f32_bf16 v92, s52, v124
    v_dot2c_f32_bf16 v92, s52, v125
    v_dot2c_f32_bf16 v92, s52, v126
    v_dot2c_f32_bf16 v92, s52, v127
    v_dot2c_f32_bf16 v93, s52, v128
    v_dot2c_f32_bf16 v93, s52, v129
    v_dot2c_f32_bf16 v93, s52, v130
    v_dot2c_f32_bf16 v93, s52, v131
    v_dot2c_f32_bf16 v94, s52, v132
    v_dot2c_f32_bf16 v94, s52, v133
    v_dot2c_f32_bf16 v94, s52, v134
    v_dot2c_f32_bf16 v94, s52, v135
L_cs_15:
    s_waitcnt lgkmcnt(4)
    v_mfma_f32_32x32x16_bf16 v[160:175], v[112:115], v[136:139], v[160:175]
    ds_read_b128 v[144:147], v107 offset:32768
    ds_read_b128 v[148:151], v107 offset:36864
    s_add_u32 m0, s26, 0
    s_nop 0
    buffer_load_dwordx4 v110, s[4:7], s24 offen offset:2048 lds
    s_add_u32 s24, s24, s25
    v_mfma_f32_32x32x16_bf16 v[208:223], v[112:115], v[140:143], v[208:223]
    ds_read_b64_tr_b16 v[124:125], v100 offset:30976
    ds_read_b64_tr_b16 v[126:127], v100 offset:32512
    s_add_u32 m0, s28, 17408
    s_nop 0
    buffer_load_dwordx4 v99, s[8:11], s53 offen lds
    s_waitcnt lgkmcnt(6)
    v_mfma_f32_32x32x16_bf16 v[176:191], v[116:119], v[136:139], v[176:191]
    ds_read_b64_tr_b16 v[128:129], v101 offset:30976
    ds_read_b64_tr_b16 v[130:131], v101 offset:32512
    s_cmp_eq_u32 s29, 5
    s_cselect_b32 s49, -1152, s54
    s_add_u32 s53, s53, s49
    v_mfma_f32_32x32x16_bf16 v[224:239], v[116:119], v[140:143], v[224:239]
    ds_read_b64_tr_b16 v[132:133], v102 offset:30976
    ds_read_b64_tr_b16 v[134:135], v102 offset:32512
    s_waitcnt lgkmcnt(8)
    v_mfma_f32_32x32x16_bf16 v[192:207], v[120:123], v[136:139], v[192:207]
    v_mfma_f32_32x32x16_bf16 v[240:255], v[120:123], v[140:143], v[240:255]
    s_cmp_lg_u32 s57, 2
    s_cbranch_scc1 L_cs_16
    v_dot2c_f32_bf16 v92, s52, v112
    v_dot2c_f32_bf16 v92, s52, v113
    v_dot2c_f32_bf16 v92, s52, v114
    v_dot2c_f32_bf16 v92, s52, v115
    v_dot2c_f32_bf16 v93, s52, v116
    v_dot2c_f32_bf16 v93, s52, v117
    v_dot2c_f32_bf16 v93, s52, v118
    v_dot2c_f32_bf16 v93, s52, v119
    v_dot2c_f32_bf16 v94, s52, v120
    v_dot2c_f32_bf16 v94, s52, v121
    v_dot2c_f32_bf16 v94, s52, v122
    v_dot2c_f32_bf16 v94, s52, v123
L_cs_16:
    s_waitcnt vmcnt(8) lgkmcnt(0)
    s_barrier
    v_mfma_f32_32x32x16_bf16 v[160:175], v[124:127], v[144:147], v[160:175]
    ds_read_b128 v[136:139], v104 offset:0
    ds_read_b128 v[140:143], v104 offset:4096
    s_add_u32 m0, s26, 24832
    s_nop 0
    buffer_load_dwordx4 v108, s[4:7], s24 offen offset:0 lds
    v_mfma_f32_32x32x16_bf16 v[208:223], v[124:127], v[148:151], v[208:223]
    ds_read_b64_tr_b16 v[112:113], v152 offset:0
    ds_read_b64_tr_b16 v[114:115], v152 offset:1536
    buffer_load_dwordx4 v109, s[4:7], s24 offen offset:1024 lds
    v_mfma_f32_32x32x16_bf16 v[176:191], v[128:131], v[144:147], v[176:191]
    ds_read_b64_tr_b16 v[116:117], v153 offset:0
    ds_read_b64_tr_b16 v[118:119], v153 offset:1536
    v_mfma_f32_32x32x16_bf16 v[224:239], v[128:131], v[148:151], v[224:239]
    ds_read_b64_tr_b16 v[120:121], v154 offset:0
    ds_read_b64_tr_b16 v[122:123], v154 offset:1536
    v_mfma_f32_32x32x16_bf16 v[192:207], v[132:135], v[144:147], v[192:207]
    v_mfma_f32_32x32x16_bf16 v[240:255], v[132:135], v[148:151], v[240:255]
    s_cmp_lg_u32 s57, 2
    s_cbranch_scc1 L_cs_17
    v_dot2c_f32_bf16 v92, s52, v124
    v_dot2c_f32_bf16 v92, s52, v125
    v_dot2c_f32_bf16 v92, s52, v126
    v_dot2c_f32_bf16 v92, s52, v127
    v_dot2c_f32_bf16 v93, s52, v128
    v_dot2c_f32_bf16 v93, s52, v129
    v_dot2c_f32_bf16 v93, s52, v130
    v_dot2c_f32_bf16 v93, s52, v131
    v_dot2c_f32_bf16 v94, s52, v132
    v_dot2c_f32_bf16 v94, s52, v133
    v_dot2c_f32_bf16 v94, s52, v134
    v_dot2c_f32_bf16 v94, s52, v135
L_cs_17:
    s_waitcnt lgkmcnt(4)
    v_mfma_f32_32x32x16_bf16 v[160:175], v[112:115], v[136:139], v[160:175]
    ds_read_b128 v[144:147], v105 offset:0
    ds_read_b128 v[148:151], v105 offset:4096
    s_add_u32 m0, s26, 24832
    s_nop 0
    buffer_load_dwordx4 v110, s[4:7], s24 offen offset:2048 lds
    s_cmp_eq_u32 s29, 5
    s_cselect_b32 s49, s48, s25
    s_add_u32 s24, s24, s49
    v_mfma_f32_32x32x16_bf16 v[208:223], v[112:115], v[140:143], v[208:223]
    ds_read_b64_tr_b16 v[124:125], v152 offset:6144
    ds_read_b64_tr_b16 v[126:127], v152 offset:7680
    s_add_u32 m0, s28, 32768
    s_nop 0
    buffer_load_dwordx4 v98, s[8:11], s53 offen lds
    s_waitcnt lgkmcnt(6)
    v_mfma_f32_32x32x16_bf16 v[176:191], v[116:119], v[136:139], v[176:191]
    ds_read_b64_tr_b16 v[128:129], v153 offset:6144
    ds_read_b64_tr_b16 v[130:131], v153 offset:7680
    v_mfma_f32_32x32x16_bf16 v[224:239], v[116:119], v[140:143], v[224:239]
    ds_read_b64_tr_b16 v[132:133], v154 offset:6144
    ds_read_b64_tr_b16 v[134:135], v154 offset:7680
    s_waitcnt lgkmcnt(8)
    v_mfma_f32_32x32x16_bf16 v[192:207], v[120:123], v[136:139], v[192:207]
    v_mfma_f32_32x32x16_bf16 v[240:255], v[120:123], v[140:143], v[240:255]
    s_cmp_lg_u32 s57, 3
    s_cbranch_scc1 L_cs_18
    v_dot2c_f32_bf16 v92, s52, v112
    v_dot2c_f32_bf16 v92, s52, v113
    v_dot2c_f32_bf16 v92, s52, v114
    v_dot2c_f32_bf16 v92, s52, v115
    v_dot2c_f32_bf16 v93, s52, v116
    v_dot2c_f32_bf16 v93, s52, v117
    v_dot2c_f32_bf16 v93, s52, v118
    v_dot2c_f32_bf16 v93, s52, v119
    v_dot2c_f32_bf16 v94, s52, v120
    v_dot2c_f32_bf16 v94, s52, v121
    v_dot2c_f32_bf16 v94, s52, v122
    v_dot2c_f32_bf16 v94, s52, v123
L_cs_18:
    s_waitcnt vmcnt(9) lgkmcnt(0)
    s_barrier
    v_mfma_f32_32x32x16_bf16 v[160:175], v[124:127], v[144:147], v[160:175]
    ds_read_b128 v[136:139], v106 offset:0
    ds_read_b128 v[140:143], v106 offset:4096
    s_add_u32 m0, s26, 49664
    s_nop 0
    buffer_load_dwordx4 v108, s[4:7], s24 offen offset:0 lds
    v_mfma_f32_32x32x16_bf16 v[208:223], v[124:127], v[148:151], v[208:223]
    ds_read_b64_tr_b16 v[112:113], v152 offset:24832
    ds_read_b64_tr_b16 v[114:115], v152 offset:26368
    buffer_load_dwordx4 v109, s[4:7], s24 offen offset:1024 lds
    v_mfma_f32_32x32x16_bf16 v[176:191], v[128:131], v[144:147], v[176:191]
    ds_read_b64_tr_b16 v[116:117], v153 offset:24832
    ds_read_b64_tr_b16 v[118:119], v153 offset:26368
    s_cmp_lg_u32 s57, 2
    s_cbranch_scc1 L_pub3_2_19
    v_mov_b32 v9, v92
    s_nop 1
    v_permlane32_swap_b32 v92, v9
    s_nop 1
    v_add_f32 v9, v9, v92
    v_or_b32 v12, 1, v9
    v_mov_b32 v9, v93
    s_nop 1
    v_permlane32_swap_b32 v93, v9
    s_nop 1
    v_add_f32 v9, v9, v93
    v_or_b32 v13, 1, v9
    v_mov_b32 v9, v94
    s_nop 1
    v_permlane32_swap_b32 v94, v9
    s_nop 1
    v_add_f32 v9, v9, v94
    v_or_b32 v14, 1, v9
    v_and_b32 v6, 31, v1
    v_lshlrev_b32 v6, 4, v6
    buffer_store_dwordx3 v[12:14], v6, s[12:15], s27 offen sc1
L_pub3_2_19:
    v_mfma_f32_32x32x16_bf16 v[224:239], v[128:131], v[148:151], v[224:239]
    ds_read_b64_tr_b16 v[120:121], v154 offset:24832
    ds_read_b64_tr_b16 v[122:123], v154 offset:26368
    v_mfma_f32_32x32x16_bf16 v[192:207], v[132:135], v[144:147], v[192:207]
    v_mfma_f32_32x32x16_bf16 v[240:255], v[132:135], v[148:151], v[240:255]
    s_cmp_lg_u32 s57, 3
    s_cbranch_scc1 L_cs_20
    v_dot2c_f32_bf16 v92, s52, v124
    v_dot2c_f32_bf16 v92, s52, v125
    v_dot2c_f32_bf16 v92, s52, v126
    v_dot2c_f32_bf16 v92, s52, v127
    v_dot2c_f32_bf16 v93, s52, v128
    v_dot2c_f32_bf16 v93, s52, v129
    v_dot2c_f32_bf16 v93, s52, v130
    v_dot2c_f32_bf16 v93, s52, v131
    v_dot2c_f32_bf16 v94, s52, v132
    v_dot2c_f32_bf16 v94, s52, v133
    v_dot2c_f32_bf16 v94, s52, v134
    v_dot2c_f32_bf16 v94, s52, v135
L_cs_20:
    s_waitcnt lgkmcnt(4)
    v_mfma_f32_32x32x16_bf16 v[160:175], v[112:115], v[136:139], v[160:175]
    ds_read_b128 v[144:147], v107 offset:0
    ds_read_b128 v[148:151], v107 offset:4096
    s_add_u32 m0, s26, 49664
    s_nop 0
    buffer_load_dwordx4 v110, s[4:7], s24 offen offset:2048 lds
    s_add_u32 s24, s24, s25
    v_mfma_f32_32x32x16_bf16 v[208:223], v[112:115], v[140:143], v[208:223]
    ds_read_b64_tr_b16 v[124:125], v152 offset:30976
    ds_read_b64_tr_b16 v[126:127], v152 offset:32512
    s_add_u32 m0, s28, 33792
    s_nop 0
    buffer_load_dwordx4 v99, s[8:11], s53 offen lds
    s_waitcnt lgkmcnt(6)
    v_mfma_f32_32x32x16_bf16 v[176:191], v[116:119], v[136:139], v[176:191]
    ds_read_b64_tr_b16 v[128:129], v153 offset:30976
    ds_read_b64_tr_b16 v[130:131], v153 offset:32512
    s_cmp_eq_u32 s29, 6
    s_cselect_b32 s49, -1152, s54
    s_add_u32 s53, s53, s49
    v_mfma_f32_32x32x16_bf16 v[224:239], v[116:119], v[140:143], v[224:239]
    ds_read_b64_tr_b16 v[132:133], v154 offset:30976
    ds_read_b64_tr_b16 v[134:135], v154 offset:32512
    s_waitcnt lgkmcnt(8)
    v_mfma_f32_32x32x16_bf16 v[192:207], v[120:123], v[136:139], v[192:207]
    v_mfma_f32_32x32x16_bf16 v[240:255], v[120:123], v[140:143], v[240:255]
    s_cmp_lg_u32 s57, 3
    s_cbranch_scc1 L_cs_21
    v_dot2c_f32_bf16 v92, s52, v112
    v_dot2c_f32_bf16 v92, s52, v113
    v_dot2c_f32_bf16 v92, s52, v114
    v_dot2c_f32_bf16 v92, s52, v115
    v_dot2c_f32_bf16 v93, s52, v116
    v_dot2c_f32_bf16 v93, s52, v117
    v_dot2c_f32_bf16 v93, s52, v118
    v_dot2c_f32_bf16 v93, s52, v119
    v_dot2c_f32_bf16 v94, s52, v120
    v_dot2c_f32_bf16 v94, s52, v121
    v_dot2c_f32_bf16 v94, s52, v122
    v_dot2c_f32_bf16 v94, s52, v123
L_cs_21:
    s_waitcnt vmcnt(8) lgkmcnt(0)
    s_barrier
    v_mfma_f32_32x32x16_bf16 v[160:175], v[124:127], v[144:147], v[160:175]
    ds_read_b128 v[136:139], v104 offset:16384
    ds_read_b128 v[140:143], v104 offset:20480
    s_add_u32 m0, s26, 74496
    s_nop 0
    buffer_load_dwordx4 v108, s[4:7], s24 offen offset:0 lds
    v_mfma_f32_32x32x16_bf16 v[208:223], v[124:127], v[148:151], v[208:223]
    ds_read_b64_tr_b16 v[112:113], v100 offset:0
    ds_read_b64_tr_b16 v[114:115], v100 offset:1536
    buffer_load_dwordx4 v109, s[4:7], s24 offen offset:1024 lds
    v_mfma_f32_32x32x16_bf16 v[176:191], v[128:131], v[144:147], v[176:191]
    ds_read_b64_tr_b16 v[116:117], v101 offset:0
    ds_read_b64_tr_b16 v[118:119], v101 offset:1536
    v_mfma_f32_32x32x16_bf16 v[224:239], v[128:131], v[148:151], v[224:239]
    ds_read_b64_tr_b16 v[120:121], v102 offset:0
    ds_read_b64_tr_b16 v[122:123], v102 offset:1536
    v_mfma_f32_32x32x16_bf16 v[192:207], v[132:135], v[144:147], v[192:207]
    v_mfma_f32_32x32x16_bf16 v[240:255], v[132:135], v[148:151], v[240:255]
    s_cmp_lg_u32 s57, 3
    s_cbranch_scc1 L_cs_22
    v_dot2c_f32_bf16 v92, s52, v124
    v_dot2c_f32_bf16 v92, s52, v125
    v_dot2c_f32_bf16 v92, s52, v126
    v_dot2c_f32_bf16 v92, s52, v127
    v_dot2c_f32_bf16 v93, s52, v128
    v_dot2c_f32_bf16 v93, s52, v129
    v_dot2c_f32_bf16 v93, s52, v130
    v_dot2c_f32_bf16 v93, s52, v131
    v_dot2c_f32_bf16 v94, s52, v132
    v_dot2c_f32_bf16 v94, s52, v133
    v_dot2c_f32_bf16 v94, s52, v134
    v_dot2c_f32_bf16 v94, s52, v135
L_cs_22:
    s_waitcnt lgkmcnt(4)
    v_mfma_f32_32x32x16_bf16 v[160:175], v[112:115], v[136:139], v[160:175]
    ds_read_b128 v[144:147], v105 offset:16384
    ds_read_b128 v[148:151], v105 offset:20480
    s_add_u32 m0, s26, 74496
    s_nop 0
    buffer_load_dwordx4 v110, s[4:7], s24 offen offset:2048 lds
    s_cmp_eq_u32 s29, 6
    s_cselect_b32 s49, s48, s25
    s_add_u32 s24, s24, s49
    v_mfma_f32_32x32x16_bf16 v[208:223], v[112:115], v[140:143], v[208:223]
    ds_read_b64_tr_b16 v[124:125], v100 offset:6144
    ds_read_b64_tr_b16 v[126:127], v100 offset:7680
    s_add_u32 m0, s28, 0
    s_nop 0
    buffer_load_dwordx4 v98, s[8:11], s53 offen lds
    s_waitcnt lgkmcnt(6)
    v_mfma_f32_32x32x16_bf16 v[176:191], v[116:119], v[136:139], v[176:191]
    ds_read_b64_tr_b16 v[128:129], v101 offset:6144
    ds_read_b64_tr_b16 v[130:131], v101 offset:7680
    v_mfma_f32_32x32x16_bf16 v[224:239], v[116:119], v[140:143], v[224:239]
    ds_read_b64_tr_b16 v[132:133], v102 offset:6144
    ds_read_b64_tr_b16 v[134:135], v102 offset:7680
    s_waitcnt lgkmcnt(8)
    v_mfma_f32_32x32x16_bf16 v[192:207], v[120:123], v[136:139], v[192:207]
    v_mfma_f32_32x32x16_bf16 v[240:255], v[120:123], v[140:143], v[240:255]
    s_cmp_lg_u32 s57, 4
    s_cbranch_scc1 L_cs_23
    v_dot2c_f32_bf16 v92, s52, v112
    v_dot2c_f32_bf16 v92, s52, v113
    v_dot2c_f32_bf16 v92, s52, v114
    v_dot2c_f32_bf16 v92, s52, v115
    v_dot2c_f32_bf16 v93, s52, v116
    v_dot2c_f32_bf16 v93, s52, v117
    v_dot2c_f32_bf16 v93, s52, v118
    v_dot2c_f32_bf16 v93, s52, v119
    v_dot2c_f32_bf16 v94, s52, v120
    v_dot2c_f32_bf16 v94, s52, v121
    v_dot2c_f32_bf16 v94, s52, v122
    v_dot2c_f32_bf16 v94, s52, v123
L_cs_23:
    s_waitcnt vmcnt(9) lgkmcnt(0)
    s_barrier
    v_mfma_f32_32x32x16_bf16 v[160:175], v[124:127], v[144:147], v[160:175]
    ds_read_b128 v[136:139], v106 offset:16384
    ds_read_b128 v[140:143], v106 offset:20480
    s_add_u32 m0, s26, 0
    s_nop 0
    buffer_load_dwordx4 v108, s[4:7], s24 offen offset:0 lds
    v_mfma_f32_32x32x16_bf16 v[208:223], v[124:127], v[148:151], v[208:223]
    ds_read_b64_tr_b16 v[112:113], v100 offset:24832
    ds_read_b64_tr_b16 v[114:115], v100 offset:26368
    buffer_load_dwordx4 v109, s[4:7], s24 offen offset:1024 lds
    v_mfma_f32_32x32x16_bf16 v[176:191], v[128:131], v[144:147], v[176:191]
    ds_read_b64_tr_b16 v[116:117], v101 offset:24832
    ds_read_b64_tr_b16 v[118:119], v101 offset:26368
    s_cmp_lg_u32 s57, 3
    s_cbranch_scc1 L_pub3_3_24
    v_mov_b32 v9, v92
    s_nop 1
    v_permlane32_swap_b32 v92, v9
    s_nop 1
    v_add_f32 v9, v9, v92
    v_or_b32 v12, 1, v9
    v_mov_b32 v9, v93
    s_nop 1
    v_permlane32_swap_b32 v93, v9
    s_nop 1
    v_add_f32 v9, v9, v93
    v_or_b32 v13, 1, v9
    v_mov_b32 v9, v94
    s_nop 1
    v_permlane32_swap_b32 v94, v9
    s_nop 1
    v_add_f32 v9, v9, v94
    v_or_b32 v14, 1, v9
    v_and_b32 v6, 31, v1
    v_lshlrev_b32 v6, 4, v6
    buffer_store_dwordx3 v[12:14], v6, s[12:15], s27 offen sc1
L_pub3_3_24:
    v_mfma_f32_32x32x16_bf16 v[224:239], v[128:131], v[148:151], v[224:239]
    ds_read_b64_tr_b16 v[120:121], v102 offset:24832
    ds_read_b64_tr_b16 v[122:123], v102 offset:26368
    v_mfma_f32_32x32x16_bf16 v[192:207], v[132:135], v[144:147], v[192:207]
    v_mfma_f32_32x32x16_bf16 v[240:255], v[132:135], v[148:151], v[240:255]
    s_cmp_lg_u32 s57, 4
    s_cbranch_scc1 L_cs_25
    v_dot2c_f32_bf16 v92, s52, v124
    v_dot2c_f32_bf16 v92, s52, v125
    v_dot2c_f32_bf16 v92, s52, v126
    v_dot2c_f32_bf16 v92, s52, v127
    v_dot2c_f32_bf16 v93, s52, v128
    v_dot2c_f32_bf16 v93, s52, v129
    v_dot2c_f32_bf16 v93, s52, v130
    v_dot2c_f32_bf16 v93, s52, v131
    v_dot2c_f32_bf16 v94, s52, v132
    v_dot2c_f32_bf16 v94, s52, v133
    v_dot2c_f32_bf16 v94, s52, v134
    v_dot2c_f32_bf16 v94, s52, v135
L_cs_25:
    s_waitcnt lgkmcnt(4)
    v_mfma_f32_32x32x16_bf16 v[160:175], v[112:115], v[136:139], v[160:175]
    ds_read_b128 v[144:147], v107 offset:16384
    ds_read_b128 v[148:151], v107 offset:20480
    s_add_u32 m0, s26, 0
    s_nop 0
    buffer_load_dwordx4 v110, s[4:7], s24 offen offset:2048 lds
    s_add_u32 s24, s24, s25
    v_mfma_f32_32x32x16_bf16 v[208:223], v[112:115], v[140:143], v[208:223]
    ds_read_b64_tr_b16 v[124:125], v100 offset:30976
    ds_read_b64_tr_b16 v[126:127], v100 offset:32512
    s_add_u32 m0, s28, 1024
    s_nop 0
    buffer_load_dwordx4 v99, s[8:11], s53 offen lds
    s_waitcnt lgkmcnt(6)
    v_mfma_f32_32x32x16_bf16 v[176:191], v[116:119], v[136:139], v[176:191]
    ds_read_b64_tr_b16 v[128:129], v101 offset:30976
    ds_read_b64_tr_b16 v[130:131], v101 offset:32512
    s_cmp_eq_u32 s29, 7
    s_cselect_b32 s49, -1152, s54
    s_add_u32 s53, s53, s49
    v_mfma_f32_32x32x16_bf16 v[224:239], v[116:119], v[140:143], v[224:239]
    ds_read_b64_tr_b16 v[132:133], v102 offset:30976
    ds_read_b64_tr_b16 v[134:135], v102 offset:32512
    s_waitcnt lgkmcnt(8)
    v_mfma_f32_32x32x16_bf16 v[192:207], v[120:123], v[136:139], v[192:207]
    v_mfma_f32_32x32x16_bf16 v[240:255], v[120:123], v[140:143], v[240:255]
    s_cmp_lg_u32 s57, 4
    s_cbranch_scc1 L_cs_26
    v_dot2c_f32_bf16 v92, s52, v112
    v_dot2c_f32_bf16 v92, s52, v113
    v_dot2c_f32_bf16 v92, s52, v114
    v_dot2c_f32_bf16 v92, s52, v115
    v_dot2c_f32_bf16 v93, s52, v116
    v_dot2c_f32_bf16 v93, s52, v117
    v_dot2c_f32_bf16 v93, s52, v118
    v_dot2c_f32_bf16 v93, s52, v119
    v_dot2c_f32_bf16 v94, s52, v120
    v_dot2c_f32_bf16 v94, s52, v121
    v_dot2c_f32_bf16 v94, s52, v122
    v_dot2c_f32_bf16 v94, s52, v123
L_cs_26:
    s_waitcnt vmcnt(8) lgkmcnt(0)
    s_barrier
    v_mfma_f32_32x32x16_bf16 v[160:175], v[124:127], v[144:147], v[160:175]
    ds_read_b128 v[136:139], v104 offset:32768
    ds_read_b128 v[140:143], v104 offset:36864
    s_add_u32 m0, s26, 24832
    s_nop 0
    buffer_load_dwordx4 v108, s[4:7], s24 offen offset:0 lds
    v_mfma_f32_32x32x16_bf16 v[208:223], v[124:127], v[148:151], v[208:223]
    ds_read_b64_tr_b16 v[112:113], v152 offset:0
    ds_read_b64_tr_b16 v[114:115], v152 offset:1536
    buffer_load_dwordx4 v109, s[4:7], s24 offen offset:1024 lds
    v_mfma_f32_32x32x16_bf16 v[176:191], v[128:131], v[144:147], v[176:191]
    ds_read_b64_tr_b16 v[116:117], v153 offset:0
    ds_read_b64_tr_b16 v[118:119], v153 offset:1536
    v_mfma_f32_32x32x16_bf16 v[224:239], v[128:131], v[148:151], v[224:239]
    ds_read_b64_tr_b16 v[120:121], v154 offset:0
    ds_read_b64_tr_b16 v[122:123], v154 offset:1536
    v_mfma_f32_32x32x16_bf16 v[192:207], v[132:135], v[144:147], v[192:207]
    v_mfma_f32_32x32x16_bf16 v[240:255], v[132:135], v[148:151], v[240:255]
    s_cmp_lg_u32 s57, 4
    s_cbranch_scc1 L_cs_27
    v_dot2c_f32_bf16 v92, s52, v124
    v_dot2c_f32_bf16 v92, s52, v125
    v_dot2c_f32_bf16 v92, s52, v126
    v_dot2c_f32_bf16 v92, s52, v127
    v_dot2c_f32_bf16 v93, s52, v128
    v_dot2c_f32_bf16 v93, s52, v129
    v_dot2c_f32_bf16 v93, s52, v130
    v_dot2c_f32_bf16 v93, s52, v131
    v_dot2c_f32_bf16 v94, s52, v132
    v_dot2c_f32_bf16 v94, s52, v133
    v_dot2c_f32_bf16 v94, s52, v134
    v_dot2c_f32_bf16 v94, s52, v135
L_cs_27:
    s_waitcnt lgkmcnt(4)
    v_mfma_f32_32x32x16_bf16 v[160:175], v[112:115], v[136:139], v[160:175]
    ds_read_b128 v[144:147], v105 offset:32768
    ds_read_b128 v[148:151], v105 offset:36864
    s_add_u32 m0, s26, 24832
    s_nop 0
    buffer_load_dwordx4 v110, s[4:7], s24 offen offset:2048 lds
    s_cmp_eq_u32 s29, 7
    s_cselect_b32 s49, s48, s25
    s_add_u32 s24, s24, s49
    v_mfma_f32_32x32x16_bf16 v[208:223], v[112:115], v[140:143], v[208:223]
    ds_read_b64_tr_b16 v[124:125], v152 offset:6144
    ds_read_b64_tr_b16 v[126:127], v152 offset:7680
    s_add_u32 m0, s28, 16384
    s_nop 0
    buffer_load_dwordx4 v98, s[8:11], s53 offen lds
    s_waitcnt lgkmcnt(6)
    v_mfma_f32_32x32x16_bf16 v[176:191], v[116:119], v[136:139], v[176:191]
    ds_read_b64_tr_b16 v[128:129], v153 offset:6144
    ds_read_b64_tr_b16 v[130:131], v153 offset:7680
    v_mfma_f32_32x32x16_bf16 v[224:239], v[116:119], v[140:143], v[224:239]
    ds_read_b64_tr_b16 v[132:133], v154 offset:6144
    ds_read_b64_tr_b16 v[134:135], v154 offset:7680
    s_waitcnt lgkmcnt(8)
    v_mfma_f32_32x32x16_bf16 v[192:207], v[120:123], v[136:139], v[192:207]
    v_mfma_f32_32x32x16_bf16 v[240:255], v[120:123], v[140:143], v[240:255]
    s_waitcnt vmcnt(9) lgkmcnt(0)
    s_barrier
    v_mfma_f32_32x32x16_bf16 v[160:175], v[124:127], v[144:147], v[160:175]
    ds_read_b128 v[136:139], v106 offset:32768
    ds_read_b128 v[140:143], v106 offset:36864
    s_add_u32 m0, s26, 49664
    s_nop 0
    buffer_load_dwordx4 v108, s[4:7], s24 offen offset:0 lds
    v_mfma_f32_32x32x16_bf16 v[208:223], v[124:127], v[148:151], v[208:223]
    ds_read_b64_tr_b16 v[112:113], v152 offset:24832
    ds_read_b64_tr_b16 v[114:115], v152 offset:26368
    buffer_load_dwordx4 v109, s[4:7], s24 offen offset:1024 lds
    v_mfma_f32_32x32x16_bf16 v[176:191], v[128:131], v[144:147], v[176:191]
    ds_read_b64_tr_b16 v[116:117], v153 offset:24832
    ds_read_b64_tr_b16 v[118:119], v153 offset:26368
    s_cmp_lg_u32 s57, 4
    s_cbranch_scc1 L_pub3_4_28
    v_mov_b32 v9, v92
    s_nop 1
    v_permlane32_swap_b32 v92, v9
    s_nop 1
    v_add_f32 v9, v9, v92
    v_or_b32 v12, 1, v9
    v_mov_b32 v9, v93
    s_nop 1
    v_permlane32_swap_b32 v93, v9
    s_nop 1
    v_add_f32 v9, v9, v93
    v_or_b32 v13, 1, v9
    v_mov_b32 v9, v94
    s_nop 1
    v_permlane32_swap_b32 v94, v9
    s_nop 1
    v_add_f32 v9, v9, v94
    v_or_b32 v14, 1, v9
    v_and_b32 v6, 31, v1
    v_lshlrev_b32 v6, 4, v6
    buffer_store_dwordx3 v[12:14], v6, s[12:15], s27 offen sc1
L_pub3_4_28:
    v_mfma_f32_32x32x16_bf16 v[224:239], v[128:131], v[148:151], v[224:239]
    ds_read_b64_tr_b16 v[120:121], v154 offset:24832
    ds_read_b64_tr_b16 v[122:123], v154 offset:26368
    s_cmp_lg_u32 s3, 0
    s_cbranch_scc1 L_ci3
    v_lshlrev_b32 v6, 6, v1
    buffer_load_dword v52, v6, s[16:19], 0 offen sc1
L_ci3:
    v_mfma_f32_32x32x16_bf16 v[192:207], v[132:135], v[144:147], v[192:207]
    v_mfma_f32_32x32x16_bf16 v[240:255], v[132:135], v[148:151], v[240:255]
    s_waitcnt lgkmcnt(4)
    v_mfma_f32_32x32x16_bf16 v[160:175], v[112:115], v[136:139], v[160:175]
    ds_read_b128 v[144:147], v107 offset:32768
    ds_read_b128 v[148:151], v107 offset:36864
    s_add_u32 m0, s26, 49664
    s_nop 0
    buffer_load_dwordx4 v110, s[4:7], s24 offen offset:2048 lds
    s_add_u32 s24, s24, s25
    v_mfma_f32_32x32x16_bf16 v[208:223], v[112:115], v[140:143], v[208:223]
    ds_read_b64_tr_b16 v[124:125], v152 offset:30976
    ds_read_b64_tr_b16 v[126:127], v152 offset:32512
    s_add_u32 m0, s28, 17408
    s_nop 0
    buffer_load_dwordx4 v99, s[8:11], s53 offen lds
    s_waitcnt lgkmcnt(6)
    v_mfma_f32_32x32x16_bf16 v[176:191], v[116:119], v[136:139], v[176:191]
    ds_read_b64_tr_b16 v[128:129], v153 offset:30976
    ds_read_b64_tr_b16 v[130:131], v153 offset:32512
    s_cmp_eq_u32 s29, 8
    s_cselect_b32 s49, -1152, s54
    s_add_u32 s53, s53, s49
    v_mfma_f32_32x32x16_bf16 v[224:239], v[116:119], v[140:143], v[224:239]
    ds_read_b64_tr_b16 v[132:133], v154 offset:30976
    ds_read_b64_tr_b16 v[134:135], v154 offset:32512
    s_waitcnt lgkmcnt(8)
    v_mfma_f32_32x32x16_bf16 v[192:207], v[120:123], v[136:139], v[192:207]
    v_mfma_f32_32x32x16_bf16 v[240:255], v[120:123], v[140:143], v[240:255]
    s_waitcnt vmcnt(8) lgkmcnt(0)
    s_barrier
    v_mfma_f32_32x32x16_bf16 v[160:175], v[124:127], v[144:147], v[160:175]
    ds_read_b128 v[136:139], v104 offset:0
    ds_read_b128 v[140:143], v104 offset:4096
    s_add_u32 m0, s26, 74496
    s_nop 0
    buffer_load_dwordx4 v108, s[4:7], s24 offen offset:0 lds
    v_mfma_f32_32x32x16_bf16 v[208:223], v[124:127], v[148:151], v[208:223]
    ds_read_b64_tr_b16 v[112:113], v100 offset:0
    ds_read_b64_tr_b16 v[114:115], v100 offset:1536
    buffer_load_dwordx4 v109, s[4:7], s24 offen offset:1024 lds
    v_mfma_f32_32x32x16_bf16 v[176:191], v[128:131], v[144:147], v[176:191]
    ds_read_b64_tr_b16 v[116:117], v101 offset:0
    ds_read_b64_tr_b16 v[118:119], v101 offset:1536
    v_mfma_f32_32x32x16_bf16 v[224:239], v[128:131], v[148:151], v[224:239]
    ds_read_b64_tr_b16 v[120:121], v102 offset:0
    ds_read_b64_tr_b16 v[122:123], v102 offset:1536
    v_mfma_f32_32x32x16_bf16 v[192:207], v[132:135], v[144:147], v[192:207]
    v_mfma_f32_32x32x16_bf16 v[240:255], v[132:135], v[148:151], v[240:255]
    s_waitcnt lgkmcnt(4)
    v_mfma_f32_32x32x16_bf16 v[160:175], v[112:115], v[136:139], v[160:175]
    ds_read_b128 v[144:147], v105 offset:0
    ds_read_b128 v[148:151], v105 offset:4096
    s_add_u32 m0, s26, 74496
    s_nop 0
    buffer_load_dwordx4 v110, s[4:7], s24 offen offset:2048 lds
    s_cmp_eq_u32 s29, 8
    s_cselect_b32 s49, s48, s25
    s_add_u32 s24, s24, s49
    v_mfma_f32_32x32x16_bf16 v[208:223], v[112:115], v[140:143], v[208:223]
    ds_read_b64_tr_b16 v[124:125], v100 offset:6144
    ds_read_b64_tr_b16 v[126:127], v100 offset:7680
    s_add_u32 m0, s28, 32768
    s_nop 0
    buffer_load_dwordx4 v98, s[8:11], s53 offen lds
    s_waitcnt lgkmcnt(6)
    v_mfma_f32_32x32x16_bf16 v[176:191], v[116:119], v[136:139], v[176:191]
    ds_read_b64_tr_b16 v[128:129], v101 offset:6144
    ds_read_b64_tr_b16 v[130:131], v101 offset:7680
    s_cmp_lg_u32 s3, 0
    s_cbranch_scc1 L_cc3
    s_waitcnt vmcnt(6)
    v_cmp_le_u32 s[68:69], 64, v52
    s_nop 1
    s_and_b32 s34, s68, 15
    s_cmp_eq_u32 s34, 15
    s_cbranch_scc0 L_cnt3_slow
L_cnt3_ok:
    v_lshlrev_b32 v6, 7, v1
    v_add_u32 v6, 17203200, v6
    buffer_load_dword v52, v6, s[12:15], 0 offen sc1
L_cc3:
    v_mfma_f32_32x32x16_bf16 v[224:239], v[116:119], v[140:143], v[224:239]
    ds_read_b64_tr_b16 v[132:133], v102 offset:6144
    ds_read_b64_tr_b16 v[134:135], v102 offset:7680
    s_waitcnt lgkmcnt(8)
    v_mfma_f32_32x32x16_bf16 v[192:207], v[120:123], v[136:139], v[192:207]
    v_mfma_f32_32x32x16_bf16 v[240:255], v[120:123], v[140:143], v[240:255]
    s_waitcnt vmcnt(9) lgkmcnt(0)
    s_barrier
    v_mfma_f32_32x32x16_bf16 v[160:175], v[124:127], v[144:147], v[160:175]
    ds_read_b128 v[136:139], v106 offset:0
    ds_read_b128 v[140:143], v106 offset:4096
    s_add_u32 m0, s26, 0
    s_nop 0
    buffer_load_dwordx4 v108, s[4:7], s24 offen offset:0 lds
    buffer_load_dwordx4 v109, s[4:7], s24 offen offset:1024 lds
    v_and_b32 v54, 31, v1
    v_mfma_f32_32x32x16_bf16 v[208:223], v[124:127], v[148:151], v[208:223]
    ds_read_b64_tr_b16 v[112:113], v100 offset:24832
    ds_read_b64_tr_b16 v[114:115], v100 offset:26368
    s_lshl_b32 s34, s20, 7
    s_lshl_b32 s35, s50, 6
    s_add_u32 s34, s34, s35
    v_mfma_f32_32x32x16_bf16 v[176:191], v[128:131], v[144:147], v[176:191]
    ds_read_b64_tr_b16 v[116:117], v101 offset:24832
    ds_read_b64_tr_b16 v[118:119], v101 offset:26368
    v_add_u32 v55, s34, v54
    v_lshlrev_b32 v55, 3, v55
    v_add_u32 v55, 16777216, v55
    v_mfma_f32_32x32x16_bf16 v[224:239], v[128:131], v[148:151], v[224:239]
    ds_read_b64_tr_b16 v[120:121], v102 offset:24832
    ds_read_b64_tr_b16 v[122:123], v102 offset:26368
    v_lshlrev_b32 v54, 4, v54
    v_lshrrev_b32 v10, 5, v1
    v_lshl_add_u32 v54, v10, 11, v54
    v_mfma_f32_32x32x16_bf16 v[192:207], v[132:135], v[144:147], v[192:207]
    s_mul_i32 s34, s21, 40
    s_lshr_b32 s35, s3, 1
    s_add_u32 s34, s34, s35
    v_mfma_f32_32x32x16_bf16 v[240:255], v[132:135], v[148:151], v[240:255]
    s_lshl_b32 s34, s34, 9
    s_add_u32 s38, s34, 18874368
    s_waitcnt lgkmcnt(4)
    v_mfma_f32_32x32x16_bf16 v[160:175], v[112:115], v[136:139], v[160:175]
    ds_read_b128 v[144:147], v107 offset:0
    ds_read_b128 v[148:151], v107 offset:4096
    s_add_u32 m0, s26, 0
    s_nop 0
    buffer_load_dwordx4 v110, s[4:7], s24 offen offset:2048 lds
    s_add_u32 s24, s24, s25
    v_mfma_f32_32x32x16_bf16 v[208:223], v[112:115], v[140:143], v[208:223]
    ds_read_b64_tr_b16 v[124:125], v100 offset:30976
    ds_read_b64_tr_b16 v[126:127], v100 offset:32512
    s_add_u32 m0, s28, 33792
    s_nop 0
    buffer_load_dwordx4 v99, s[8:11], s53 offen lds
    s_waitcnt lgkmcnt(6)
    v_mfma_f32_32x32x16_bf16 v[176:191], v[116:119], v[136:139], v[176:191]
    ds_read_b64_tr_b16 v[128:129], v101 offset:30976
    ds_read_b64_tr_b16 v[130:131], v101 offset:32512
    s_cmp_eq_u32 s29, 9
    s_cselect_b32 s49, -1152, s54
    s_add_u32 s53, s53, s49
    v_mfma_f32_32x32x16_bf16 v[224:239], v[116:119], v[140:143], v[224:239]
    ds_read_b64_tr_b16 v[132:133], v102 offset:30976
    ds_read_b64_tr_b16 v[134:135], v102 offset:32512
    buffer_load_dwordx2 v[2:3], v55, s[12:15], 0 offen sc1
    s_waitcnt lgkmcnt(8)
    v_mfma_f32_32x32x16_bf16 v[192:207], v[120:123], v[136:139], v[192:207]
    buffer_load_dwordx2 v[4:5], v55, s[12:15], 0 offen offset:256 sc1
    v_mfma_f32_32x32x16_bf16 v[240:255], v[120:123], v[140:143], v[240:255]
    buffer_load_dwordx4 v[32:35], v54, s[12:15], s38 offen sc1
    s_add_u32 s38, s38, 4096
    s_waitcnt vmcnt(11) lgkmcnt(0)
    s_barrier
    v_mfma_f32_32x32x16_bf16 v[160:175], v[124:127], v[144:147], v[160:175]
    ds_read_b128 v[136:139], v104 offset:16384
    ds_read_b128 v[140:143], v104 offset:20480
    s_add_u32 m0, s26, 24832
    s_nop 0
    buffer_load_dwordx4 v108, s[4:7], s24 offen offset:0 lds
    v_mfma_f32_32x32x16_bf16 v[208:223], v[124:127], v[148:151], v[208:223]
    ds_read_b64_tr_b16 v[112:113], v152 offset:0
    ds_read_b64_tr_b16 v[114:115], v152 offset:1536
    buffer_load_dwordx4 v109, s[4:7], s24 offen offset:1024 lds
    v_mfma_f32_32x32x16_bf16 v[176:191], v[128:131], v[144:147], v[176:191]
    ds_read_b64_tr_b16 v[116:117], v153 offset:0
    ds_read_b64_tr_b16 v[118:119], v153 offset:1536
    v_mfma_f32_32x32x16_bf16 v[224:239], v[128:131], v[148:151], v[224:239]
    ds_read_b64_tr_b16 v[120:121], v154 offset:0
    ds_read_b64_tr_b16 v[122:123], v154 offset:1536
    v_mfma_f32_32x32x16_bf16 v[192:207], v[132:135], v[144:147], v[192:207]
    v_mfma_f32_32x32x16_bf16 v[240:255], v[132:135], v[148:151], v[240:255]
    s_waitcnt lgkmcnt(4)
    v_mfma_f32_32x32x16_bf16 v[160:175], v[112:115], v[136:139], v[160:175]
    ds_read_b128 v[144:147], v105 offset:16384
    ds_read_b128 v[148:151], v105 offset:20480
    s_add_u32 m0, s26, 24832
    s_nop 0
    buffer_load_dwordx4 v110, s[4:7], s24 offen offset:2048 lds
    s_cmp_eq_u32 s29, 9
    s_cselect_b32 s49, s48, s25
    s_add_u32 s24, s24, s49
    v_mfma_f32_32x32x16_bf16 v[208:223], v[112:115], v[140:143], v[208:223]
    ds_read_b64_tr_b16 v[124:125], v152 offset:6144
    ds_read_b64_tr_b16 v[126:127], v152 offset:7680
    s_add_u32 m0, s28, 0
    s_nop 0
    buffer_load_dwordx4 v98, s[8:11], s53 offen lds
    s_waitcnt lgkmcnt(6)
    v_mfma_f32_32x32x16_bf16 v[176:191], v[116:119], v[136:139], v[176:191]
    ds_read_b64_tr_b16 v[128:129], v153 offset:6144
    ds_read_b64_tr_b16 v[130:131], v153 offset:7680
    buffer_load_dwordx4 v[36:39], v54, s[12:15], s38 offen sc1
    s_add_u32 s38, s38, 4096
    v_mfma_f32_32x32x16_bf16 v[224:239], v[116:119], v[140:143], v[224:239]
    ds_read_b64_tr_b16 v[132:133], v154 offset:6144
    ds_read_b64_tr_b16 v[134:135], v154 offset:7680
    buffer_load_dwordx4 v[40:43], v54, s[12:15], s38 offen sc1
    s_add_u32 s38, s38, 4096
    s_waitcnt lgkmcnt(8)
    v_mfma_f32_32x32x16_bf16 v[192:207], v[120:123], v[136:139], v[192:207]
    v_mfma_f32_32x32x16_bf16 v[240:255], v[120:123], v[140:143], v[240:255]
    s_waitcnt vmcnt(14) lgkmcnt(0)
    s_barrier
    v_mfma_f32_32x32x16_bf16 v[160:175], v[124:127], v[144:147], v[160:175]
    ds_read_b128 v[136:139], v106 offset:16384
    ds_read_b128 v[140:143], v106 offset:20480
    s_add_u32 m0, s26, 49664
    s_nop 0
    buffer_load_dwordx4 v108, s[4:7], s24 offen offset:0 lds
    v_mfma_f32_32x32x16_bf16 v[208:223], v[124:127], v[148:151], v[208:223]
    ds_read_b64_tr_b16 v[112:113], v152 offset:24832
    ds_read_b64_tr_b16 v[114:115], v152 offset:26368
    buffer_load_dwordx4 v109, s[4:7], s24 offen offset:1024 lds
    v_mfma_f32_32x32x16_bf16 v[176:191], v[128:131], v[144:147], v[176:191]
    ds_read_b64_tr_b16 v[116:117], v153 offset:24832
    ds_read_b64_tr_b16 v[118:119], v153 offset:26368
    s_mov_b64 exec, 3
    global_load_dword v88, v[86:87], off
    s_mov_b64 exec, -1
    v_mfma_f32_32x32x16_bf16 v[224:239], v[128:131], v[148:151], v[224:239]
    ds_read_b64_tr_b16 v[120:121], v154 offset:24832
    ds_read_b64_tr_b16 v[122:123], v154 offset:26368
    v_mfma_f32_32x32x16_bf16 v[192:207], v[132:135], v[144:147], v[192:207]
    v_mfma_f32_32x32x16_bf16 v[240:255], v[132:135], v[148:151], v[240:255]
    s_waitcnt lgkmcnt(4)
    v_mfma_f32_32x32x16_bf16 v[160:175], v[112:115], v[136:139], v[160:175]
    ds_read_b128 v[144:147], v107 offset:16384
    ds_read_b128 v[148:151], v107 offset:20480
    s_add_u32 m0, s26, 49664
    s_nop 0
    buffer_load_dwordx4 v110, s[4:7], s24 offen offset:2048 lds
    s_add_u32 s24, s24, s25
    v_mfma_f32_32x32x16_bf16 v[208:223], v[112:115], v[140:143], v[208:223]
    ds_read_b64_tr_b16 v[124:125], v152 offset:30976
    ds_read_b64_tr_b16 v[126:127], v152 offset:32512
    s_add_u32 m0, s28, 1024
    s_nop 0
    buffer_load_dwordx4 v99, s[8:11], s53 offen lds
    s_waitcnt lgkmcnt(6)
    v_mfma_f32_32x32x16_bf16 v[176:191], v[116:119], v[136:139], v[176:191]
    ds_read_b64_tr_b16 v[128:129], v153 offset:30976
    ds_read_b64_tr_b16 v[130:131], v153 offset:32512
    s_add_u32 s53, s53, s54
    v_mfma_f32_32x32x16_bf16 v[224:239], v[116:119], v[140:143], v[224:239]
    ds_read_b64_tr_b16 v[132:133], v154 offset:30976
    ds_read_b64_tr_b16 v[134:135], v154 offset:32512
    buffer_load_dwordx4 v[44:47], v54, s[12:15], s38 offen sc1
    s_add_u32 s38, s38, 4096
    s_waitcnt lgkmcnt(8)
    v_mfma_f32_32x32x16_bf16 v[192:207], v[120:123], v[136:139], v[192:207]
    buffer_load_dwordx4 v[48:51], v54, s[12:15], s38 offen sc1
    v_mfma_f32_32x32x16_bf16 v[240:255], v[120:123], v[140:143], v[240:255]
    s_cmp_lg_u32 s3, 0
    s_cbranch_scc1 L_fc3
    s_waitcnt vmcnt(20)
    v_cmp_ne_u32 s[68:69], 0, v52
    s_mov_b32 s34, 0xf01fc07f
    s_mov_b32 s35, 0xfe07
    s_and_b64 s[68:69], s[68:69], s[34:35]
    s_cmp_eq_u64 s[68:69], s[34:35]
    s_cbranch_scc0 L_fw3_slow
L_fw3_ok:
L_fc3:
    s_waitcnt vmcnt(16) lgkmcnt(0)
    s_barrier
    v_mfma_f32_32x32x16_bf16 v[160:175], v[124:127], v[144:147], v[160:175]
    ds_read_b128 v[136:139], v104 offset:32768
    ds_read_b128 v[140:143], v104 offset:36864
    s_add_u32 m0, s26, 74496
    s_nop 0
    buffer_load_dwordx4 v108, s[4:7], s24 offen offset:0 lds
    v_mfma_f32_32x32x16_bf16 v[208:223], v[124:127], v[148:151], v[208:223]
    ds_read_b64_tr_b16 v[112:113], v100 offset:0
    ds_read_b64_tr_b16 v[114:115], v100 offset:1536
    buffer_load_dwordx4 v109, s[4:7], s24 offen offset:1024 lds
    v_mfma_f32_32x32x16_bf16 v[176:191], v[128:131], v[144:147], v[176:191]
    ds_read_b64_tr_b16 v[116:117], v101 offset:0
    ds_read_b64_tr_b16 v[118:119], v101 offset:1536
    v_mfma_f32_32x32x16_bf16 v[224:239], v[128:131], v[148:151], v[224:239]
    ds_read_b64_tr_b16 v[120:121], v102 offset:0
    ds_read_b64_tr_b16 v[122:123], v102 offset:1536
    v_mfma_f32_32x32x16_bf16 v[192:207], v[132:135], v[144:147], v[192:207]
    v_mfma_f32_32x32x16_bf16 v[240:255], v[132:135], v[148:151], v[240:255]
    s_waitcnt lgkmcnt(4)
    v_mfma_f32_32x32x16_bf16 v[160:175], v[112:115], v[136:139], v[160:175]
    ds_read_b128 v[144:147], v105 offset:32768
    ds_read_b128 v[148:151], v105 offset:36864
    s_add_u32 m0, s26, 74496
    s_nop 0
    buffer_load_dwordx4 v110, s[4:7], s24 offen offset:2048 lds
    s_add_u32 s24, s24, s25
    v_mfma_f32_32x32x16_bf16 v[208:223], v[112:115], v[140:143], v[208:223]
    ds_read_b64_tr_b16 v[124:125], v100 offset:6144
    ds_read_b64_tr_b16 v[126:127], v100 offset:7680
    s_mov_b32 s53, s56
    s_mov_b32 s54, 4096
    s_waitcnt lgkmcnt(6)
    v_mfma_f32_32x32x16_bf16 v[176:191], v[116:119], v[136:139], v[176:191]
    ds_read_b64_tr_b16 v[128:129], v101 offset:6144
    ds_read_b64_tr_b16 v[130:131], v101 offset:7680
    s_mov_b32 s8, s12
    s_mov_b32 s9, s13
    s_mov_b32 s10, s14
    v_mfma_f32_32x32x16_bf16 v[224:239], v[116:119], v[140:143], v[224:239]
    ds_read_b64_tr_b16 v[132:133], v102 offset:6144
    ds_read_b64_tr_b16 v[134:135], v102 offset:7680
    v_mov_b32 v98, v155
    v_add_u32 v99, 1024, v155
    s_waitcnt lgkmcnt(8)
    v_mfma_f32_32x32x16_bf16 v[192:207], v[120:123], v[136:139], v[192:207]
    s_cmp_eq_u32 s22, 2
    s_cbranch_scc1 L_nx3_10_0
    s_add_u32 m0, s28, 16384
    s_nop 0
    buffer_load_dwordx4 v98, s[8:11], s53 offen lds
L_nx3_10_0:
    v_mfma_f32_32x32x16_bf16 v[240:255], v[120:123], v[140:143], v[240:255]
    s_waitcnt vmcnt(13) lgkmcnt(0)
    s_barrier
    v_mfma_f32_32x32x16_bf16 v[160:175], v[124:127], v[144:147], v[160:175]
    ds_read_b128 v[136:139], v106 offset:32768
    ds_read_b128 v[140:143], v106 offset:36864
    s_mov_b32 s24, s55
    s_mov_b32 s25, 6144
    s_mov_b32 s4, s12
    s_mov_b32 s5, s13
    s_mov_b32 s6, s14
    v_mfma_f32_32x32x16_bf16 v[208:223], v[124:127], v[148:151], v[208:223]
    ds_read_b64_tr_b16 v[112:113], v100 offset:24832
    ds_read_b64_tr_b16 v[114:115], v100 offset:26368
    v_mov_b32 v108, v155
    v_mov_b32 v109, v155
    v_mov_b32 v110, v155
    s_add_u32 m0, s26, 0
    s_nop 0
    buffer_load_dwordx4 v108, s[4:7], s24 offen offset:0 lds
    v_mfma_f32_32x32x16_bf16 v[176:191], v[128:131], v[144:147], v[176:191]
    ds_read_b64_tr_b16 v[116:117], v101 offset:24832
    ds_read_b64_tr_b16 v[118:119], v101 offset:26368
    buffer_load_dwordx4 v109, s[4:7], s24 offen offset:1024 lds
    v_mfma_f32_32x32x16_bf16 v[224:239], v[128:131], v[148:151], v[224:239]
    ds_read_b64_tr_b16 v[120:121], v102 offset:24832
    ds_read_b64_tr_b16 v[122:123], v102 offset:26368
    buffer_load_dwordx4 v110, s[4:7], s24 offen offset:2048 lds
    s_add_u32 s24, s24, s25
    v_mfma_f32_32x32x16_bf16 v[192:207], v[132:135], v[144:147], v[192:207]
    s_cmp_eq_u32 s22, 2
    s_cbranch_scc1 L_nx3_10_1
    s_add_u32 m0, s28, 17408
    s_nop 0
    buffer_load_dwordx4 v99, s[8:11], s53 offen lds
L_nx3_10_1:
    v_mfma_f32_32x32x16_bf16 v[240:255], v[132:135], v[148:151], v[240:255]
    s_add_u32 s53, s53, s54
    s_waitcnt lgkmcnt(4)
    v_mfma_f32_32x32x16_bf16 v[160:175], v[112:115], v[136:139], v[160:175]
    ds_read_b128 v[144:147], v107 offset:32768
    ds_read_b128 v[148:151], v107 offset:36864
    v_mfma_f32_32x32x16_bf16 v[208:223], v[112:115], v[140:143], v[208:223]
    ds_read_b64_tr_b16 v[124:125], v100 offset:30976
    ds_read_b64_tr_b16 v[126:127], v100 offset:32512
    s_waitcnt lgkmcnt(6)
    v_mfma_f32_32x32x16_bf16 v[176:191], v[116:119], v[136:139], v[176:191]
    ds_read_b64_tr_b16 v[128:129], v101 offset:30976
    ds_read_b64_tr_b16 v[130:131], v101 offset:32512
    v_mfma_f32_32x32x16_bf16 v[224:239], v[116:119], v[140:143], v[224:239]
    ds_read_b64_tr_b16 v[132:133], v102 offset:30976
    ds_read_b64_tr_b16 v[134:135], v102 offset:32512
    s_waitcnt lgkmcnt(8)
    v_mfma_f32_32x32x16_bf16 v[192:207], v[120:123], v[136:139], v[192:207]
    v_mfma_f32_32x32x16_bf16 v[240:255], v[120:123], v[140:143], v[240:255]
    s_waitcnt vmcnt(6) lgkmcnt(0)
    s_barrier
    v_mfma_f32_32x32x16_bf16 v[160:175], v[124:127], v[144:147], v[160:175]
    ds_read_b128 v[136:139], v104 offset:0
    ds_read_b128 v[140:143], v104 offset:4096
    s_add_u32 m0, s26, 24832
    s_nop 0
    buffer_load_dwordx4 v108, s[4:7], s24 offen offset:0 lds
    buffer_load_dwordx4 v109, s[4:7], s24 offen offset:1024 lds
    buffer_load_dwordx4 v110, s[4:7], s24 offen offset:2048 lds
    s_add_u32 s24, s24, s25
    v_mfma_f32_32x32x16_bf16 v[208:223], v[124:127], v[148:151], v[208:223]
    ds_read_b64_tr_b16 v[112:113], v152 offset:0
    ds_read_b64_tr_b16 v[114:115], v152 offset:1536
    s_cmp_eq_u32 s22, 2
    s_cbranch_scc1 L_nx3_11_0
    s_add_u32 m0, s28, 32768
    s_nop 0
    buffer_load_dwordx4 v98, s[8:11], s53 offen lds
L_nx3_11_0:
    v_min3_u32 v6, v32, v33, v34
    v_min3_u32 v6, v6, v36, v37
    v_min3_u32 v6, v6, v38, v40
    v_min3_u32 v6, v6, v41, v42
    v_min3_u32 v6, v6, v44, v45
    v_min3_u32 v6, v6, v46, v48
    v_min3_u32 v6, v6, v49, v50
    v_cmp_eq_u32 vcc, 0, v6
    s_nop 4
    s_cmp_eq_u64 vcc, 0
    s_cbranch_scc0 L_ev3_slow
L_ev3_ok:
    v_add_f32 v32, v32, v36
    v_mfma_f32_32x32x16_bf16 v[176:191], v[128:131], v[144:147], v[176:191]
    ds_read_b64_tr_b16 v[116:117], v153 offset:0
    ds_read_b64_tr_b16 v[118:119], v153 offset:1536
    v_add_f32 v33, v33, v37
    v_add_f32 v34, v34, v38
    v_add_f32 v32, v32, v40
    v_mfma_f32_32x32x16_bf16 v[224:239], v[128:131], v[148:151], v[224:239]
    ds_read_b64_tr_b16 v[120:121], v154 offset:0
    ds_read_b64_tr_b16 v[122:123], v154 offset:1536
    v_add_f32 v33, v33, v41
    v_add_f32 v34, v34, v42
    v_add_f32 v32, v32, v44
    v_mfma_f32_32x32x16_bf16 v[192:207], v[132:135], v[144:147], v[192:207]
    v_add_f32 v33, v33, v45
    v_add_f32 v34, v34, v46
    v_mfma_f32_32x32x16_bf16 v[240:255], v[132:135], v[148:151], v[240:255]
    v_add_f32 v32, v32, v48
    v_add_f32 v33, v33, v49
    s_waitcnt lgkmcnt(4)
    v_mfma_f32_32x32x16_bf16 v[160:175], v[112:115], v[136:139], v[160:175]
    ds_read_b128 v[144:147], v105 offset:0
    ds_read_b128 v[148:151], v105 offset:4096
    s_cmp_lg_u32 s3, 0
    s_cbranch_scc1 L_f23
    v_lshlrev_b32 v6, 7, v1
    v_add_u32 v6, 17203200, v6
    buffer_load_dword v92, v6, s[12:15], 0 offen sc1
    v_add_u32 v6, 8192, v6
    s_mov_b64 exec, 1023
    buffer_load_dword v93, v6, s[12:15], 0 offen sc1
    s_mov_b64 exec, -1
L_f23:
    v_add_f32 v34, v34, v50
    v_mov_b32 v76, 0
    v_mfma_f32_32x32x16_bf16 v[208:223], v[112:115], v[140:143], v[208:223]
    ds_read_b64_tr_b16 v[124:125], v152 offset:6144
    ds_read_b64_tr_b16 v[126:127], v152 offset:7680
    v_mov_b32 v77, 0
    v_mov_b32 v78, 0
    s_waitcnt lgkmcnt(6)
    v_mfma_f32_32x32x16_bf16 v[176:191], v[116:119], v[136:139], v[176:191]
    ds_read_b64_tr_b16 v[128:129], v153 offset:6144
    ds_read_b64_tr_b16 v[130:131], v153 offset:7680
    v_mov_b32 v79, 0
    v_mov_b32 v80, 0
    v_mfma_f32_32x32x16_bf16 v[224:239], v[116:119], v[140:143], v[224:239]
    ds_read_b64_tr_b16 v[132:133], v154 offset:6144
    ds_read_b64_tr_b16 v[134:135], v154 offset:7680
    v_mov_b32 v81, 0
    v_mov_b32 v82, 0
    s_waitcnt lgkmcnt(8)
    v_mfma_f32_32x32x16_bf16 v[192:207], v[120:123], v[136:139], v[192:207]
    v_mov_b32 v83, 0
    v_mov_b32 v36, v32
    v_mov_b32 v37, v33
    v_mov_b32 v38, v34
    s_nop 1
    v_permlane32_swap_b32 v32, v36
    v_permlane32_swap_b32 v33, v37
    v_permlane32_swap_b32 v34, v38
    v_xor_b32 v2, 0x80000000, v2
    v_xor_b32 v4, 0x80000000, v4
    v_add_f32 v32, v32, v36
    v_add_f32 v33, v33, v37
    v_add_f32 v34, v34, v38
    v_mfma_f32_32x32x16_bf16 v[240:255], v[120:123], v[140:143], v[240:255]
    s_mov_b32 s34, 0x07060302
    s_mov_b64 exec, 0xffffffff
    v_perm_b32 v76, v2, v2, s34
    v_lshrrev_b32 v77, 16, v2
    v_perm_b32 v80, v4, v4, s34
    v_lshrrev_b32 v81, 16, v4
    s_mov_b64 exec, -1
    v_and_b32 v36, 0xffff0000, v32
    s_waitcnt vmcnt(6) lgkmcnt(0)
    s_barrier
    v_mfma_f32_32x32x16_bf16 v[160:175], v[124:127], v[144:147], v[160:175]
    ds_read_b128 v[136:139], v106 offset:0
    ds_read_b128 v[140:143], v106 offset:4096
    s_add_u32 m0, s26, 49664
    s_nop 0
    buffer_load_dwordx4 v108, s[4:7], s24 offen offset:0 lds
    buffer_load_dwordx4 v109, s[4:7], s24 offen offset:1024 lds
    buffer_load_dwordx4 v110, s[4:7], s24 offen offset:2048 lds
    s_add_u32 s24, s24, s25
    v_mfma_f32_32x32x16_bf16 v[208:223], v[124:127], v[148:151], v[208:223]
    ds_read_b64_tr_b16 v[112:113], v152 offset:24832
    ds_read_b64_tr_b16 v[114:115], v152 offset:26368
    s_cmp_eq_u32 s22, 2
    s_cbranch_scc1 L_nx3_11_1
    s_add_u32 m0, s28, 33792
    s_nop 0
    buffer_load_dwordx4 v99, s[8:11], s53 offen lds
L_nx3_11_1:
    s_add_u32 s53, s53, s54
    v_sub_f32 v36, v32, v36
    v_mfma_f32_32x32x16_bf16 v[176:191], v[128:131], v[144:147], v[176:191]
    ds_read_b64_tr_b16 v[116:117], v153 offset:24832
    ds_read_b64_tr_b16 v[118:119], v153 offset:26368
    v_and_b32 v40, 0xffff0000, v36
    s_mov_b32 s34, 0x07060302
    v_perm_b32 v64, v36, v32, s34
    v_sub_f32 v40, v36, v40
    v_mfma_f32_32x32x16_bf16 v[224:239], v[128:131], v[148:151], v[224:239]
    ds_read_b64_tr_b16 v[120:121], v154 offset:24832
    ds_read_b64_tr_b16 v[122:123], v154 offset:26368
    v_mov_b32 v66, 0
    v_mov_b32 v67, 0
    v_cvt_pk_bf16_f32 v65, v40, 0
    v_mfma_f32_32x32x16_bf16 v[192:207], v[132:135], v[144:147], v[192:207]
    v_and_b32 v37, 0xffff0000, v33
    v_sub_f32 v37, v33, v37
    v_and_b32 v41, 0xffff0000, v37
    v_mfma_f32_32x32x16_bf16 v[240:255], v[132:135], v[148:151], v[240:255]
    s_mov_b32 s34, 0x07060302
    v_perm_b32 v68, v37, v33, s34
    v_sub_f32 v41, v37, v41
    s_waitcnt lgkmcnt(4)
    v_mfma_f32_32x32x16_bf16 v[160:175], v[112:115], v[136:139], v[160:175]
    ds_read_b128 v[144:147], v107 offset:0
    ds_read_b128 v[148:151], v107 offset:4096
    s_cmp_lg_u32 s3, 0
    s_cbranch_scc1 L_fc23
    s_waitcnt vmcnt(3)
    v_cmp_ne_u32 s[68:69], 0, v92
    v_cmp_ne_u32 s[34:35], 0, v93
    s_nop 1
    s_and_b32 s34, s34, 1023
    s_cmp_eq_u64 s[68:69], -1
    s_cselect_b32 s34, s34, 0
    s_cmp_eq_u32 s34, 1023
    s_cbranch_scc0 L_fg3_slow
L_fg3_ok:
L_fc23:
    v_mov_b32 v70, 0
    v_mfma_f32_32x32x16_bf16 v[208:223], v[112:115], v[140:143], v[208:223]
    ds_read_b64_tr_b16 v[124:125], v152 offset:30976
    ds_read_b64_tr_b16 v[126:127], v152 offset:32512
    v_mov_b32 v71, 0
    v_cvt_pk_bf16_f32 v69, v41, 0
    s_waitcnt lgkmcnt(6)
    v_mfma_f32_32x32x16_bf16 v[176:191], v[116:119], v[136:139], v[176:191]
    ds_read_b64_tr_b16 v[128:129], v153 offset:30976
    ds_read_b64_tr_b16 v[130:131], v153 offset:32512
    v_and_b32 v38, 0xffff0000, v34
    v_sub_f32 v38, v34, v38
    v_mfma_f32_32x32x16_bf16 v[224:239], v[116:119], v[140:143], v[224:239]
    ds_read_b64_tr_b16 v[132:133], v154 offset:30976
    ds_read_b64_tr_b16 v[134:135], v154 offset:32512
    v_and_b32 v42, 0xffff0000, v38
    s_mov_b32 s34, 0x07060302
    v_perm_b32 v72, v38, v34, s34
    s_waitcnt lgkmcnt(8)
    v_mfma_f32_32x32x16_bf16 v[192:207], v[120:123], v[136:139], v[192:207]
    v_sub_f32 v42, v38, v42
    v_mov_b32 v74, 0
    v_mfma_f32_32x32x16_bf16 v[240:255], v[120:123], v[140:143], v[240:255]
    v_mov_b32 v75, 0
    v_cvt_pk_bf16_f32 v73, v42, 0
    s_waitcnt lgkmcnt(0)
    s_barrier
    v_mfma_f32_32x32x16_bf16 v[160:175], v[124:127], v[144:147], v[160:175]
    s_add_u32 m0, s26, 74496
    s_nop 0
    buffer_load_dwordx4 v108, s[4:7], s24 offen offset:0 lds
    v_mfma_f32_32x32x16_bf16 v[208:223], v[124:127], v[148:151], v[208:223]
    buffer_load_dwordx4 v109, s[4:7], s24 offen offset:1024 lds
    v_mfma_f32_32x32x16_bf16 v[176:191], v[128:131], v[144:147], v[176:191]
    buffer_load_dwordx4 v110, s[4:7], s24 offen offset:2048 lds
    s_add_u32 s24, s24, s25
    v_mfma_f32_32x32x16_bf16 v[224:239], v[128:131], v[148:151], v[224:239]
    s_cmp_eq_u32 s22, 2
    s_cbranch_scc1 L_nx3_12_0
    s_add_u32 m0, s28, 0
    s_nop 0
    buffer_load_dwordx4 v98, s[8:11], s53 offen lds
L_nx3_12_0:
    v_mfma_f32_32x32x16_bf16 v[192:207], v[132:135], v[144:147], v[192:207]
    s_cmp_eq_u32 s22, 2
    s_cbranch_scc1 L_nx3_12_1
    s_add_u32 m0, s28, 1024
    s_nop 0
    buffer_load_dwordx4 v99, s[8:11], s53 offen lds
L_nx3_12_1:
    v_mfma_f32_32x32x16_bf16 v[240:255], v[132:135], v[148:151], v[240:255]
    v_mfma_f32_32x32x16_bf16 v[160:175], v[64:67], v[76:79], v[160:175]
    v_mfma_f32_32x32x16_bf16 v[208:223], v[64:67], v[80:83], v[208:223]
    v_mfma_f32_32x32x16_bf16 v[176:191], v[68:71], v[76:79], v[176:191]
    v_mfma_f32_32x32x16_bf16 v[224:239], v[68:71], v[80:83], v[224:239]
    v_mfma_f32_32x32x16_bf16 v[192:207], v[72:75], v[76:79], v[192:207]
    v_mfma_f32_32x32x16_bf16 v[240:255], v[72:75], v[80:83], v[240:255]
    s_cmp_eq_u32 s22, 1
    s_cbranch_scc1 L_q3
    s_cmp_eq_u32 s22, 2
    s_cbranch_scc1 L_kv3
    v_mul_f32 v6, v3, v3
    v_mul_f32 v8, v5, v5
    v_bfe_u32 v12, v1, 4, 1
    v_lshlrev_b32 v12, 10, v12
    v_lshrrev_b32 v13, 5, v1
    v_lshl_add_u32 v12, v13, 8, v12
    v_and_b32 v13, 15, v1
    v_lshl_add_u32 v12, v13, 4, v12
    s_lshl_b32 s55, s20, 1
    s_add_u32 s55, s55, s50
    s_mul_i32 s55, s55, 54
    s_mul_i32 s56, s23, 12
    s_add_u32 s56, s56, s51
    s_nop 3
    s_add_u32 s57, s56, 0
    s_lshr_b32 s33, s57, 1
    s_add_u32 s33, s33, s55
    s_lshl_b32 s33, s33, 12
    s_and_b32 s57, s57, 1
    s_lshl_b32 s57, s57, 9
    s_add_u32 s33, s33, s57
    v_mul_f32 v160, v160, v168
    v_mul_f32 v161, v161, v169
    v_mul_f32 v162, v162, v170
    v_mul_f32 v163, v163, v171
    v_mul_f32 v164, v164, v172
    v_mul_f32 v165, v165, v173
    v_mul_f32 v166, v166, v174
    v_mul_f32 v167, v167, v175
    v_mul_f32 v160, v160, v6
    v_mul_f32 v161, v161, v6
    v_mul_f32 v162, v162, v6
    v_mul_f32 v163, v163, v6
    v_mul_f32 v164, v164, v6
    v_mul_f32 v165, v165, v6
    v_mul_f32 v166, v166, v6
    v_mul_f32 v167, v167, v6
    v_cvt_pk_bf16_f32 v168, v160, v161
    v_cvt_pk_bf16_f32 v169, v162, v163
    v_cvt_pk_bf16_f32 v170, v164, v165
    v_cvt_pk_bf16_f32 v171, v166, v167
    buffer_store_dwordx4 v[168:171], v12, s[12:15], s33 offen offset:0 sc1
    v_mul_f32 v208, v208, v216
    v_mul_f32 v209, v209, v217
    v_mul_f32 v210, v210, v218
    v_mul_f32 v211, v211, v219
    v_mul_f32 v212, v212, v220
    v_mul_f32 v213, v213, v221
    v_mul_f32 v214, v214, v222
    v_mul_f32 v215, v215, v223
    v_mul_f32 v208, v208, v8
    v_mul_f32 v209, v209, v8
    v_mul_f32 v210, v210, v8
    v_mul_f32 v211, v211, v8
    v_mul_f32 v212, v212, v8
    v_mul_f32 v213, v213, v8
    v_mul_f32 v214, v214, v8
    v_mul_f32 v215, v215, v8
    v_cvt_pk_bf16_f32 v216, v208, v209
    v_cvt_pk_bf16_f32 v217, v210, v211
    v_cvt_pk_bf16_f32 v218, v212, v213
    v_cvt_pk_bf16_f32 v219, v214, v215
    buffer_store_dwordx4 v[216:219], v12, s[12:15], s33 offen offset:2048 sc1
    s_add_u32 s57, s56, 1
    s_lshr_b32 s33, s57, 1
    s_add_u32 s33, s33, s55
    s_lshl_b32 s33, s33, 12
    s_and_b32 s57, s57, 1
    s_lshl_b32 s57, s57, 9
    s_add_u32 s33, s33, s57
    v_mul_f32 v176, v176, v184
    v_mul_f32 v177, v177, v185
    v_mul_f32 v178, v178, v186
    v_mul_f32 v179, v179, v187
    v_mul_f32 v180, v180, v188
    v_mul_f32 v181, v181, v189
    v_mul_f32 v182, v182, v190
    v_mul_f32 v183, v183, v191
    v_mul_f32 v176, v176, v6
    v_mul_f32 v177, v177, v6
    v_mul_f32 v178, v178, v6
    v_mul_f32 v179, v179, v6
    v_mul_f32 v180, v180, v6
    v_mul_f32 v181, v181, v6
    v_mul_f32 v182, v182, v6
    v_mul_f32 v183, v183, v6
    v_cvt_pk_bf16_f32 v184, v176, v177
    v_cvt_pk_bf16_f32 v185, v178, v179
    v_cvt_pk_bf16_f32 v186, v180, v181
    v_cvt_pk_bf16_f32 v187, v182, v183
    buffer_store_dwordx4 v[184:187], v12, s[12:15], s33 offen offset:0 sc1
    v_mul_f32 v224, v224, v232
    v_mul_f32 v225, v225, v233
    v_mul_f32 v226, v226, v234
    v_mul_f32 v227, v227, v235
    v_mul_f32 v228, v228, v236
    v_mul_f32 v229, v229, v237
    v_mul_f32 v230, v230, v238
    v_mul_f32 v231, v231, v239
    v_mul_f32 v224, v224, v8
    v_mul_f32 v225, v225, v8
    v_mul_f32 v226, v226, v8
    v_mul_f32 v227, v227, v8
    v_mul_f32 v228, v228, v8
    v_mul_f32 v229, v229, v8
    v_mul_f32 v230, v230, v8
    v_mul_f32 v231, v231, v8
    v_cvt_pk_bf16_f32 v232, v224, v225
    v_cvt_pk_bf16_f32 v233, v226, v227
    v_cvt_pk_bf16_f32 v234, v228, v229
    v_cvt_pk_bf16_f32 v235, v230, v231
    buffer_store_dwordx4 v[232:235], v12, s[12:15], s33 offen offset:2048 sc1
    s_add_u32 s57, s56, 2
    s_lshr_b32 s33, s57, 1
    s_add_u32 s33, s33, s55
    s_lshl_b32 s33, s33, 12
    s_and_b32 s57, s57, 1
    s_lshl_b32 s57, s57, 9
    s_add_u32 s33, s33, s57
    v_mul_f32 v192, v192, v200
    v_mul_f32 v193, v193, v201
    v_mul_f32 v194, v194, v202
    v_mul_f32 v195, v195, v203
    v_mul_f32 v196, v196, v204
    v_mul_f32 v197, v197, v205
    v_mul_f32 v198, v198, v206
    v_mul_f32 v199, v199, v207
    v_mul_f32 v192, v192, v6
    v_mul_f32 v193, v193, v6
    v_mul_f32 v194, v194, v6
    v_mul_f32 v195, v195, v6
    v_mul_f32 v196, v196, v6
    v_mul_f32 v197, v197, v6
    v_mul_f32 v198, v198, v6
    v_mul_f32 v199, v199, v6
    v_cvt_pk_bf16_f32 v200, v192, v193
    v_cvt_pk_bf16_f32 v201, v194, v195
    v_cvt_pk_bf16_f32 v202, v196, v197
    v_cvt_pk_bf16_f32 v203, v198, v199
    buffer_store_dwordx4 v[200:203], v12, s[12:15], s33 offen offset:0 sc1
    v_mul_f32 v240, v240, v248
    v_mul_f32 v241, v241, v249
    v_mul_f32 v242, v242, v250
    v_mul_f32 v243, v243, v251
    v_mul_f32 v244, v244, v252
    v_mul_f32 v245, v245, v253
    v_mul_f32 v246, v246, v254
    v_mul_f32 v247, v247, v255
    v_mul_f32 v240, v240, v8
    v_mul_f32 v241, v241, v8
    v_mul_f32 v242, v242, v8
    v_mul_f32 v243, v243, v8
    v_mul_f32 v244, v244, v8
    v_mul_f32 v245, v245, v8
    v_mul_f32 v246, v246, v8
    v_mul_f32 v247, v247, v8
    v_cvt_pk_bf16_f32 v248, v240, v241
    v_cvt_pk_bf16_f32 v249, v242, v243
    v_cvt_pk_bf16_f32 v250, v244, v245
    v_cvt_pk_bf16_f32 v251, v246, v247
    buffer_store_dwordx4 v[248:251], v12, s[12:15], s33 offen offset:2048 sc1
    s_branch L_p1_done
L_q3:
    v_mul_f32 v6, 0x3fb8aa3b, v3
    v_mul_f32 v8, 0x3fb8aa3b, v5
    v_mov_b32 v14, 0x35c1a2a0
    s_mov_b32 s68, 0x3f317218
    v_bfe_u32 v12, v1, 4, 1
    v_lshlrev_b32 v12, 10, v12
    v_lshrrev_b32 v13, 5, v1
    v_lshl_add_u32 v12, v13, 8, v12
    v_and_b32 v13, 15, v1
    v_lshl_add_u32 v12, v13, 4, v12
    s_lshl_b32 s55, s20, 1
    s_add_u32 s55, s55, s50
    s_mul_i32 s55, s55, 20
    s_mul_i32 s56, s23, 10
    s_add_u32 s55, s55, s56
    s_lshl_b32 s55, s55, 12
    s_add_u32 s55, s55, 7340032
    s_add_u32 s57, s51, 0
    s_lshr_b32 s33, s57, 1
    s_lshl_b32 s33, s33, 12
    s_and_b32 s57, s57, 1
    s_lshl_b32 s57, s57, 9
    s_add_u32 s33, s33, s57
    s_add_u32 s33, s33, s55
    s_add_u32 s56, s33, 20480
    v_fma_f32 v160, v160, v6, v14
    v_fma_f32 v161, v161, v6, v14
    v_fma_f32 v162, v162, v6, v14
    v_fma_f32 v163, v163, v6, v14
    v_fma_f32 v164, v164, v6, v14
    v_fma_f32 v165, v165, v6, v14
    v_fma_f32 v166, v166, v6, v14
    v_fma_f32 v167, v167, v6, v14
    v_fma_f32 v168, v168, v6, v14
    v_fma_f32 v169, v169, v6, v14
    v_fma_f32 v170, v170, v6, v14
    v_fma_f32 v171, v171, v6, v14
    v_fma_f32 v172, v172, v6, v14
    v_fma_f32 v173, v173, v6, v14
    v_fma_f32 v174, v174, v6, v14
    v_fma_f32 v175, v175, v6, v14
    v_exp_f32 v48, v160 clamp
    v_exp_f32 v49, v161 clamp
    v_exp_f32 v50, v162 clamp
    v_exp_f32 v51, v163 clamp
    v_exp_f32 v52, v164 clamp
    v_exp_f32 v53, v165 clamp
    v_exp_f32 v54, v166 clamp
    v_exp_f32 v55, v167 clamp
    v_exp_f32 v56, v168 clamp
    v_exp_f32 v57, v169 clamp
    v_exp_f32 v58, v170 clamp
    v_exp_f32 v59, v171 clamp
    v_exp_f32 v60, v172 clamp
    v_exp_f32 v61, v173 clamp
    v_exp_f32 v62, v174 clamp
    v_exp_f32 v63, v175 clamp
    v_max_f32 v160, v160, v14
    v_max_f32 v161, v161, v14
    v_max_f32 v162, v162, v14
    v_max_f32 v163, v163, v14
    v_max_f32 v164, v164, v14
    v_max_f32 v165, v165, v14
    v_max_f32 v166, v166, v14
    v_max_f32 v167, v167, v14
    v_max_f32 v168, v168, v14
    v_max_f32 v169, v169, v14
    v_max_f32 v170, v170, v14
    v_max_f32 v171, v171, v14
    v_max_f32 v172, v172, v14
    v_max_f32 v173, v173, v14
    v_max_f32 v174, v174, v14
    v_max_f32 v175, v175, v14
    v_fmac_f32 v48, s68, v160
    v_fmac_f32 v49, s68, v161
    v_fmac_f32 v50, s68, v162
    v_fmac_f32 v51, s68, v163
    v_fmac_f32 v52, s68, v164
    v_fmac_f32 v53, s68, v165
    v_fmac_f32 v54, s68, v166
    v_fmac_f32 v55, s68, v167
    v_fmac_f32 v56, s68, v168
    v_fmac_f32 v57, s68, v169
    v_fmac_f32 v58, s68, v170
    v_fmac_f32 v59, s68, v171
    v_fmac_f32 v60, s68, v172
    v_fmac_f32 v61, s68, v173
    v_fmac_f32 v62, s68, v174
    v_fmac_f32 v63, s68, v175
    v_cvt_pk_bf16_f32 v160, v48, v49
    v_cvt_pk_bf16_f32 v161, v50, v51
    v_cvt_pk_bf16_f32 v162, v52, v53
    v_cvt_pk_bf16_f32 v163, v54, v55
    v_cvt_pk_bf16_f32 v164, v56, v57
    v_cvt_pk_bf16_f32 v165, v58, v59
    v_cvt_pk_bf16_f32 v166, v60, v61
    v_cvt_pk_bf16_f32 v167, v62, v63
    buffer_store_dwordx4 v[160:163], v12, s[12:15], s33 offen offset:0 sc1
    buffer_store_dwordx4 v[164:167], v12, s[12:15], s56 offen offset:0 sc1
    v_fma_f32 v208, v208, v8, v14
    v_fma_f32 v209, v209, v8, v14
    v_fma_f32 v210, v210, v8, v14
    v_fma_f32 v211, v211, v8, v14
    v_fma_f32 v212, v212, v8, v14
    v_fma_f32 v213, v213, v8, v14
    v_fma_f32 v214, v214, v8, v14
    v_fma_f32 v215, v215, v8, v14
    v_fma_f32 v216, v216, v8, v14
    v_fma_f32 v217, v217, v8, v14
    v_fma_f32 v218, v218, v8, v14
    v_fma_f32 v219, v219, v8, v14
    v_fma_f32 v220, v220, v8, v14
    v_fma_f32 v221, v221, v8, v14
    v_fma_f32 v222, v222, v8, v14
    v_fma_f32 v223, v223, v8, v14
    v_exp_f32 v48, v208 clamp
    v_exp_f32 v49, v209 clamp
    v_exp_f32 v50, v210 clamp
    v_exp_f32 v51, v211 clamp
    v_exp_f32 v52, v212 clamp
    v_exp_f32 v53, v213 clamp
    v_exp_f32 v54, v214 clamp
    v_exp_f32 v55, v215 clamp
    v_exp_f32 v56, v216 clamp
    v_exp_f32 v57, v217 clamp
    v_exp_f32 v58, v218 clamp
    v_exp_f32 v59, v219 clamp
    v_exp_f32 v60, v220 clamp
    v_exp_f32 v61, v221 clamp
    v_exp_f32 v62, v222 clamp
    v_exp_f32 v63, v223 clamp
    v_max_f32 v208, v208, v14
    v_max_f32 v209, v209, v14
    v_max_f32 v210, v210, v14
    v_max_f32 v211, v211, v14
    v_max_f32 v212, v212, v14
    v_max_f32 v213, v213, v14
    v_max_f32 v214, v214, v14
    v_max_f32 v215, v215, v14
    v_max_f32 v216, v216, v14
    v_max_f32 v217, v217, v14
    v_max_f32 v218, v218, v14
    v_max_f32 v219, v219, v14
    v_max_f32 v220, v220, v14
    v_max_f32 v221, v221, v14
    v_max_f32 v222, v222, v14
    v_max_f32 v223, v223, v14
    v_fmac_f32 v48, s68, v208
    v_fmac_f32 v49, s68, v209
    v_fmac_f32 v50, s68, v210
    v_fmac_f32 v51, s68, v211
    v_fmac_f32 v52, s68, v212
    v_fmac_f32 v53, s68, v213
    v_fmac_f32 v54, s68, v214
    v_fmac_f32 v55, s68, v215
    v_fmac_f32 v56, s68, v216
    v_fmac_f32 v57, s68, v217
    v_fmac_f32 v58, s68, v218
    v_fmac_f32 v59, s68, v219
    v_fmac_f32 v60, s68, v220
    v_fmac_f32 v61, s68, v221
    v_fmac_f32 v62, s68, v222
    v_fmac_f32 v63, s68, v223
    v_cvt_pk_bf16_f32 v208, v48, v49
    v_cvt_pk_bf16_f32 v209, v50, v51
    v_cvt_pk_bf16_f32 v210, v52, v53
    v_cvt_pk_bf16_f32 v211, v54, v55
    v_cvt_pk_bf16_f32 v212, v56, v57
    v_cvt_pk_bf16_f32 v213, v58, v59
    v_cvt_pk_bf16_f32 v214, v60, v61
    v_cvt_pk_bf16_f32 v215, v62, v63
    buffer_store_dwordx4 v[208:211], v12, s[12:15], s33 offen offset:2048 sc1
    buffer_store_dwordx4 v[212:215], v12, s[12:15], s56 offen offset:2048 sc1
    s_add_u32 s57, s51, 1
    s_lshr_b32 s33, s57, 1
    s_lshl_b32 s33, s33, 12
    s_and_b32 s57, s57, 1
    s_lshl_b32 s57, s57, 9
    s_add_u32 s33, s33, s57
    s_add_u32 s33, s33, s55
    s_add_u32 s56, s33, 20480
    v_fma_f32 v176, v176, v6, v14
    v_fma_f32 v177, v177, v6, v14
    v_fma_f32 v178, v178, v6, v14
    v_fma_f32 v179, v179, v6, v14
    v_fma_f32 v180, v180, v6, v14
    v_fma_f32 v181, v181, v6, v14
    v_fma_f32 v182, v182, v6, v14
    v_fma_f32 v183, v183, v6, v14
    v_fma_f32 v184, v184, v6, v14
    v_fma_f32 v185, v185, v6, v14
    v_fma_f32 v186, v186, v6, v14
    v_fma_f32 v187, v187, v6, v14
    v_fma_f32 v188, v188, v6, v14
    v_fma_f32 v189, v189, v6, v14
    v_fma_f32 v190, v190, v6, v14
    v_fma_f32 v191, v191, v6, v14
    v_exp_f32 v48, v176 clamp
    v_exp_f32 v49, v177 clamp
    v_exp_f32 v50, v178 clamp
    v_exp_f32 v51, v179 clamp
    v_exp_f32 v52, v180 clamp
    v_exp_f32 v53, v181 clamp
    v_exp_f32 v54, v182 clamp
    v_exp_f32 v55, v183 clamp
    v_exp_f32 v56, v184 clamp
    v_exp_f32 v57, v185 clamp
    v_exp_f32 v58, v186 clamp
    v_exp_f32 v59, v187 clamp
    v_exp_f32 v60, v188 clamp
    v_exp_f32 v61, v189 clamp
    v_exp_f32 v62, v190 clamp
    v_exp_f32 v63, v191 clamp
    v_max_f32 v176, v176, v14
    v_max_f32 v177, v177, v14
    v_max_f32 v178, v178, v14
    v_max_f32 v179, v179, v14
    v_max_f32 v180, v180, v14
    v_max_f32 v181, v181, v14
    v_max_f32 v182, v182, v14
    v_max_f32 v183, v183, v14
    v_max_f32 v184, v184, v14
    v_max_f32 v185, v185, v14
    v_max_f32 v186, v186, v14
    v_max_f32 v187, v187, v14
    v_max_f32 v188, v188, v14
    v_max_f32 v189, v189, v14
    v_max_f32 v190, v190, v14
    v_max_f32 v191, v191, v14
    v_fmac_f32 v48, s68, v176
    v_fmac_f32 v49, s68, v177
    v_fmac_f32 v50, s68, v178
    v_fmac_f32 v51, s68, v179
    v_fmac_f32 v52, s68, v180
    v_fmac_f32 v53, s68, v181
    v_fmac_f32 v54, s68, v182
    v_fmac_f32 v55, s68, v183
    v_fmac_f32 v56, s68, v184
    v_fmac_f32 v57, s68, v185
    v_fmac_f32 v58, s68, v186
    v_fmac_f32 v59, s68, v187
    v_fmac_f32 v60, s68, v188
    v_fmac_f32 v61, s68, v189
    v_fmac_f32 v62, s68, v190
    v_fmac_f32 v63, s68, v191
    v_cvt_pk_bf16_f32 v176, v48, v49
    v_cvt_pk_bf16_f32 v177, v50, v51
    v_cvt_pk_bf16_f32 v178, v52, v53
    v_cvt_pk_bf16_f32 v179, v54, v55
    v_cvt_pk_bf16_f32 v180, v56, v57
    v_cvt_pk_bf16_f32 v181, v58, v59
    v_cvt_pk_bf16_f32 v182, v60, v61
    v_cvt_pk_bf16_f32 v183, v62, v63
    buffer_store_dwordx4 v[176:179], v12, s[12:15], s33 offen offset:0 sc1
    buffer_store_dwordx4 v[180:183], v12, s[12:15], s56 offen offset:0 sc1
    v_fma_f32 v224, v224, v8, v14
    v_fma_f32 v225, v225, v8, v14
    v_fma_f32 v226, v226, v8, v14
    v_fma_f32 v227, v227, v8, v14
    v_fma_f32 v228, v228, v8, v14
    v_fma_f32 v229, v229, v8, v14
    v_fma_f32 v230, v230, v8, v14
    v_fma_f32 v231, v231, v8, v14
    v_fma_f32 v232, v232, v8, v14
    v_fma_f32 v233, v233, v8, v14
    v_fma_f32 v234, v234, v8, v14
    v_fma_f32 v235, v235, v8, v14
    v_fma_f32 v236, v236, v8, v14
    v_fma_f32 v237, v237, v8, v14
    v_fma_f32 v238, v238, v8, v14
    v_fma_f32 v239, v239, v8, v14
    v_exp_f32 v48, v224 clamp
    v_exp_f32 v49, v225 clamp
    v_exp_f32 v50, v226 clamp
    v_exp_f32 v51, v227 clamp
    v_exp_f32 v52, v228 clamp
    v_exp_f32 v53, v229 clamp
    v_exp_f32 v54, v230 clamp
    v_exp_f32 v55, v231 clamp
    v_exp_f32 v56, v232 clamp
    v_exp_f32 v57, v233 clamp
    v_exp_f32 v58, v234 clamp
    v_exp_f32 v59, v235 clamp
    v_exp_f32 v60, v236 clamp
    v_exp_f32 v61, v237 clamp
    v_exp_f32 v62, v238 clamp
    v_exp_f32 v63, v239 clamp
    v_max_f32 v224, v224, v14
    v_max_f32 v225, v225, v14
    v_max_f32 v226, v226, v14
    v_max_f32 v227, v227, v14
    v_max_f32 v228, v228, v14
    v_max_f32 v229, v229, v14
    v_max_f32 v230, v230, v14
    v_max_f32 v231, v231, v14
    v_max_f32 v232, v232, v14
    v_max_f32 v233, v233, v14
    v_max_f32 v234, v234, v14
    v_max_f32 v235, v235, v14
    v_max_f32 v236, v236, v14
    v_max_f32 v237, v237, v14
    v_max_f32 v238, v238, v14
    v_max_f32 v239, v239, v14
    v_fmac_f32 v48, s68, v224
    v_fmac_f32 v49, s68, v225
    v_fmac_f32 v50, s68, v226
    v_fmac_f32 v51, s68, v227
    v_fmac_f32 v52, s68, v228
    v_fmac_f32 v53, s68, v229
    v_fmac_f32 v54, s68, v230
    v_fmac_f32 v55, s68, v231
    v_fmac_f32 v56, s68, v232
    v_fmac_f32 v57, s68, v233
    v_fmac_f32 v58, s68, v234
    v_fmac_f32 v59, s68, v235
    v_fmac_f32 v60, s68, v236
    v_fmac_f32 v61, s68, v237
    v_fmac_f32 v62, s68, v238
    v_fmac_f32 v63, s68, v239
    v_cvt_pk_bf16_f32 v224, v48, v49
    v_cvt_pk_bf16_f32 v225, v50, v51
    v_cvt_pk_bf16_f32 v226, v52, v53
    v_cvt_pk_bf16_f32 v227, v54, v55
    v_cvt_pk_bf16_f32 v228, v56, v57
    v_cvt_pk_bf16_f32 v229, v58, v59
    v_cvt_pk_bf16_f32 v230, v60, v61
    v_cvt_pk_bf16_f32 v231, v62, v63
    buffer_store_dwordx4 v[224:227], v12, s[12:15], s33 offen offset:2048 sc1
    buffer_store_dwordx4 v[228:231], v12, s[12:15], s56 offen offset:2048 sc1
    s_add_u32 s57, s51, 2
    s_lshr_b32 s33, s57, 1
    s_lshl_b32 s33, s33, 12
    s_and_b32 s57, s57, 1
    s_lshl_b32 s57, s57, 9
    s_add_u32 s33, s33, s57
    s_add_u32 s33, s33, s55
    s_add_u32 s56, s33, 20480
    v_fma_f32 v192, v192, v6, v14
    v_fma_f32 v193, v193, v6, v14
    v_fma_f32 v194, v194, v6, v14
    v_fma_f32 v195, v195, v6, v14
    v_fma_f32 v196, v196, v6, v14
    v_fma_f32 v197, v197, v6, v14
    v_fma_f32 v198, v198, v6, v14
    v_fma_f32 v199, v199, v6, v14
    v_fma_f32 v200, v200, v6, v14
    v_fma_f32 v201, v201, v6, v14
    v_fma_f32 v202, v202, v6, v14
    v_fma_f32 v203, v203, v6, v14
    v_fma_f32 v204, v204, v6, v14
    v_fma_f32 v205, v205, v6, v14
    v_fma_f32 v206, v206, v6, v14
    v_fma_f32 v207, v207, v6, v14
    v_exp_f32 v48, v192 clamp
    v_exp_f32 v49, v193 clamp
    v_exp_f32 v50, v194 clamp
    v_exp_f32 v51, v195 clamp
    v_exp_f32 v52, v196 clamp
    v_exp_f32 v53, v197 clamp
    v_exp_f32 v54, v198 clamp
    v_exp_f32 v55, v199 clamp
    v_exp_f32 v56, v200 clamp
    v_exp_f32 v57, v201 clamp
    v_exp_f32 v58, v202 clamp
    v_exp_f32 v59, v203 clamp
    v_exp_f32 v60, v204 clamp
    v_exp_f32 v61, v205 clamp
    v_exp_f32 v62, v206 clamp
    v_exp_f32 v63, v207 clamp
    v_max_f32 v192, v192, v14
    v_max_f32 v193, v193, v14
    v_max_f32 v194, v194, v14
    v_max_f32 v195, v195, v14
    v_max_f32 v196, v196, v14
    v_max_f32 v197, v197, v14
    v_max_f32 v198, v198, v14
    v_max_f32 v199, v199, v14
    v_max_f32 v200, v200, v14
    v_max_f32 v201, v201, v14
    v_max_f32 v202, v202, v14
    v_max_f32 v203, v203, v14
    v_max_f32 v204, v204, v14
    v_max_f32 v205, v205, v14
    v_max_f32 v206, v206, v14
    v_max_f32 v207, v207, v14
    v_fmac_f32 v48, s68, v192
    v_fmac_f32 v49, s68, v193
    v_fmac_f32 v50, s68, v194
    v_fmac_f32 v51, s68, v195
    v_fmac_f32 v52, s68, v196
    v_fmac_f32 v53, s68, v197
    v_fmac_f32 v54, s68, v198
    v_fmac_f32 v55, s68, v199
    v_fmac_f32 v56, s68, v200
    v_fmac_f32 v57, s68, v201
    v_fmac_f32 v58, s68, v202
    v_fmac_f32 v59, s68, v203
    v_fmac_f32 v60, s68, v204
    v_fmac_f32 v61, s68, v205
    v_fmac_f32 v62, s68, v206
    v_fmac_f32 v63, s68, v207
    v_cvt_pk_bf16_f32 v192, v48, v49
    v_cvt_pk_bf16_f32 v193, v50, v51
    v_cvt_pk_bf16_f32 v194, v52, v53
    v_cvt_pk_bf16_f32 v195, v54, v55
    v_cvt_pk_bf16_f32 v196, v56, v57
    v_cvt_pk_bf16_f32 v197, v58, v59
    v_cvt_pk_bf16_f32 v198, v60, v61
    v_cvt_pk_bf16_f32 v199, v62, v63
    buffer_store_dwordx4 v[192:195], v12, s[12:15], s33 offen offset:0 sc1
    buffer_store_dwordx4 v[196:199], v12, s[12:15], s56 offen offset:0 sc1
    v_fma_f32 v240, v240, v8, v14
    v_fma_f32 v241, v241, v8, v14
    v_fma_f32 v242, v242, v8, v14
    v_fma_f32 v243, v243, v8, v14
    v_fma_f32 v244, v244, v8, v14
    v_fma_f32 v245, v245, v8, v14
    v_fma_f32 v246, v246, v8, v14
    v_fma_f32 v247, v247, v8, v14
    v_fma_f32 v248, v248, v8, v14
    v_fma_f32 v249, v249, v8, v14
    v_fma_f32 v250, v250, v8, v14
    v_fma_f32 v251, v251, v8, v14
    v_fma_f32 v252, v252, v8, v14
    v_fma_f32 v253, v253, v8, v14
    v_fma_f32 v254, v254, v8, v14
    v_fma_f32 v255, v255, v8, v14
    v_exp_f32 v48, v240 clamp
    v_exp_f32 v49, v241 clamp
    v_exp_f32 v50, v242 clamp
    v_exp_f32 v51, v243 clamp
    v_exp_f32 v52, v244 clamp
    v_exp_f32 v53, v245 clamp
    v_exp_f32 v54, v246 clamp
    v_exp_f32 v55, v247 clamp
    v_exp_f32 v56, v248 clamp
    v_exp_f32 v57, v249 clamp
    v_exp_f32 v58, v250 clamp
    v_exp_f32 v59, v251 clamp
    v_exp_f32 v60, v252 clamp
    v_exp_f32 v61, v253 clamp
    v_exp_f32 v62, v254 clamp
    v_exp_f32 v63, v255 clamp
    v_max_f32 v240, v240, v14
    v_max_f32 v241, v241, v14
    v_max_f32 v242, v242, v14
    v_max_f32 v243, v243, v14
    v_max_f32 v244, v244, v14
    v_max_f32 v245, v245, v14
    v_max_f32 v246, v246, v14
    v_max_f32 v247, v247, v14
    v_max_f32 v248, v248, v14
    v_max_f32 v249, v249, v14
    v_max_f32 v250, v250, v14
    v_max_f32 v251, v251, v14
    v_max_f32 v252, v252, v14
    v_max_f32 v253, v253, v14
    v_max_f32 v254, v254, v14
    v_max_f32 v255, v255, v14
    v_fmac_f32 v48, s68, v240
    v_fmac_f32 v49, s68, v241
    v_fmac_f32 v50, s68, v242
    v_fmac_f32 v51, s68, v243
    v_fmac_f32 v52, s68, v244
    v_fmac_f32 v53, s68, v245
    v_fmac_f32 v54, s68, v246
    v_fmac_f32 v55, s68, v247
    v_fmac_f32 v56, s68, v248
    v_fmac_f32 v57, s68, v249
    v_fmac_f32 v58, s68, v250
    v_fmac_f32 v59, s68, v251
    v_fmac_f32 v60, s68, v252
    v_fmac_f32 v61, s68, v253
    v_fmac_f32 v62, s68, v254
    v_fmac_f32 v63, s68, v255
    v_cvt_pk_bf16_f32 v240, v48, v49
    v_cvt_pk_bf16_f32 v241, v50, v51
    v_cvt_pk_bf16_f32 v242, v52, v53
    v_cvt_pk_bf16_f32 v243, v54, v55
    v_cvt_pk_bf16_f32 v244, v56, v57
    v_cvt_pk_bf16_f32 v245, v58, v59
    v_cvt_pk_bf16_f32 v246, v60, v61
    v_cvt_pk_bf16_f32 v247, v62, v63
    buffer_store_dwordx4 v[240:243], v12, s[12:15], s33 offen offset:2048 sc1
    buffer_store_dwordx4 v[244:247], v12, s[12:15], s56 offen offset:2048 sc1
    s_branch L_p1_done
L_kv3:
    s_cmp_ge_u32 s3, 4
    s_cbranch_scc1 L_el3_no
    s_mul_i32 s34, s3, 14
    s_cmp_eq_u32 s3, 3
    s_cselect_b32 s35, 1, 0
    s_sub_u32 s34, s34, s35
    s_mul_i32 s35, s59, 74
    s_add_u32 s34, s34, s35
    s_mul_i32 s56, s34, 5120
    s_add_u32 s56, s56, 10485760
    s_add_u32 s56, s56, 35840
L_el3:
    s_add_u32 s57, s56, 4096
    buffer_load_dwordx4 v[96:99], v155, s[12:15], s56 offen offset:0
    buffer_load_dwordx4 v[100:103], v155, s[12:15], s56 offen offset:1024
    buffer_load_dwordx4 v[104:107], v155, s[12:15], s56 offen offset:2048
    buffer_load_dwordx4 v[108:111], v155, s[12:15], s56 offen offset:3072
    buffer_load_dwordx4 v[112:115], v155, s[12:15], s57 offen
    s_add_u32 s56, s56, 5120
    s_add_u32 s57, s57, 5120
    buffer_load_dwordx4 v[116:119], v155, s[12:15], s56 offen offset:0
    buffer_load_dwordx4 v[120:123], v155, s[12:15], s56 offen offset:1024
    buffer_load_dwordx4 v[124:127], v155, s[12:15], s56 offen offset:2048
    buffer_load_dwordx4 v[128:131], v155, s[12:15], s56 offen offset:3072
    buffer_load_dwordx4 v[132:135], v155, s[12:15], s57 offen
    s_add_u32 s56, s56, 5120
    s_add_u32 s57, s57, 5120
    buffer_load_dwordx4 v[136:139], v155, s[12:15], s56 offen offset:0
    buffer_load_dwordx4 v[140:143], v155, s[12:15], s56 offen offset:1024
    buffer_load_dwordx4 v[144:147], v155, s[12:15], s56 offen offset:2048
    buffer_load_dwordx4 v[148:151], v155, s[12:15], s56 offen offset:3072
    buffer_load_dwordx4 v[152:155], v155, s[12:15], s57 offen
L_el3_no:
    v_mul_f32 v6, 0x3fb8aa3b, v3
    v_mul_f32 v8, 0x3fb8aa3b, v5
    v_mov_b32 v14, 0x35c1a2a0
    s_mov_b32 s68, 0x3f317218
    v_and_b32 v12, 31, v1
    s_lshl_b32 s55, s50, 5
    v_add_u32 v12, s55, v12
    v_mul_u32_u24 v12, 336, v12
    v_lshrrev_b32 v13, 5, v1
    v_lshl_add_u32 v12, v13, 4, v12
    s_lshl_b32 s55, s51, 5
    s_add_u32 s55, s55, 99328
    v_add_u32 v12, s55, v12
    v_lshrrev_b32 v9, 5, v1
    v_bfe_u32 v10, v1, 2, 2
    v_lshl_add_u32 v9, v10, 2, v9
    v_mul_u32_u24 v9, 336, v9
    v_bfe_u32 v10, v1, 4, 1
    v_lshl_add_u32 v9, v10, 5, v9
    v_and_b32 v10, 3, v1
    v_lshl_add_u32 v9, v10, 3, v9
    s_mul_i32 s55, s3, 40
    s_add_u32 s55, s55, 99328
    v_add_u32 v9, s55, v9
    v_mov_b32 v88, s52
    v_mov_b32 v89, s52
    v_mov_b32 v90, s52
    v_mov_b32 v91, s52
    v_fma_f32 v160, v160, v6, v14
    v_fma_f32 v161, v161, v6, v14
    v_fma_f32 v162, v162, v6, v14
    v_fma_f32 v163, v163, v6, v14
    v_fma_f32 v164, v164, v6, v14
    v_fma_f32 v165, v165, v6, v14
    v_fma_f32 v166, v166, v6, v14
    v_fma_f32 v167, v167, v6, v14
    v_exp_f32 v48, v160 clamp
    v_exp_f32 v49, v161 clamp
    v_exp_f32 v50, v162 clamp
    v_exp_f32 v51, v163 clamp
    v_exp_f32 v52, v164 clamp
    v_exp_f32 v53, v165 clamp
    v_exp_f32 v54, v166 clamp
    v_exp_f32 v55, v167 clamp
    v_max_f32 v160, v160, v14
    v_max_f32 v161, v161, v14
    v_max_f32 v162, v162, v14
    v_max_f32 v163, v163, v14
    v_max_f32 v164, v164, v14
    v_max_f32 v165, v165, v14
    v_max_f32 v166, v166, v14
    v_max_f32 v167, v167, v14
    v_fmac_f32 v48, s68, v160
    v_fmac_f32 v49, s68, v161
    v_fmac_f32 v50, s68, v162
    v_fmac_f32 v51, s68, v163
    v_fmac_f32 v52, s68, v164
    v_fmac_f32 v53, s68, v165
    v_fmac_f32 v54, s68, v166
    v_fmac_f32 v55, s68, v167
    v_mul_f32 v168, v168, v3
    v_mul_f32 v169, v169, v3
    v_mul_f32 v170, v170, v3
    v_mul_f32 v171, v171, v3
    v_mul_f32 v172, v172, v3
    v_mul_f32 v173, v173, v3
    v_mul_f32 v174, v174, v3
    v_mul_f32 v175, v175, v3
    v_cvt_pk_bf16_f32 v160, v48, v49
    v_cvt_pk_bf16_f32 v161, v50, v51
    v_cvt_pk_bf16_f32 v162, v52, v53
    v_cvt_pk_bf16_f32 v163, v54, v55
    v_cvt_pk_bf16_f32 v164, v168, v169
    v_cvt_pk_bf16_f32 v165, v170, v171
    v_cvt_pk_bf16_f32 v166, v172, v173
    v_cvt_pk_bf16_f32 v167, v174, v175
    ds_write_b128 v12, v[160:163] offset:0
    ds_write_b128 v12, v[164:167] offset:21504
    v_fma_f32 v176, v176, v6, v14
    v_fma_f32 v177, v177, v6, v14
    v_fma_f32 v178, v178, v6, v14
    v_fma_f32 v179, v179, v6, v14
    v_fma_f32 v180, v180, v6, v14
    v_fma_f32 v181, v181, v6, v14
    v_fma_f32 v182, v182, v6, v14
    v_fma_f32 v183, v183, v6, v14
    v_exp_f32 v48, v176 clamp
    v_exp_f32 v49, v177 clamp
    v_exp_f32 v50, v178 clamp
    v_exp_f32 v51, v179 clamp
    v_exp_f32 v52, v180 clamp
    v_exp_f32 v53, v181 clamp
    v_exp_f32 v54, v182 clamp
    v_exp_f32 v55, v183 clamp
    v_max_f32 v176, v176, v14
    v_max_f32 v177, v177, v14
    v_max_f32 v178, v178, v14
    v_max_f32 v179, v179, v14
    v_max_f32 v180, v180, v14
    v_max_f32 v181, v181, v14
    v_max_f32 v182, v182, v14
    v_max_f32 v183, v183, v14
    v_fmac_f32 v48, s68, v176
    v_fmac_f32 v49, s68, v177
    v_fmac_f32 v50, s68, v178
    v_fmac_f32 v51, s68, v179
    v_fmac_f32 v52, s68, v180
    v_fmac_f32 v53, s68, v181
    v_fmac_f32 v54, s68, v182
    v_fmac_f32 v55, s68, v183
    v_mul_f32 v184, v184, v3
    v_mul_f32 v185, v185, v3
    v_mul_f32 v186, v186, v3
    v_mul_f32 v187, v187, v3
    v_mul_f32 v188, v188, v3
    v_mul_f32 v189, v189, v3
    v_mul_f32 v190, v190, v3
    v_mul_f32 v191, v191, v3
    v_cvt_pk_bf16_f32 v176, v48, v49
    v_cvt_pk_bf16_f32 v177, v50, v51
    v_cvt_pk_bf16_f32 v178, v52, v53
    v_cvt_pk_bf16_f32 v179, v54, v55
    v_cvt_pk_bf16_f32 v180, v184, v185
    v_cvt_pk_bf16_f32 v181, v186, v187
    v_cvt_pk_bf16_f32 v182, v188, v189
    v_cvt_pk_bf16_f32 v183, v190, v191
    ds_write_b128 v12, v[176:179] offset:32
    ds_write_b128 v12, v[180:183] offset:21536
    v_fma_f32 v192, v192, v6, v14
    v_fma_f32 v193, v193, v6, v14
    v_fma_f32 v194, v194, v6, v14
    v_fma_f32 v195, v195, v6, v14
    v_fma_f32 v196, v196, v6, v14
    v_fma_f32 v197, v197, v6, v14
    v_fma_f32 v198, v198, v6, v14
    v_fma_f32 v199, v199, v6, v14
    v_exp_f32 v48, v192 clamp
    v_exp_f32 v49, v193 clamp
    v_exp_f32 v50, v194 clamp
    v_exp_f32 v51, v195 clamp
    v_exp_f32 v52, v196 clamp
    v_exp_f32 v53, v197 clamp
    v_exp_f32 v54, v198 clamp
    v_exp_f32 v55, v199 clamp
    v_max_f32 v192, v192, v14
    v_max_f32 v193, v193, v14
    v_max_f32 v194, v194, v14
    v_max_f32 v195, v195, v14
    v_max_f32 v196, v196, v14
    v_max_f32 v197, v197, v14
    v_max_f32 v198, v198, v14
    v_max_f32 v199, v199, v14
    v_fmac_f32 v48, s68, v192
    v_fmac_f32 v49, s68, v193
    v_fmac_f32 v50, s68, v194
    v_fmac_f32 v51, s68, v195
    v_fmac_f32 v52, s68, v196
    v_fmac_f32 v53, s68, v197
    v_fmac_f32 v54, s68, v198
    v_fmac_f32 v55, s68, v199
    v_mul_f32 v200, v200, v3
    v_mul_f32 v201, v201, v3
    v_mul_f32 v202, v202, v3
    v_mul_f32 v203, v203, v3
    v_mul_f32 v204, v204, v3
    v_mul_f32 v205, v205, v3
    v_mul_f32 v206, v206, v3
    v_mul_f32 v207, v207, v3
    v_cvt_pk_bf16_f32 v192, v48, v49
    v_cvt_pk_bf16_f32 v193, v50, v51
    v_cvt_pk_bf16_f32 v194, v52, v53
    v_cvt_pk_bf16_f32 v195, v54, v55
    v_cvt_pk_bf16_f32 v196, v200, v201
    v_cvt_pk_bf16_f32 v197, v202, v203
    v_cvt_pk_bf16_f32 v198, v204, v205
    v_cvt_pk_bf16_f32 v199, v206, v207
    ds_write_b128 v12, v[192:195] offset:64
    ds_write_b128 v12, v[196:199] offset:21568
    s_waitcnt lgkmcnt(0)
    s_barrier
    ds_read_b64_tr_b16 v[16:17], v9 offset:0
    ds_read_b64_tr_b16 v[18:19], v9 offset:672
    ds_read_b64_tr_b16 v[20:21], v9 offset:21504
    ds_read_b64_tr_b16 v[22:23], v9 offset:22176
    ds_read_b64_tr_b16 v[24:25], v9 offset:5376
    ds_read_b64_tr_b16 v[26:27], v9 offset:6048
    ds_read_b64_tr_b16 v[28:29], v9 offset:26880
    ds_read_b64_tr_b16 v[30:31], v9 offset:27552
    ds_read_b64_tr_b16 v[32:33], v9 offset:10752
    ds_read_b64_tr_b16 v[34:35], v9 offset:11424
    ds_read_b64_tr_b16 v[36:37], v9 offset:32256
    ds_read_b64_tr_b16 v[38:39], v9 offset:32928
    ds_read_b64_tr_b16 v[40:41], v9 offset:16128
    ds_read_b64_tr_b16 v[42:43], v9 offset:16800
    ds_read_b64_tr_b16 v[44:45], v9 offset:37632
    ds_read_b64_tr_b16 v[46:47], v9 offset:38304
    v_fma_f32 v208, v208, v8, v14
    v_fma_f32 v209, v209, v8, v14
    v_fma_f32 v210, v210, v8, v14
    v_fma_f32 v211, v211, v8, v14
    v_fma_f32 v212, v212, v8, v14
    v_fma_f32 v213, v213, v8, v14
    v_fma_f32 v214, v214, v8, v14
    v_fma_f32 v215, v215, v8, v14
    v_exp_f32 v48, v208 clamp
    v_exp_f32 v49, v209 clamp
    v_exp_f32 v50, v210 clamp
    v_exp_f32 v51, v211 clamp
    v_exp_f32 v52, v212 clamp
    v_exp_f32 v53, v213 clamp
    v_exp_f32 v54, v214 clamp
    v_exp_f32 v55, v215 clamp
    v_max_f32 v208, v208, v14
    v_max_f32 v209, v209, v14
    v_max_f32 v210, v210, v14
    v_max_f32 v211, v211, v14
    v_max_f32 v212, v212, v14
    v_max_f32 v213, v213, v14
    v_max_f32 v214, v214, v14
    v_max_f32 v215, v215, v14
    v_fmac_f32 v48, s68, v208
    v_fmac_f32 v49, s68, v209
    v_fmac_f32 v50, s68, v210
    v_fmac_f32 v51, s68, v211
    v_fmac_f32 v52, s68, v212
    v_fmac_f32 v53, s68, v213
    v_fmac_f32 v54, s68, v214
    v_fmac_f32 v55, s68, v215
    v_mul_f32 v216, v216, v5
    v_mul_f32 v217, v217, v5
    v_mul_f32 v218, v218, v5
    v_mul_f32 v219, v219, v5
    v_mul_f32 v220, v220, v5
    v_mul_f32 v221, v221, v5
    v_mul_f32 v222, v222, v5
    v_mul_f32 v223, v223, v5
    v_cvt_pk_bf16_f32 v208, v48, v49
    v_cvt_pk_bf16_f32 v209, v50, v51
    v_cvt_pk_bf16_f32 v210, v52, v53
    v_cvt_pk_bf16_f32 v211, v54, v55
    v_cvt_pk_bf16_f32 v212, v216, v217
    v_cvt_pk_bf16_f32 v213, v218, v219
    v_cvt_pk_bf16_f32 v214, v220, v221
    v_cvt_pk_bf16_f32 v215, v222, v223
    s_waitcnt lgkmcnt(0)
    v_mfma_f32_32x32x16_bf16 v[160:175], v[16:19], v[20:23], 0
    v_mfma_f32_32x32x16_bf16 v[176:191], v[16:19], v[88:91], 0
    v_mfma_f32_32x32x16_bf16 v[160:175], v[24:27], v[28:31], v[160:175]
    v_mfma_f32_32x32x16_bf16 v[176:191], v[24:27], v[88:91], v[176:191]
    v_mfma_f32_32x32x16_bf16 v[160:175], v[32:35], v[36:39], v[160:175]
    v_mfma_f32_32x32x16_bf16 v[176:191], v[32:35], v[88:91], v[176:191]
    v_mfma_f32_32x32x16_bf16 v[160:175], v[40:43], v[44:47], v[160:175]
    v_mfma_f32_32x32x16_bf16 v[176:191], v[40:43], v[88:91], v[176:191]
    v_fma_f32 v224, v224, v8, v14
    v_fma_f32 v225, v225, v8, v14
    v_fma_f32 v226, v226, v8, v14
    v_fma_f32 v227, v227, v8, v14
    v_fma_f32 v228, v228, v8, v14
    v_fma_f32 v229, v229, v8, v14
    v_fma_f32 v230, v230, v8, v14
    v_fma_f32 v231, v231, v8, v14
    v_exp_f32 v48, v224 clamp
    v_exp_f32 v49, v225 clamp
    v_exp_f32 v50, v226 clamp
    v_exp_f32 v51, v227 clamp
    v_exp_f32 v52, v228 clamp
    v_exp_f32 v53, v229 clamp
    v_exp_f32 v54, v230 clamp
    v_exp_f32 v55, v231 clamp
    v_max_f32 v224, v224, v14
    v_max_f32 v225, v225, v14
    v_max_f32 v226, v226, v14
    v_max_f32 v227, v227, v14
    v_max_f32 v228, v228, v14
    v_max_f32 v229, v229, v14
    v_max_f32 v230, v230, v14
    v_max_f32 v231, v231, v14
    v_fmac_f32 v48, s68, v224
    v_fmac_f32 v49, s68, v225
    v_fmac_f32 v50, s68, v226
    v_fmac_f32 v51, s68, v227
    v_fmac_f32 v52, s68, v228
    v_fmac_f32 v53, s68, v229
    v_fmac_f32 v54, s68, v230
    v_fmac_f32 v55, s68, v231
    v_mul_f32 v232, v232, v5
    v_mul_f32 v233, v233, v5
    v_mul_f32 v234, v234, v5
    v_mul_f32 v235, v235, v5
    v_mul_f32 v236, v236, v5
    v_mul_f32 v237, v237, v5
    v_mul_f32 v238, v238, v5
    v_mul_f32 v239, v239, v5
    v_cvt_pk_bf16_f32 v224, v48, v49
    v_cvt_pk_bf16_f32 v225, v50, v51
    v_cvt_pk_bf16_f32 v226, v52, v53
    v_cvt_pk_bf16_f32 v227, v54, v55
    v_cvt_pk_bf16_f32 v228, v232, v233
    v_cvt_pk_bf16_f32 v229, v234, v235
    v_cvt_pk_bf16_f32 v230, v236, v237
    v_cvt_pk_bf16_f32 v231, v238, v239
    v_fma_f32 v240, v240, v8, v14
    v_fma_f32 v241, v241, v8, v14
    v_fma_f32 v242, v242, v8, v14
    v_fma_f32 v243, v243, v8, v14
    v_fma_f32 v244, v244, v8, v14
    v_fma_f32 v245, v245, v8, v14
    v_fma_f32 v246, v246, v8, v14
    v_fma_f32 v247, v247, v8, v14
    v_exp_f32 v48, v240 clamp
    v_exp_f32 v49, v241 clamp
    v_exp_f32 v50, v242 clamp
    v_exp_f32 v51, v243 clamp
    v_exp_f32 v52, v244 clamp
    v_exp_f32 v53, v245 clamp
    v_exp_f32 v54, v246 clamp
    v_exp_f32 v55, v247 clamp
    v_max_f32 v240, v240, v14
    v_max_f32 v241, v241, v14
    v_max_f32 v242, v242, v14
    v_max_f32 v243, v243, v14
    v_max_f32 v244, v244, v14
    v_max_f32 v245, v245, v14
    v_max_f32 v246, v246, v14
    v_max_f32 v247, v247, v14
    v_fmac_f32 v48, s68, v240
    v_fmac_f32 v49, s68, v241
    v_fmac_f32 v50, s68, v242
    v_fmac_f32 v51, s68, v243
    v_fmac_f32 v52, s68, v244
    v_fmac_f32 v53, s68, v245
    v_fmac_f32 v54, s68, v246
    v_fmac_f32 v55, s68, v247
    v_mul_f32 v248, v248, v5
    v_mul_f32 v249, v249, v5
    v_mul_f32 v250, v250, v5
    v_mul_f32 v251, v251, v5
    v_mul_f32 v252, v252, v5
    v_mul_f32 v253, v253, v5
    v_mul_f32 v254, v254, v5
    v_mul_f32 v255, v255, v5
    v_cvt_pk_bf16_f32 v240, v48, v49
    v_cvt_pk_bf16_f32 v241, v50, v51
    v_cvt_pk_bf16_f32 v242, v52, v53
    v_cvt_pk_bf16_f32 v243, v54, v55
    v_cvt_pk_bf16_f32 v244, v248, v249
    v_cvt_pk_bf16_f32 v245, v250, v251
    v_cvt_pk_bf16_f32 v246, v252, v253
    v_cvt_pk_bf16_f32 v247, v254, v255
    s_barrier
    ds_write_b128 v12, v[208:211] offset:0
    ds_write_b128 v12, v[212:215] offset:21504
    ds_write_b128 v12, v[224:227] offset:32
    ds_write_b128 v12, v[228:231] offset:21536
    ds_write_b128 v12, v[240:243] offset:64
    ds_write_b128 v12, v[244:247] offset:21568
    s_waitcnt lgkmcnt(0)
    s_barrier
    ds_read_b64_tr_b16 v[56:57], v9 offset:0
    ds_read_b64_tr_b16 v[58:59], v9 offset:672
    ds_read_b64_tr_b16 v[60:61], v9 offset:21504
    ds_read_b64_tr_b16 v[62:63], v9 offset:22176
    ds_read_b64_tr_b16 v[64:65], v9 offset:5376
    ds_read_b64_tr_b16 v[66:67], v9 offset:6048
    ds_read_b64_tr_b16 v[68:69], v9 offset:26880
    ds_read_b64_tr_b16 v[70:71], v9 offset:27552
    ds_read_b64_tr_b16 v[72:73], v9 offset:10752
    ds_read_b64_tr_b16 v[74:75], v9 offset:11424
    ds_read_b64_tr_b16 v[76:77], v9 offset:32256
    ds_read_b64_tr_b16 v[78:79], v9 offset:32928
    ds_read_b64_tr_b16 v[80:81], v9 offset:16128
    ds_read_b64_tr_b16 v[82:83], v9 offset:16800
    ds_read_b64_tr_b16 v[84:85], v9 offset:37632
    ds_read_b64_tr_b16 v[86:87], v9 offset:38304
    v_and_b32 v8, 31, v1
    v_lshrrev_b32 v13, 5, v1
    v_mul_u32_u24 v10, 80, v8
    s_lshl_b32 s55, s23, 3
    s_add_u32 s55, s55, s3
    s_lshl_b32 s55, s55, 4
    s_add_u32 s55, s55, s20
    s_mul_i32 s55, s55, 1792
    s_add_u32 s55, s55, 15728640
    v_cmp_eq_u32 vcc, 20, v8
    v_lshl_add_u32 v10, v13, 4, v10
    s_waitcnt lgkmcnt(12)
    v_mfma_f32_32x32x16_bf16 v[160:175], v[56:59], v[60:63], v[160:175]
    v_mfma_f32_32x32x16_bf16 v[176:191], v[56:59], v[88:91], v[176:191]
    s_waitcnt lgkmcnt(8)
    v_mfma_f32_32x32x16_bf16 v[160:175], v[64:67], v[68:71], v[160:175]
    v_mfma_f32_32x32x16_bf16 v[176:191], v[64:67], v[88:91], v[176:191]
    s_waitcnt lgkmcnt(4)
    v_mfma_f32_32x32x16_bf16 v[160:175], v[72:75], v[76:79], v[160:175]
    v_mfma_f32_32x32x16_bf16 v[176:191], v[72:75], v[88:91], v[176:191]
    s_waitcnt lgkmcnt(0)
    v_mfma_f32_32x32x16_bf16 v[160:175], v[80:83], v[84:87], v[160:175]
    v_mfma_f32_32x32x16_bf16 v[176:191], v[80:83], v[88:91], v[176:191]
    s_nop 7
    s_nop 3
    v_cndmask_b32 v160, v160, v176, vcc
    v_cndmask_b32 v161, v161, v177, vcc
    v_cndmask_b32 v162, v162, v178, vcc
    v_cndmask_b32 v163, v163, v179, vcc
    v_cndmask_b32 v164, v164, v180, vcc
    v_cndmask_b32 v165, v165, v181, vcc
    v_cndmask_b32 v166, v166, v182, vcc
    v_cndmask_b32 v167, v167, v183, vcc
    v_cndmask_b32 v168, v168, v184, vcc
    v_cndmask_b32 v169, v169, v185, vcc
    v_cndmask_b32 v170, v170, v186, vcc
    v_cndmask_b32 v171, v171, v187, vcc
    v_or_b32 v160, 1, v160
    v_or_b32 v164, 1, v164
    v_or_b32 v168, 1, v168
    v_cmp_ge_u32 vcc, 20, v8
    s_and_saveexec_b64 s[56:57], vcc
    buffer_store_dwordx4 v[160:163], v10, s[12:15], s55 offen sc1
    buffer_store_dwordx4 v[164:167], v10, s[12:15], s55 offen offset:32 sc1
    v_cmp_eq_u32 vcc, 0, v13
    s_and_b64 exec, exec, vcc
    buffer_store_dwordx4 v[168:171], v10, s[12:15], s55 offen offset:64 sc1
    s_mov_b64 exec, s[56:57]
    s_waitcnt vmcnt(3)
    s_barrier
    s_branch L_p1_posted
L_b2:
    ds_read_b128 v[136:139], v104 offset:0
    ds_read_b128 v[140:143], v104 offset:4096
    ds_read_b64_tr_b16 v[112:113], v100 offset:0
    ds_read_b64_tr_b16 v[114:115], v100 offset:1536
    ds_read_b64_tr_b16 v[116:117], v101 offset:0
    ds_read_b64_tr_b16 v[118:119], v101 offset:1536
    s_waitcnt lgkmcnt(2)
    v_mfma_f32_32x32x16_bf16 v[160:175], v[112:115], v[136:139], v[160:175]
    ds_read_b128 v[144:147], v105 offset:0
    ds_read_b128 v[148:151], v105 offset:4096
    ds_read_b64_tr_b16 v[124:125], v100 offset:6144
    v_mfma_f32_32x32x16_bf16 v[208:223], v[112:115], v[140:143], v[208:223]
    ds_read_b64_tr_b16 v[126:127], v100 offset:7680
    ds_read_b64_tr_b16 v[128:129], v101 offset:6144
    ds_read_b64_tr_b16 v[130:131], v101 offset:7680
    s_waitcnt lgkmcnt(6)
    v_mfma_f32_32x32x16_bf16 v[176:191], v[116:119], v[136:139], v[176:191]
    v_mfma_f32_32x32x16_bf16 v[224:239], v[116:119], v[140:143], v[224:239]
    s_cmp_lg_u32 s57, 0
    s_cbranch_scc1 L_cs_29
    v_dot2c_f32_bf16 v92, s52, v112
    v_dot2c_f32_bf16 v92, s52, v113
    v_dot2c_f32_bf16 v92, s52, v114
    v_dot2c_f32_bf16 v92, s52, v115
    v_dot2c_f32_bf16 v93, s52, v116
    v_dot2c_f32_bf16 v93, s52, v117
    v_dot2c_f32_bf16 v93, s52, v118
    v_dot2c_f32_bf16 v93, s52, v119
L_cs_29:
    s_waitcnt vmcnt(10) lgkmcnt(0)
    s_barrier
    v_mfma_f32_32x32x16_bf16 v[160:175], v[124:127], v[144:147], v[160:175]
    ds_read_b128 v[136:139], v106 offset:0
    ds_read_b128 v[140:143], v106 offset:4096
    ds_read_b64_tr_b16 v[112:113], v100 offset:24832
    s_add_u32 m0, s26, 0
    s_nop 0
    buffer_load_dwordx4 v108, s[4:7], s24 offen offset:0 lds
    v_mfma_f32_32x32x16_bf16 v[208:223], v[124:127], v[148:151], v[208:223]
    ds_read_b64_tr_b16 v[114:115], v100 offset:26368
    ds_read_b64_tr_b16 v[116:117], v101 offset:24832
    ds_read_b64_tr_b16 v[118:119], v101 offset:26368
    buffer_load_dwordx4 v109, s[4:7], s24 offen offset:1024 lds
    v_mfma_f32_32x32x16_bf16 v[176:191], v[128:131], v[144:147], v[176:191]
    v_mfma_f32_32x32x16_bf16 v[224:239], v[128:131], v[148:151], v[224:239]
    s_cmp_lg_u32 s57, 0
    s_cbranch_scc1 L_cs_30
    v_dot2c_f32_bf16 v92, s52, v124
    v_dot2c_f32_bf16 v92, s52, v125
    v_dot2c_f32_bf16 v92, s52, v126
    v_dot2c_f32_bf16 v92, s52, v127
    v_dot2c_f32_bf16 v93, s52, v128
    v_dot2c_f32_bf16 v93, s52, v129
    v_dot2c_f32_bf16 v93, s52, v130
    v_dot2c_f32_bf16 v93, s52, v131
L_cs_30:
    s_waitcnt lgkmcnt(2)
    v_mfma_f32_32x32x16_bf16 v[160:175], v[112:115], v[136:139], v[160:175]
    ds_read_b128 v[144:147], v107 offset:0
    ds_read_b128 v[148:151], v107 offset:4096
    ds_read_b64_tr_b16 v[124:125], v100 offset:30976
    s_add_u32 m0, s26, 0
    s_nop 0
    buffer_load_dwordx4 v110, s[4:7], s24 offen offset:2048 lds
    s_add_u32 s24, s24, s25
    v_mfma_f32_32x32x16_bf16 v[208:223], v[112:115], v[140:143], v[208:223]
    ds_read_b64_tr_b16 v[126:127], v100 offset:32512
    ds_read_b64_tr_b16 v[128:129], v101 offset:30976
    ds_read_b64_tr_b16 v[130:131], v101 offset:32512
    s_add_u32 m0, s28, 33792
    s_nop 0
    buffer_load_dwordx4 v99, s[8:11], s53 offen lds
    s_waitcnt lgkmcnt(6)
    v_mfma_f32_32x32x16_bf16 v[176:191], v[116:119], v[136:139], v[176:191]
    s_cmp_eq_u32 s29, 3
    s_cselect_b32 s49, -1152, s54
    s_add_u32 s53, s53, s49
    v_mfma_f32_32x32x16_bf16 v[224:239], v[116:119], v[140:143], v[224:239]
    s_cmp_lg_u32 s57, 0
    s_cbranch_scc1 L_cs_31
    v_dot2c_f32_bf16 v92, s52, v112
    v_dot2c_f32_bf16 v92, s52, v113
    v_dot2c_f32_bf16 v92, s52, v114
    v_dot2c_f32_bf16 v92, s52, v115
    v_dot2c_f32_bf16 v93, s52, v116
    v_dot2c_f32_bf16 v93, s52, v117
    v_dot2c_f32_bf16 v93, s52, v118
    v_dot2c_f32_bf16 v93, s52, v119
L_cs_31:
    s_waitcnt vmcnt(9) lgkmcnt(0)
    s_barrier
    v_mfma_f32_32x32x16_bf16 v[160:175], v[124:127], v[144:147], v[160:175]
    ds_read_b128 v[136:139], v104 offset:16384
    ds_read_b128 v[140:143], v104 offset:20480
    ds_read_b64_tr_b16 v[112:113], v152 offset:0
    s_add_u32 m0, s26, 24832
    s_nop 0
    buffer_load_dwordx4 v108, s[4:7], s24 offen offset:0 lds
    v_mfma_f32_32x32x16_bf16 v[208:223], v[124:127], v[148:151], v[208:223]
    ds_read_b64_tr_b16 v[114:115], v152 offset:1536
    ds_read_b64_tr_b16 v[116:117], v153 offset:0
    ds_read_b64_tr_b16 v[118:119], v153 offset:1536
    buffer_load_dwordx4 v109, s[4:7], s24 offen offset:1024 lds
    v_mfma_f32_32x32x16_bf16 v[176:191], v[128:131], v[144:147], v[176:191]
    v_mfma_f32_32x32x16_bf16 v[224:239], v[128:131], v[148:151], v[224:239]
    s_cmp_lg_u32 s57, 0
    s_cbranch_scc1 L_cs_32
    v_dot2c_f32_bf16 v92, s52, v124
    v_dot2c_f32_bf16 v92, s52, v125
    v_dot2c_f32_bf16 v92, s52, v126
    v_dot2c_f32_bf16 v92, s52, v127
    v_dot2c_f32_bf16 v93, s52, v128
    v_dot2c_f32_bf16 v93, s52, v129
    v_dot2c_f32_bf16 v93, s52, v130
    v_dot2c_f32_bf16 v93, s52, v131
L_cs_32:
    s_waitcnt lgkmcnt(2)
    v_mfma_f32_32x32x16_bf16 v[160:175], v[112:115], v[136:139], v[160:175]
    ds_read_b128 v[144:147], v105 offset:16384
    ds_read_b128 v[148:151], v105 offset:20480
    ds_read_b64_tr_b16 v[124:125], v152 offset:6144
    s_add_u32 m0, s26, 24832
    s_nop 0
    buffer_load_dwordx4 v110, s[4:7], s24 offen offset:2048 lds
    s_cmp_eq_u32 s29, 3
    s_cselect_b32 s49, s48, s25
    s_add_u32 s24, s24, s49
    v_mfma_f32_32x32x16_bf16 v[208:223], v[112:115], v[140:143], v[208:223]
    ds_read_b64_tr_b16 v[126:127], v152 offset:7680
    ds_read_b64_tr_b16 v[128:129], v153 offset:6144
    ds_read_b64_tr_b16 v[130:131], v153 offset:7680
    s_add_u32 m0, s28, 0
    s_nop 0
    buffer_load_dwordx4 v98, s[8:11], s53 offen lds
    s_waitcnt lgkmcnt(6)
    v_mfma_f32_32x32x16_bf16 v[176:191], v[116:119], v[136:139], v[176:191]
    v_mfma_f32_32x32x16_bf16 v[224:239], v[116:119], v[140:143], v[224:239]
    s_cmp_lg_u32 s57, 1
    s_cbranch_scc1 L_cs_33
    v_dot2c_f32_bf16 v92, s52, v112
    v_dot2c_f32_bf16 v92, s52, v113
    v_dot2c_f32_bf16 v92, s52, v114
    v_dot2c_f32_bf16 v92, s52, v115
    v_dot2c_f32_bf16 v93, s52, v116
    v_dot2c_f32_bf16 v93, s52, v117
    v_dot2c_f32_bf16 v93, s52, v118
    v_dot2c_f32_bf16 v93, s52, v119
L_cs_33:
    s_waitcnt vmcnt(8) lgkmcnt(0)
    s_barrier
    v_mfma_f32_32x32x16_bf16 v[160:175], v[124:127], v[144:147], v[160:175]
    ds_read_b128 v[136:139], v106 offset:16384
    ds_read_b128 v[140:143], v106 offset:20480
    ds_read_b64_tr_b16 v[112:113], v152 offset:24832
    s_add_u32 m0, s26, 49664
    s_nop 0
    buffer_load_dwordx4 v108, s[4:7], s24 offen offset:0 lds
    v_mfma_f32_32x32x16_bf16 v[208:223], v[124:127], v[148:151], v[208:223]
    ds_read_b64_tr_b16 v[114:115], v152 offset:26368
    ds_read_b64_tr_b16 v[116:117], v153 offset:24832
    ds_read_b64_tr_b16 v[118:119], v153 offset:26368
    buffer_load_dwordx4 v109, s[4:7], s24 offen offset:1024 lds
    v_mfma_f32_32x32x16_bf16 v[176:191], v[128:131], v[144:147], v[176:191]
    s_cmp_lg_u32 s57, 0
    s_cbranch_scc1 L_pub2_0_34
    v_mov_b32 v9, v92
    s_nop 1
    v_permlane32_swap_b32 v92, v9
    s_nop 1
    v_add_f32 v9, v9, v92
    v_or_b32 v12, 1, v9
    v_mov_b32 v9, v93
    s_nop 1
    v_permlane32_swap_b32 v93, v9
    s_nop 1
    v_add_f32 v9, v9, v93
    v_or_b32 v13, 1, v9
    v_mov_b32 v9, v94
    s_nop 1
    v_permlane32_swap_b32 v94, v9
    s_nop 1
    v_add_f32 v9, v9, v94
    v_or_b32 v14, 1, v9
    v_and_b32 v6, 31, v1
    v_lshlrev_b32 v6, 4, v6
    buffer_store_dwordx3 v[12:14], v6, s[12:15], s27 offen sc1
L_pub2_0_34:
    v_mfma_f32_32x32x16_bf16 v[224:239], v[128:131], v[148:151], v[224:239]
    s_cmp_lg_u32 s57, 1
    s_cbranch_scc1 L_cs_35
    v_dot2c_f32_bf16 v92, s52, v124
    v_dot2c_f32_bf16 v92, s52, v125
    v_dot2c_f32_bf16 v92, s52, v126
    v_dot2c_f32_bf16 v92, s52, v127
    v_dot2c_f32_bf16 v93, s52, v128
    v_dot2c_f32_bf16 v93, s52, v129
    v_dot2c_f32_bf16 v93, s52, v130
    v_dot2c_f32_bf16 v93, s52, v131
L_cs_35:
    s_waitcnt lgkmcnt(2)
    v_mfma_f32_32x32x16_bf16 v[160:175], v[112:115], v[136:139], v[160:175]
    ds_read_b128 v[144:147], v107 offset:16384
    ds_read_b128 v[148:151], v107 offset:20480
    ds_read_b64_tr_b16 v[124:125], v152 offset:30976
    s_add_u32 m0, s26, 49664
    s_nop 0
    buffer_load_dwordx4 v110, s[4:7], s24 offen offset:2048 lds
    s_add_u32 s24, s24, s25
    v_mfma_f32_32x32x16_bf16 v[208:223], v[112:115], v[140:143], v[208:223]
    ds_read_b64_tr_b16 v[126:127], v152 offset:32512
    ds_read_b64_tr_b16 v[128:129], v153 offset:30976
    ds_read_b64_tr_b16 v[130:131], v153 offset:32512
    s_add_u32 m0, s28, 1024
    s_nop 0
    buffer_load_dwordx4 v99, s[8:11], s53 offen lds
    s_waitcnt lgkmcnt(6)
    v_mfma_f32_32x32x16_bf16 v[176:191], v[116:119], v[136:139], v[176:191]
    s_cmp_eq_u32 s29, 4
    s_cselect_b32 s49, -1152, s54
    s_add_u32 s53, s53, s49
    v_mfma_f32_32x32x16_bf16 v[224:239], v[116:119], v[140:143], v[224:239]
    s_cmp_lg_u32 s57, 1
    s_cbranch_scc1 L_cs_36
    v_dot2c_f32_bf16 v92, s52, v112
    v_dot2c_f32_bf16 v92, s52, v113
    v_dot2c_f32_bf16 v92, s52, v114
    v_dot2c_f32_bf16 v92, s52, v115
    v_dot2c_f32_bf16 v93, s52, v116
    v_dot2c_f32_bf16 v93, s52, v117
    v_dot2c_f32_bf16 v93, s52, v118
    v_dot2c_f32_bf16 v93, s52, v119
L_cs_36:
    s_waitcnt vmcnt(8) lgkmcnt(0)
    s_barrier
    v_mfma_f32_32x32x16_bf16 v[160:175], v[124:127], v[144:147], v[160:175]
    ds_read_b128 v[136:139], v104 offset:32768
    ds_read_b128 v[140:143], v104 offset:36864
    ds_read_b64_tr_b16 v[112:113], v100 offset:0
    s_add_u32 m0, s26, 74496
    s_nop 0
    buffer_load_dwordx4 v108, s[4:7], s24 offen offset:0 lds
    v_mfma_f32_32x32x16_bf16 v[208:223], v[124:127], v[148:151], v[208:223]
    ds_read_b64_tr_b16 v[114:115], v100 offset:1536
    ds_read_b64_tr_b16 v[116:117], v101 offset:0
    ds_read_b64_tr_b16 v[118:119], v101 offset:1536
    buffer_load_dwordx4 v109, s[4:7], s24 offen offset:1024 lds
    v_mfma_f32_32x32x16_bf16 v[176:191], v[128:131], v[144:147], v[176:191]
    v_mfma_f32_32x32x16_bf16 v[224:239], v[128:131], v[148:151], v[224:239]
    s_cmp_lg_u32 s57, 1
    s_cbranch_scc1 L_cs_37
    v_dot2c_f32_bf16 v92, s52, v124
    v_dot2c_f32_bf16 v92, s52, v125
    v_dot2c_f32_bf16 v92, s52, v126
    v_dot2c_f32_bf16 v92, s52, v127
    v_dot2c_f32_bf16 v93, s52, v128
    v_dot2c_f32_bf16 v93, s52, v129
    v_dot2c_f32_bf16 v93, s52, v130
    v_dot2c_f32_bf16 v93, s52, v131
L_cs_37:
    s_waitcnt lgkmcnt(2)
    v_mfma_f32_32x32x16_bf16 v[160:175], v[112:115], v[136:139], v[160:175]
    ds_read_b128 v[144:147], v105 offset:32768
    ds_read_b128 v[148:151], v105 offset:36864
    ds_read_b64_tr_b16 v[124:125], v100 offset:6144
    s_add_u32 m0, s26, 74496
    s_nop 0
    buffer_load_dwordx4 v110, s[4:7], s24 offen offset:2048 lds
    s_cmp_eq_u32 s29, 4
    s_cselect_b32 s49, s48, s25
    s_add_u32 s24, s24, s49
    v_mfma_f32_32x32x16_bf16 v[208:223], v[112:115], v[140:143], v[208:223]
    ds_read_b64_tr_b16 v[126:127], v100 offset:7680
    ds_read_b64_tr_b16 v[128:129], v101 offset:6144
    ds_read_b64_tr_b16 v[130:131], v101 offset:7680
    s_add_u32 m0, s28, 16384
    s_nop 0
    buffer_load_dwordx4 v98, s[8:11], s53 offen lds
    s_waitcnt lgkmcnt(6)
    v_mfma_f32_32x32x16_bf16 v[176:191], v[116:119], v[136:139], v[176:191]
    v_mfma_f32_32x32x16_bf16 v[224:239], v[116:119], v[140:143], v[224:239]
    s_cmp_lg_u32 s57, 2
    s_cbranch_scc1 L_cs_38
    v_dot2c_f32_bf16 v92, s52, v112
    v_dot2c_f32_bf16 v92, s52, v113
    v_dot2c_f32_bf16 v92, s52, v114
    v_dot2c_f32_bf16 v92, s52, v115
    v_dot2c_f32_bf16 v93, s52, v116
    v_dot2c_f32_bf16 v93, s52, v117
    v_dot2c_f32_bf16 v93, s52, v118
    v_dot2c_f32_bf16 v93, s52, v119
L_cs_38:
    s_waitcnt vmcnt(9) lgkmcnt(0)
    s_barrier
    v_mfma_f32_32x32x16_bf16 v[160:175], v[124:127], v[144:147], v[160:175]
    ds_read_b128 v[136:139], v106 offset:32768
    ds_read_b128 v[140:143], v106 offset:36864
    ds_read_b64_tr_b16 v[112:113], v100 offset:24832
    s_add_u32 m0, s26, 0
    s_nop 0
    buffer_load_dwordx4 v108, s[4:7], s24 offen offset:0 lds
    v_mfma_f32_32x32x16_bf16 v[208:223], v[124:127], v[148:151], v[208:223]
    ds_read_b64_tr_b16 v[114:115], v100 offset:26368
    ds_read_b64_tr_b16 v[116:117], v101 offset:24832
    ds_read_b64_tr_b16 v[118:119], v101 offset:26368
    buffer_load_dwordx4 v109, s[4:7], s24 offen offset:1024 lds
    v_mfma_f32_32x32x16_bf16 v[176:191], v[128:131], v[144:147], v[176:191]
    s_cmp_lg_u32 s57, 1
    s_cbranch_scc1 L_pub2_1_39
    v_mov_b32 v9, v92
    s_nop 1
    v_permlane32_swap_b32 v92, v9
    s_nop 1
    v_add_f32 v9, v9, v92
    v_or_b32 v12, 1, v9
    v_mov_b32 v9, v93
    s_nop 1
    v_permlane32_swap_b32 v93, v9
    s_nop 1
    v_add_f32 v9, v9, v93
    v_or_b32 v13, 1, v9
    v_mov_b32 v9, v94
    s_nop 1
    v_permlane32_swap_b32 v94, v9
    s_nop 1
    v_add_f32 v9, v9, v94
    v_or_b32 v14, 1, v9
    v_and_b32 v6, 31, v1
    v_lshlrev_b32 v6, 4, v6
    buffer_store_dwordx3 v[12:14], v6, s[12:15], s27 offen sc1
L_pub2_1_39:
    v_mfma_f32_32x32x16_bf16 v[224:239], v[128:131], v[148:151], v[224:239]
    s_cmp_lg_u32 s57, 2
    s_cbranch_scc1 L_cs_40
    v_dot2c_f32_bf16 v92, s52, v124
    v_dot2c_f32_bf16 v92, s52, v125
    v_dot2c_f32_bf16 v92, s52, v126
    v_dot2c_f32_bf16 v92, s52, v127
    v_dot2c_f32_bf16 v93, s52, v128
    v_dot2c_f32_bf16 v93, s52, v129
    v_dot2c_f32_bf16 v93, s52, v130
    v_dot2c_f32_bf16 v93, s52, v131
L_cs_40:
    s_waitcnt lgkmcnt(2)
    v_mfma_f32_32x32x16_bf16 v[160:175], v[112:115], v[136:139], v[160:175]
    ds_read_b128 v[144:147], v107 offset:32768
    ds_read_b128 v[148:151], v107 offset:36864
    ds_read_b64_tr_b16 v[124:125], v100 offset:30976
    s_add_u32 m0, s26, 0
    s_nop 0
    buffer_load_dwordx4 v110, s[4:7], s24 offen offset:2048 lds
    s_add_u32 s24, s24, s25
    v_mfma_f32_32x32x16_bf16 v[208:223], v[112:115], v[140:143], v[208:223]
    ds_read_b64_tr_b16 v[126:127], v100 offset:32512
    ds_read_b64_tr_b16 v[128:129], v101 offset:30976
    ds_read_b64_tr_b16 v[130:131], v101 offset:32512
    s_add_u32 m0, s28, 17408
    s_nop 0
    buffer_load_dwordx4 v99, s[8:11], s53 offen lds
    s_waitcnt lgkmcnt(6)
    v_mfma_f32_32x32x16_bf16 v[176:191], v[116:119], v[136:139], v[176:191]
    s_cmp_eq_u32 s29, 5
    s_cselect_b32 s49, -1152, s54
    s_add_u32 s53, s53, s49
    v_mfma_f32_32x32x16_bf16 v[224:239], v[116:119], v[140:143], v[224:239]
    s_cmp_lg_u32 s57, 2
    s_cbranch_scc1 L_cs_41
    v_dot2c_f32_bf16 v92, s52, v112
    v_dot2c_f32_bf16 v92, s52, v113
    v_dot2c_f32_bf16 v92, s52, v114
    v_dot2c_f32_bf16 v92, s52, v115
    v_dot2c_f32_bf16 v93, s52, v116
    v_dot2c_f32_bf16 v93, s52, v117
    v_dot2c_f32_bf16 v93, s52, v118
    v_dot2c_f32_bf16 v93, s52, v119
L_cs_41:
    s_waitcnt vmcnt(8) lgkmcnt(0)
    s_barrier
    v_mfma_f32_32x32x16_bf16 v[160:175], v[124:127], v[144:147], v[160:175]
    ds_read_b128 v[136:139], v104 offset:0
    ds_read_b128 v[140:143], v104 offset:4096
    ds_read_b64_tr_b16 v[112:113], v152 offset:0
    s_add_u32 m0, s26, 24832
    s_nop 0
    buffer_load_dwordx4 v108, s[4:7], s24 offen offset:0 lds
    v_mfma_f32_32x32x16_bf16 v[208:223], v[124:127], v[148:151], v[208:223]
    ds_read_b64_tr_b16 v[114:115], v152 offset:1536
    ds_read_b64_tr_b16 v[116:117], v153 offset:0
    ds_read_b64_tr_b16 v[118:119], v153 offset:1536
    buffer_load_dwordx4 v109, s[4:7], s24 offen offset:1024 lds
    v_mfma_f32_32x32x16_bf16 v[176:191], v[128:131], v[144:147], v[176:191]
    v_mfma_f32_32x32x16_bf16 v[224:239], v[128:131], v[148:151], v[224:239]
    s_cmp_lg_u32 s57, 2
    s_cbranch_scc1 L_cs_42
    v_dot2c_f32_bf16 v92, s52, v124
    v_dot2c_f32_bf16 v92, s52, v125
    v_dot2c_f32_bf16 v92, s52, v126
    v_dot2c_f32_bf16 v92, s52, v127
    v_dot2c_f32_bf16 v93, s52, v128
    v_dot2c_f32_bf16 v93, s52, v129
    v_dot2c_f32_bf16 v93, s52, v130
    v_dot2c_f32_bf16 v93, s52, v131
L_cs_42:
    s_waitcnt lgkmcnt(2)
    v_mfma_f32_32x32x16_bf16 v[160:175], v[112:115], v[136:139], v[160:175]
    ds_read_b128 v[144:147], v105 offset:0
    ds_read_b128 v[148:151], v105 offset:4096
    ds_read_b64_tr_b16 v[124:125], v152 offset:6144
    s_add_u32 m0, s26, 24832
    s_nop 0
    buffer_load_dwordx4 v110, s[4:7], s24 offen offset:2048 lds
    s_cmp_eq_u32 s29, 5
    s_cselect_b32 s49, s48, s25
    s_add_u32 s24, s24, s49
    v_mfma_f32_32x32x16_bf16 v[208:223], v[112:115], v[140:143], v[208:223]
    ds_read_b64_tr_b16 v[126:127], v152 offset:7680
    ds_read_b64_tr_b16 v[128:129], v153 offset:6144
    ds_read_b64_tr_b16 v[130:131], v153 offset:7680
    s_add_u32 m0, s28, 32768
    s_nop 0
    buffer_load_dwordx4 v98, s[8:11], s53 offen lds
    s_waitcnt lgkmcnt(6)
    v_mfma_f32_32x32x16_bf16 v[176:191], v[116:119], v[136:139], v[176:191]
    v_mfma_f32_32x32x16_bf16 v[224:239], v[116:119], v[140:143], v[224:239]
    s_cmp_lg_u32 s57, 3
    s_cbranch_scc1 L_cs_43
    v_dot2c_f32_bf16 v92, s52, v112
    v_dot2c_f32_bf16 v92, s52, v113
    v_dot2c_f32_bf16 v92, s52, v114
    v_dot2c_f32_bf16 v92, s52, v115
    v_dot2c_f32_bf16 v93, s52, v116
    v_dot2c_f32_bf16 v93, s52, v117
    v_dot2c_f32_bf16 v93, s52, v118
    v_dot2c_f32_bf16 v93, s52, v119
L_cs_43:
    s_waitcnt vmcnt(9) lgkmcnt(0)
    s_barrier
    v_mfma_f32_32x32x16_bf16 v[160:175], v[124:127], v[144:147], v[160:175]
    ds_read_b128 v[136:139], v106 offset:0
    ds_read_b128 v[140:143], v106 offset:4096
    ds_read_b64_tr_b16 v[112:113], v152 offset:24832
    s_add_u32 m0, s26, 49664
    s_nop 0
    buffer_load_dwordx4 v108, s[4:7], s24 offen offset:0 lds
    v_mfma_f32_32x32x16_bf16 v[208:223], v[124:127], v[148:151], v[208:223]
    ds_read_b64_tr_b16 v[114:115], v152 offset:26368
    ds_read_b64_tr_b16 v[116:117], v153 offset:24832
    ds_read_b64_tr_b16 v[118:119], v153 offset:26368
    buffer_load_dwordx4 v109, s[4:7], s24 offen offset:1024 lds
    v_mfma_f32_32x32x16_bf16 v[176:191], v[128:131], v[144:147], v[176:191]
    s_cmp_lg_u32 s57, 2
    s_cbranch_scc1 L_pub2_2_44
    v_mov_b32 v9, v92
    s_nop 1
    v_permlane32_swap_b32 v92, v9
    s_nop 1
    v_add_f32 v9, v9, v92
    v_or_b32 v12, 1, v9
    v_mov_b32 v9, v93
    s_nop 1
    v_permlane32_swap_b32 v93, v9
    s_nop 1
    v_add_f32 v9, v9, v93
    v_or_b32 v13, 1, v9
    v_mov_b32 v9, v94
    s_nop 1
    v_permlane32_swap_b32 v94, v9
    s_nop 1
    v_add_f32 v9, v9, v94
    v_or_b32 v14, 1, v9
    v_and_b32 v6, 31, v1
    v_lshlrev_b32 v6, 4, v6
    buffer_store_dwordx3 v[12:14], v6, s[12:15], s27 offen sc1
L_pub2_2_44:
    v_mfma_f32_32x32x16_bf16 v[224:239], v[128:131], v[148:151], v[224:239]
    s_cmp_lg_u32 s57, 3
    s_cbranch_scc1 L_cs_45
    v_dot2c_f32_bf16 v92, s52, v124
    v_dot2c_f32_bf16 v92, s52, v125
    v_dot2c_f32_bf16 v92, s52, v126
    v_dot2c_f32_bf16 v92, s52, v127
    v_dot2c_f32_bf16 v93, s52, v128
    v_dot2c_f32_bf16 v93, s52, v129
    v_dot2c_f32_bf16 v93, s52, v130
    v_dot2c_f32_bf16 v93, s52, v131
L_cs_45:
    s_waitcnt lgkmcnt(2)
    v_mfma_f32_32x32x16_bf16 v[160:175], v[112:115], v[136:139], v[160:175]
    ds_read_b128 v[144:147], v107 offset:0
    ds_read_b128 v[148:151], v107 offset:4096
    ds_read_b64_tr_b16 v[124:125], v152 offset:30976
    s_add_u32 m0, s26, 49664
    s_nop 0
    buffer_load_dwordx4 v110, s[4:7], s24 offen offset:2048 lds
    s_add_u32 s24, s24, s25
    v_mfma_f32_32x32x16_bf16 v[208:223], v[112:115], v[140:143], v[208:223]
    ds_read_b64_tr_b16 v[126:127], v152 offset:32512
    ds_read_b64_tr_b16 v[128:129], v153 offset:30976
    ds_read_b64_tr_b16 v[130:131], v153 offset:32512
    s_add_u32 m0, s28, 33792
    s_nop 0
    buffer_load_dwordx4 v99, s[8:11], s53 offen lds
    s_waitcnt lgkmcnt(6)
    v_mfma_f32_32x32x16_bf16 v[176:191], v[116:119], v[136:139], v[176:191]
    s_cmp_eq_u32 s29, 6
    s_cselect_b32 s49, -1152, s54
    s_add_u32 s53, s53, s49
    v_mfma_f32_32x32x16_bf16 v[224:239], v[116:119], v[140:143], v[224:239]
    s_cmp_lg_u32 s57, 3
    s_cbranch_scc1 L_cs_46
    v_dot2c_f32_bf16 v92, s52, v112
    v_dot2c_f32_bf16 v92, s52, v113
    v_dot2c_f32_bf16 v92, s52, v114
    v_dot2c_f32_bf16 v92, s52, v115
    v_dot2c_f32_bf16 v93, s52, v116
    v_dot2c_f32_bf16 v93, s52, v117
    v_dot2c_f32_bf16 v93, s52, v118
    v_dot2c_f32_bf16 v93, s52, v119
L_cs_46:
    s_waitcnt vmcnt(8) lgkmcnt(0)
    s_barrier
    v_mfma_f32_32x32x16_bf16 v[160:175], v[124:127], v[144:147], v[160:175]
    ds_read_b128 v[136:139], v104 offset:16384
    ds_read_b128 v[140:143], v104 offset:20480
    ds_read_b64_tr_b16 v[112:113], v100 offset:0
    s_add_u32 m0, s26, 74496
    s_nop 0
    buffer_load_dwordx4 v108, s[4:7], s24 offen offset:0 lds
    v_mfma_f32_32x32x16_bf16 v[208:223], v[124:127], v[148:151], v[208:223]
    ds_read_b64_tr_b16 v[114:115], v100 offset:1536
    ds_read_b64_tr_b16 v[116:117], v101 offset:0
    ds_read_b64_tr_b16 v[118:119], v101 offset:1536
    buffer_load_dwordx4 v109, s[4:7], s24 offen offset:1024 lds
    v_mfma_f32_32x32x16_bf16 v[176:191], v[128:131], v[144:147], v[176:191]
    v_mfma_f32_32x32x16_bf16 v[224:239], v[128:131], v[148:151], v[224:239]
    s_cmp_lg_u32 s57, 3
    s_cbranch_scc1 L_cs_47
    v_dot2c_f32_bf16 v92, s52, v124
    v_dot2c_f32_bf16 v92, s52, v125
    v_dot2c_f32_bf16 v92, s52, v126
    v_dot2c_f32_bf16 v92, s52, v127
    v_dot2c_f32_bf16 v93, s52, v128
    v_dot2c_f32_bf16 v93, s52, v129
    v_dot2c_f32_bf16 v93, s52, v130
    v_dot2c_f32_bf16 v93, s52, v131
L_cs_47:
    s_waitcnt lgkmcnt(2)
    v_mfma_f32_32x32x16_bf16 v[160:175], v[112:115], v[136:139], v[160:175]
    ds_read_b128 v[144:147], v105 offset:16384
    ds_read_b128 v[148:151], v105 offset:20480
    ds_read_b64_tr_b16 v[124:125], v100 offset:6144
    s_add_u32 m0, s26, 74496
    s_nop 0
    buffer_load_dwordx4 v110, s[4:7], s24 offen offset:2048 lds
    s_cmp_eq_u32 s29, 6
    s_cselect_b32 s49, s48, s25
    s_add_u32 s24, s24, s49
    v_mfma_f32_32x32x16_bf16 v[208:223], v[112:115], v[140:143], v[208:223]
    ds_read_b64_tr_b16 v[126:127], v100 offset:7680
    ds_read_b64_tr_b16 v[128:129], v101 offset:6144
    ds_read_b64_tr_b16 v[130:131], v101 offset:7680
    s_add_u32 m0, s28, 0
    s_nop 0
    buffer_load_dwordx4 v98, s[8:11], s53 offen lds
    s_waitcnt lgkmcnt(6)
    v_mfma_f32_32x32x16_bf16 v[176:191], v[116:119], v[136:139], v[176:191]
    v_mfma_f32_32x32x16_bf16 v[224:239], v[116:119], v[140:143], v[224:239]
    s_cmp_lg_u32 s57, 4
    s_cbranch_scc1 L_cs_48
    v_dot2c_f32_bf16 v92, s52, v112
    v_dot2c_f32_bf16 v92, s52, v113
    v_dot2c_f32_bf16 v92, s52, v114
    v_dot2c_f32_bf16 v92, s52, v115
    v_dot2c_f32_bf16 v93, s52, v116
    v_dot2c_f32_bf16 v93, s52, v117
    v_dot2c_f32_bf16 v93, s52, v118
    v_dot2c_f32_bf16 v93, s52, v119
L_cs_48:
    s_waitcnt vmcnt(9) lgkmcnt(0)
    s_barrier
    v_mfma_f32_32x32x16_bf16 v[160:175], v[124:127], v[144:147], v[160:175]
    ds_read_b128 v[136:139], v106 offset:16384
    ds_read_b128 v[140:143], v106 offset:20480
    ds_read_b64_tr_b16 v[112:113], v100 offset:24832
    s_add_u32 m0, s26, 0
    s_nop 0
    buffer_load_dwordx4 v108, s[4:7], s24 offen offset:0 lds
    v_mfma_f32_32x32x16_bf16 v[208:223], v[124:127], v[148:151], v[208:223]
    ds_read_b64_tr_b16 v[114:115], v100 offset:26368
    ds_read_b64_tr_b16 v[116:117], v101 offset:24832
    ds_read_b64_tr_b16 v[118:119], v101 offset:26368
    buffer_load_dwordx4 v109, s[4:7], s24 offen offset:1024 lds
    v_mfma_f32_32x32x16_bf16 v[176:191], v[128:131], v[144:147], v[176:191]
    s_cmp_lg_u32 s57, 3
    s_cbranch_scc1 L_pub2_3_49
    v_mov_b32 v9, v92
    s_nop 1
    v_permlane32_swap_b32 v92, v9
    s_nop 1
    v_add_f32 v9, v9, v92
    v_or_b32 v12, 1, v9
    v_mov_b32 v9, v93
    s_nop 1
    v_permlane32_swap_b32 v93, v9
    s_nop 1
    v_add_f32 v9, v9, v93
    v_or_b32 v13, 1, v9
    v_mov_b32 v9, v94
    s_nop 1
    v_permlane32_swap_b32 v94, v9
    s_nop 1
    v_add_f32 v9, v9, v94
    v_or_b32 v14, 1, v9
    v_and_b32 v6, 31, v1
    v_lshlrev_b32 v6, 4, v6
    buffer_store_dwordx3 v[12:14], v6, s[12:15], s27 offen sc1
L_pub2_3_49:
    v_mfma_f32_32x32x16_bf16 v[224:239], v[128:131], v[148:151], v[224:239]
    s_cmp_lg_u32 s57, 4
    s_cbranch_scc1 L_cs_50
    v_dot2c_f32_bf16 v92, s52, v124
    v_dot2c_f32_bf16 v92, s52, v125
    v_dot2c_f32_bf16 v92, s52, v126
    v_dot2c_f32_bf16 v92, s52, v127
    v_dot2c_f32_bf16 v93, s52, v128
    v_dot2c_f32_bf16 v93, s52, v129
    v_dot2c_f32_bf16 v93, s52, v130
    v_dot2c_f32_bf16 v93, s52, v131
L_cs_50:
    s_waitcnt lgkmcnt(2)
    v_mfma_f32_32x32x16_bf16 v[160:175], v[112:115], v[136:139], v[160:175]
    ds_read_b128 v[144:147], v107 offset:16384
    ds_read_b128 v[148:151], v107 offset:20480
    ds_read_b64_tr_b16 v[124:125], v100 offset:30976
    s_add_u32 m0, s26, 0
    s_nop 0
    buffer_load_dwordx4 v110, s[4:7], s24 offen offset:2048 lds
    s_add_u32 s24, s24, s25
    v_mfma_f32_32x32x16_bf16 v[208:223], v[112:115], v[140:143], v[208:223]
    ds_read_b64_tr_b16 v[126:127], v100 offset:32512
    ds_read_b64_tr_b16 v[128:129], v101 offset:30976
    ds_read_b64_tr_b16 v[130:131], v101 offset:32512
    s_add_u32 m0, s28, 1024
    s_nop 0
    buffer_load_dwordx4 v99, s[8:11], s53 offen lds
    s_waitcnt lgkmcnt(6)
    v_mfma_f32_32x32x16_bf16 v[176:191], v[116:119], v[136:139], v[176:191]
    s_cmp_eq_u32 s29, 7
    s_cselect_b32 s49, -1152, s54
    s_add_u32 s53, s53, s49
    v_mfma_f32_32x32x16_bf16 v[224:239], v[116:119], v[140:143], v[224:239]
    s_cmp_lg_u32 s57, 4
    s_cbranch_scc1 L_cs_51
    v_dot2c_f32_bf16 v92, s52, v112
    v_dot2c_f32_bf16 v92, s52, v113
    v_dot2c_f32_bf16 v92, s52, v114
    v_dot2c_f32_bf16 v92, s52, v115
    v_dot2c_f32_bf16 v93, s52, v116
    v_dot2c_f32_bf16 v93, s52, v117
    v_dot2c_f32_bf16 v93, s52, v118
    v_dot2c_f32_bf16 v93, s52, v119
L_cs_51:
    s_waitcnt vmcnt(8) lgkmcnt(0)
    s_barrier
    v_mfma_f32_32x32x16_bf16 v[160:175], v[124:127], v[144:147], v[160:175]
    ds_read_b128 v[136:139], v104 offset:32768
    ds_read_b128 v[140:143], v104 offset:36864
    ds_read_b64_tr_b16 v[112:113], v152 offset:0
    s_add_u32 m0, s26, 24832
    s_nop 0
    buffer_load_dwordx4 v108, s[4:7], s24 offen offset:0 lds
    v_mfma_f32_32x32x16_bf16 v[208:223], v[124:127], v[148:151], v[208:223]
    ds_read_b64_tr_b16 v[114:115], v152 offset:1536
    ds_read_b64_tr_b16 v[116:117], v153 offset:0
    ds_read_b64_tr_b16 v[118:119], v153 offset:1536
    buffer_load_dwordx4 v109, s[4:7], s24 offen offset:1024 lds
    v_mfma_f32_32x32x16_bf16 v[176:191], v[128:131], v[144:147], v[176:191]
    v_mfma_f32_32x32x16_bf16 v[224:239], v[128:131], v[148:151], v[224:239]
    s_cmp_lg_u32 s57, 4
    s_cbranch_scc1 L_cs_52
    v_dot2c_f32_bf16 v92, s52, v124
    v_dot2c_f32_bf16 v92, s52, v125
    v_dot2c_f32_bf16 v92, s52, v126
    v_dot2c_f32_bf16 v92, s52, v127
    v_dot2c_f32_bf16 v93, s52, v128
    v_dot2c_f32_bf16 v93, s52, v129
    v_dot2c_f32_bf16 v93, s52, v130
    v_dot2c_f32_bf16 v93, s52, v131
L_cs_52:
    s_waitcnt lgkmcnt(2)
    v_mfma_f32_32x32x16_bf16 v[160:175], v[112:115], v[136:139], v[160:175]
    ds_read_b128 v[144:147], v105 offset:32768
    ds_read_b128 v[148:151], v105 offset:36864
    ds_read_b64_tr_b16 v[124:125], v152 offset:6144
    s_add_u32 m0, s26, 24832
    s_nop 0
    buffer_load_dwordx4 v110, s[4:7], s24 offen offset:2048 lds
    s_cmp_eq_u32 s29, 7
    s_cselect_b32 s49, s48, s25
    s_add_u32 s24, s24, s49
    v_mfma_f32_32x32x16_bf16 v[208:223], v[112:115], v[140:143], v[208:223]
    ds_read_b64_tr_b16 v[126:127], v152 offset:7680
    ds_read_b64_tr_b16 v[128:129], v153 offset:6144
    ds_read_b64_tr_b16 v[130:131], v153 offset:7680
    s_add_u32 m0, s28, 16384
    s_nop 0
    buffer_load_dwordx4 v98, s[8:11], s53 offen lds
    s_waitcnt lgkmcnt(6)
    v_mfma_f32_32x32x16_bf16 v[176:191], v[116:119], v[136:139], v[176:191]
    v_mfma_f32_32x32x16_bf16 v[224:239], v[116:119], v[140:143], v[224:239]
    s_waitcnt vmcnt(9) lgkmcnt(0)
    s_barrier
    v_mfma_f32_32x32x16_bf16 v[160:175], v[124:127], v[144:147], v[160:175]
    ds_read_b128 v[136:139], v106 offset:32768
    ds_read_b128 v[140:143], v106 offset:36864
    ds_read_b64_tr_b16 v[112:113], v152 offset:24832
    s_add_u32 m0, s26, 49664
    s_nop 0
    buffer_load_dwordx4 v108, s[4:7], s24 offen offset:0 lds
    v_mfma_f32_32x32x16_bf16 v[208:223], v[124:127], v[148:151], v[208:223]
    ds_read_b64_tr_b16 v[114:115], v152 offset:26368
    ds_read_b64_tr_b16 v[116:117], v153 offset:24832
    ds_read_b64_tr_b16 v[118:119], v153 offset:26368
    buffer_load_dwordx4 v109, s[4:7], s24 offen offset:1024 lds
    v_mfma_f32_32x32x16_bf16 v[176:191], v[128:131], v[144:147], v[176:191]
    s_cmp_lg_u32 s57, 4
    s_cbranch_scc1 L_pub2_4_53
    v_mov_b32 v9, v92
    s_nop 1
    v_permlane32_swap_b32 v92, v9
    s_nop 1
    v_add_f32 v9, v9, v92
    v_or_b32 v12, 1, v9
    v_mov_b32 v9, v93
    s_nop 1
    v_permlane32_swap_b32 v93, v9
    s_nop 1
    v_add_f32 v9, v9, v93
    v_or_b32 v13, 1, v9
    v_mov_b32 v9, v94
    s_nop 1
    v_permlane32_swap_b32 v94, v9
    s_nop 1
    v_add_f32 v9, v9, v94
    v_or_b32 v14, 1, v9
    v_and_b32 v6, 31, v1
    v_lshlrev_b32 v6, 4, v6
    buffer_store_dwordx3 v[12:14], v6, s[12:15], s27 offen sc1
L_pub2_4_53:
    v_mfma_f32_32x32x16_bf16 v[224:239], v[128:131], v[148:151], v[224:239]
    s_waitcnt lgkmcnt(2)
    v_mfma_f32_32x32x16_bf16 v[160:175], v[112:115], v[136:139], v[160:175]
    ds_read_b128 v[144:147], v107 offset:32768
    ds_read_b128 v[148:151], v107 offset:36864
    ds_read_b64_tr_b16 v[124:125], v152 offset:30976
    s_add_u32 m0, s26, 49664
    s_nop 0
    buffer_load_dwordx4 v110, s[4:7], s24 offen offset:2048 lds
    s_add_u32 s24, s24, s25
    v_mfma_f32_32x32x16_bf16 v[208:223], v[112:115], v[140:143], v[208:223]
    ds_read_b64_tr_b16 v[126:127], v152 offset:32512
    ds_read_b64_tr_b16 v[128:129], v153 offset:30976
    ds_read_b64_tr_b16 v[130:131], v153 offset:32512
    s_add_u32 m0, s28, 17408
    s_nop 0
    buffer_load_dwordx4 v99, s[8:11], s53 offen lds
    s_waitcnt lgkmcnt(6)
    v_mfma_f32_32x32x16_bf16 v[176:191], v[116:119], v[136:139], v[176:191]
    s_cmp_eq_u32 s29, 8
    s_cselect_b32 s49, -1152, s54
    s_add_u32 s53, s53, s49
    v_mfma_f32_32x32x16_bf16 v[224:239], v[116:119], v[140:143], v[224:239]
    s_waitcnt vmcnt(8) lgkmcnt(0)
    s_barrier
    v_mfma_f32_32x32x16_bf16 v[160:175], v[124:127], v[144:147], v[160:175]
    ds_read_b128 v[136:139], v104 offset:0
    ds_read_b128 v[140:143], v104 offset:4096
    ds_read_b64_tr_b16 v[112:113], v100 offset:0
    s_add_u32 m0, s26, 74496
    s_nop 0
    buffer_load_dwordx4 v108, s[4:7], s24 offen offset:0 lds
    v_mfma_f32_32x32x16_bf16 v[208:223], v[124:127], v[148:151], v[208:223]
    ds_read_b64_tr_b16 v[114:115], v100 offset:1536
    ds_read_b64_tr_b16 v[116:117], v101 offset:0
    ds_read_b64_tr_b16 v[118:119], v101 offset:1536
    buffer_load_dwordx4 v109, s[4:7], s24 offen offset:1024 lds
    v_mfma_f32_32x32x16_bf16 v[176:191], v[128:131], v[144:147], v[176:191]
    v_mfma_f32_32x32x16_bf16 v[224:239], v[128:131], v[148:151], v[224:239]
    s_waitcnt lgkmcnt(2)
    v_mfma_f32_32x32x16_bf16 v[160:175], v[112:115], v[136:139], v[160:175]
    ds_read_b128 v[144:147], v105 offset:0
    ds_read_b128 v[148:151], v105 offset:4096
    ds_read_b64_tr_b16 v[124:125], v100 offset:6144
    s_add_u32 m0, s26, 74496
    s_nop 0
    buffer_load_dwordx4 v110, s[4:7], s24 offen offset:2048 lds
    s_cmp_eq_u32 s29, 8
    s_cselect_b32 s49, s48, s25
    s_add_u32 s24, s24, s49
    v_mfma_f32_32x32x16_bf16 v[208:223], v[112:115], v[140:143], v[208:223]
    ds_read_b64_tr_b16 v[126:127], v100 offset:7680
    ds_read_b64_tr_b16 v[128:129], v101 offset:6144
    ds_read_b64_tr_b16 v[130:131], v101 offset:7680
    s_add_u32 m0, s28, 32768
    s_nop 0
    buffer_load_dwordx4 v98, s[8:11], s53 offen lds
    s_waitcnt lgkmcnt(6)
    v_mfma_f32_32x32x16_bf16 v[176:191], v[116:119], v[136:139], v[176:191]
    v_mfma_f32_32x32x16_bf16 v[224:239], v[116:119], v[140:143], v[224:239]
    s_waitcnt vmcnt(9) lgkmcnt(0)
    s_barrier
    v_mfma_f32_32x32x16_bf16 v[160:175], v[124:127], v[144:147], v[160:175]
    ds_read_b128 v[136:139], v106 offset:0
    ds_read_b128 v[140:143], v106 offset:4096
    ds_read_b64_tr_b16 v[112:113], v100 offset:24832
    s_add_u32 m0, s26, 0
    s_nop 0
    buffer_load_dwordx4 v108, s[4:7], s24 offen offset:0 lds
    buffer_load_dwordx4 v109, s[4:7], s24 offen offset:1024 lds
    v_and_b32 v54, 31, v1
    s_lshl_b32 s34, s20, 7
    s_lshl_b32 s35, s50, 6
    v_mfma_f32_32x32x16_bf16 v[208:223], v[124:127], v[148:151], v[208:223]
    ds_read_b64_tr_b16 v[114:115], v100 offset:26368
    ds_read_b64_tr_b16 v[116:117], v101 offset:24832
    ds_read_b64_tr_b16 v[118:119], v101 offset:26368
    s_add_u32 s34, s34, s35
    v_add_u32 v55, s34, v54
    v_lshlrev_b32 v55, 3, v55
    v_add_u32 v55, 16777216, v55
    v_mfma_f32_32x32x16_bf16 v[176:191], v[128:131], v[144:147], v[176:191]
    v_lshlrev_b32 v54, 4, v54
    v_lshrrev_b32 v10, 5, v1
    v_lshl_add_u32 v54, v10, 11, v54
    s_mul_i32 s34, s21, 40
    v_mfma_f32_32x32x16_bf16 v[224:239], v[128:131], v[148:151], v[224:239]
    s_lshr_b32 s35, s3, 1
    s_add_u32 s34, s34, s35
    s_lshl_b32 s34, s34, 9
    s_add_u32 s38, s34, 18874368
    s_waitcnt lgkmcnt(2)
    v_mfma_f32_32x32x16_bf16 v[160:175], v[112:115], v[136:139], v[160:175]
    ds_read_b128 v[144:147], v107 offset:0
    ds_read_b128 v[148:151], v107 offset:4096
    ds_read_b64_tr_b16 v[124:125], v100 offset:30976
    s_add_u32 m0, s26, 0
    s_nop 0
    buffer_load_dwordx4 v110, s[4:7], s24 offen offset:2048 lds
    s_add_u32 s24, s24, s25
    s_add_u32 m0, s28, 33792
    s_nop 0
    buffer_load_dwordx4 v99, s[8:11], s53 offen lds
    v_mfma_f32_32x32x16_bf16 v[208:223], v[112:115], v[140:143], v[208:223]
    ds_read_b64_tr_b16 v[126:127], v100 offset:32512
    ds_read_b64_tr_b16 v[128:129], v101 offset:30976
    ds_read_b64_tr_b16 v[130:131], v101 offset:32512
    s_cmp_eq_u32 s29, 9
    s_cselect_b32 s49, -1152, s54
    s_add_u32 s53, s53, s49
    buffer_load_dwordx2 v[2:3], v55, s[12:15], 0 offen sc1
    s_waitcnt lgkmcnt(6)
    v_mfma_f32_32x32x16_bf16 v[176:191], v[116:119], v[136:139], v[176:191]
    buffer_load_dwordx2 v[4:5], v55, s[12:15], 0 offen offset:256 sc1
    v_mfma_f32_32x32x16_bf16 v[224:239], v[116:119], v[140:143], v[224:239]
    buffer_load_dwordx4 v[32:35], v54, s[12:15], s38 offen sc1
    s_add_u32 s38, s38, 4096
    s_waitcnt vmcnt(11) lgkmcnt(0)
    s_barrier
    v_mfma_f32_32x32x16_bf16 v[160:175], v[124:127], v[144:147], v[160:175]
    ds_read_b128 v[136:139], v104 offset:16384
    ds_read_b128 v[140:143], v104 offset:20480
    ds_read_b64_tr_b16 v[112:113], v152 offset:0
    s_add_u32 m0, s26, 24832
    s_nop 0
    buffer_load_dwordx4 v108, s[4:7], s24 offen offset:0 lds
    v_mfma_f32_32x32x16_bf16 v[208:223], v[124:127], v[148:151], v[208:223]
    ds_read_b64_tr_b16 v[114:115], v152 offset:1536
    ds_read_b64_tr_b16 v[116:117], v153 offset:0
    ds_read_b64_tr_b16 v[118:119], v153 offset:1536
    buffer_load_dwordx4 v109, s[4:7], s24 offen offset:1024 lds
    v_mfma_f32_32x32x16_bf16 v[176:191], v[128:131], v[144:147], v[176:191]
    v_mfma_f32_32x32x16_bf16 v[224:239], v[128:131], v[148:151], v[224:239]
    s_waitcnt lgkmcnt(2)
    v_mfma_f32_32x32x16_bf16 v[160:175], v[112:115], v[136:139], v[160:175]
    ds_read_b128 v[144:147], v105 offset:16384
    ds_read_b128 v[148:151], v105 offset:20480
    ds_read_b64_tr_b16 v[124:125], v152 offset:6144
    s_add_u32 m0, s26, 24832
    s_nop 0
    buffer_load_dwordx4 v110, s[4:7], s24 offen offset:2048 lds
    s_cmp_eq_u32 s29, 9
    s_cselect_b32 s49, s48, s25
    s_add_u32 s24, s24, s49
    v_mfma_f32_32x32x16_bf16 v[208:223], v[112:115], v[140:143], v[208:223]
    ds_read_b64_tr_b16 v[126:127], v152 offset:7680
    ds_read_b64_tr_b16 v[128:129], v153 offset:6144
    ds_read_b64_tr_b16 v[130:131], v153 offset:7680
    s_add_u32 m0, s28, 0
    s_nop 0
    buffer_load_dwordx4 v98, s[8:11], s53 offen lds
    s_waitcnt lgkmcnt(6)
    v_mfma_f32_32x32x16_bf16 v[176:191], v[116:119], v[136:139], v[176:191]
    buffer_load_dwordx4 v[36:39], v54, s[12:15], s38 offen sc1
    s_add_u32 s38, s38, 4096
    v_mfma_f32_32x32x16_bf16 v[224:239], v[116:119], v[140:143], v[224:239]
    buffer_load_dwordx4 v[40:43], v54, s[12:15], s38 offen sc1
    s_add_u32 s38, s38, 4096
    s_waitcnt vmcnt(14) lgkmcnt(0)
    s_barrier
    v_mfma_f32_32x32x16_bf16 v[160:175], v[124:127], v[144:147], v[160:175]
    ds_read_b128 v[136:139], v106 offset:16384
    ds_read_b128 v[140:143], v106 offset:20480
    ds_read_b64_tr_b16 v[112:113], v152 offset:24832
    s_add_u32 m0, s26, 49664
    s_nop 0
    buffer_load_dwordx4 v108, s[4:7], s24 offen offset:0 lds
    v_mfma_f32_32x32x16_bf16 v[208:223], v[124:127], v[148:151], v[208:223]
    ds_read_b64_tr_b16 v[114:115], v152 offset:26368
    ds_read_b64_tr_b16 v[116:117], v153 offset:24832
    ds_read_b64_tr_b16 v[118:119], v153 offset:26368
    buffer_load_dwordx4 v109, s[4:7], s24 offen offset:1024 lds
    v_mfma_f32_32x32x16_bf16 v[176:191], v[128:131], v[144:147], v[176:191]
    s_mov_b64 exec, 3
    global_load_dword v88, v[86:87], off
    s_mov_b64 exec, -1
    v_mfma_f32_32x32x16_bf16 v[224:239], v[128:131], v[148:151], v[224:239]
    s_waitcnt lgkmcnt(2)
    v_mfma_f32_32x32x16_bf16 v[160:175], v[112:115], v[136:139], v[160:175]
    ds_read_b128 v[144:147], v107 offset:16384
    ds_read_b128 v[148:151], v107 offset:20480
    ds_read_b64_tr_b16 v[124:125], v152 offset:30976
    s_add_u32 m0, s26, 49664
    s_nop 0
    buffer_load_dwordx4 v110, s[4:7], s24 offen offset:2048 lds
    s_add_u32 s24, s24, s25
    s_add_u32 m0, s28, 1024
    s_nop 0
    buffer_load_dwordx4 v99, s[8:11], s53 offen lds
    v_mfma_f32_32x32x16_bf16 v[208:223], v[112:115], v[140:143], v[208:223]
    ds_read_b64_tr_b16 v[126:127], v152 offset:32512
    ds_read_b64_tr_b16 v[128:129], v153 offset:30976
    ds_read_b64_tr_b16 v[130:131], v153 offset:32512
    s_add_u32 s53, s53, s54
    s_waitcnt lgkmcnt(6)
    v_mfma_f32_32x32x16_bf16 v[176:191], v[116:119], v[136:139], v[176:191]
    buffer_load_dwordx4 v[44:47], v54, s[12:15], s38 offen sc1
    s_add_u32 s38, s38, 4096
    v_mfma_f32_32x32x16_bf16 v[224:239], v[116:119], v[140:143], v[224:239]
    buffer_load_dwordx4 v[48:51], v54, s[12:15], s38 offen sc1
    s_waitcnt vmcnt(16) lgkmcnt(0)
    s_barrier
    v_mfma_f32_32x32x16_bf16 v[160:175], v[124:127], v[144:147], v[160:175]
    ds_read_b128 v[136:139], v104 offset:32768
    ds_read_b128 v[140:143], v104 offset:36864
    ds_read_b64_tr_b16 v[112:113], v100 offset:0
    s_add_u32 m0, s26, 74496
    s_nop 0
    buffer_load_dwordx4 v108, s[4:7], s24 offen offset:0 lds
    v_mfma_f32_32x32x16_bf16 v[208:223], v[124:127], v[148:151], v[208:223]
    ds_read_b64_tr_b16 v[114:115], v100 offset:1536
    ds_read_b64_tr_b16 v[116:117], v101 offset:0
    ds_read_b64_tr_b16 v[118:119], v101 offset:1536
    buffer_load_dwordx4 v109, s[4:7], s24 offen offset:1024 lds
    v_mfma_f32_32x32x16_bf16 v[176:191], v[128:131], v[144:147], v[176:191]
    v_mfma_f32_32x32x16_bf16 v[224:239], v[128:131], v[148:151], v[224:239]
    s_waitcnt lgkmcnt(2)
    v_mfma_f32_32x32x16_bf16 v[160:175], v[112:115], v[136:139], v[160:175]
    ds_read_b128 v[144:147], v105 offset:32768
    ds_read_b128 v[148:151], v105 offset:36864
    ds_read_b64_tr_b16 v[124:125], v100 offset:6144
    s_add_u32 m0, s26, 74496
    s_nop 0
    buffer_load_dwordx4 v110, s[4:7], s24 offen offset:2048 lds
    s_add_u32 s24, s24, s25
    s_mov_b32 s53, s56
    s_mov_b32 s54, 4096
    v_mfma_f32_32x32x16_bf16 v[208:223], v[112:115], v[140:143], v[208:223]
    ds_read_b64_tr_b16 v[126:127], v100 offset:7680
    ds_read_b64_tr_b16 v[128:129], v101 offset:6144
    ds_read_b64_tr_b16 v[130:131], v101 offset:7680
    s_mov_b32 s8, s12
    s_mov_b32 s9, s13
    s_mov_b32 s10, s14
    s_waitcnt lgkmcnt(6)
    v_mfma_f32_32x32x16_bf16 v[176:191], v[116:119], v[136:139], v[176:191]
    v_mov_b32 v98, v155
    v_add_u32 v99, 1024, v155
    v_mfma_f32_32x32x16_bf16 v[224:239], v[116:119], v[140:143], v[224:239]
    s_cmp_eq_u32 s22, 2
    s_cbranch_scc1 L_nx2_10_0
    s_add_u32 m0, s28, 16384
    s_nop 0
    buffer_load_dwordx4 v98, s[8:11], s53 offen lds
L_nx2_10_0:
    s_waitcnt vmcnt(13) lgkmcnt(0)
    s_barrier
    v_mfma_f32_32x32x16_bf16 v[160:175], v[124:127], v[144:147], v[160:175]
    ds_read_b128 v[136:139], v106 offset:32768
    ds_read_b128 v[140:143], v106 offset:36864
    ds_read_b64_tr_b16 v[112:113], v100 offset:24832
    s_mov_b32 s24, s55
    s_mov_b32 s25, 6144
    s_mov_b32 s4, s12
    s_mov_b32 s5, s13
    s_mov_b32 s6, s14
    v_mfma_f32_32x32x16_bf16 v[208:223], v[124:127], v[148:151], v[208:223]
    ds_read_b64_tr_b16 v[114:115], v100 offset:26368
    ds_read_b64_tr_b16 v[116:117], v101 offset:24832
    ds_read_b64_tr_b16 v[118:119], v101 offset:26368
    v_mov_b32 v108, v155
    v_mov_b32 v109, v155
    v_mov_b32 v110, v155
    s_add_u32 m0, s26, 0
    s_nop 0
    buffer_load_dwordx4 v108, s[4:7], s24 offen offset:0 lds
    v_mfma_f32_32x32x16_bf16 v[176:191], v[128:131], v[144:147], v[176:191]
    buffer_load_dwordx4 v109, s[4:7], s24 offen offset:1024 lds
    buffer_load_dwordx4 v110, s[4:7], s24 offen offset:2048 lds
    s_add_u32 s24, s24, s25
    v_mfma_f32_32x32x16_bf16 v[224:239], v[128:131], v[148:151], v[224:239]
    s_cmp_eq_u32 s22, 2
    s_cbranch_scc1 L_nx2_10_1
    s_add_u32 m0, s28, 17408
    s_nop 0
    buffer_load_dwordx4 v99, s[8:11], s53 offen lds
L_nx2_10_1:
    s_add_u32 s53, s53, s54
    s_waitcnt lgkmcnt(2)
    v_mfma_f32_32x32x16_bf16 v[160:175], v[112:115], v[136:139], v[160:175]
    ds_read_b128 v[144:147], v107 offset:32768
    ds_read_b128 v[148:151], v107 offset:36864
    ds_read_b64_tr_b16 v[124:125], v100 offset:30976
    v_mfma_f32_32x32x16_bf16 v[208:223], v[112:115], v[140:143], v[208:223]
    ds_read_b64_tr_b16 v[126:127], v100 offset:32512
    ds_read_b64_tr_b16 v[128:129], v101 offset:30976
    ds_read_b64_tr_b16 v[130:131], v101 offset:32512
    s_waitcnt lgkmcnt(6)
    v_mfma_f32_32x32x16_bf16 v[176:191], v[116:119], v[136:139], v[176:191]
    v_mfma_f32_32x32x16_bf16 v[224:239], v[116:119], v[140:143], v[224:239]
    s_waitcnt vmcnt(6) lgkmcnt(0)
    s_barrier
    v_mfma_f32_32x32x16_bf16 v[160:175], v[124:127], v[144:147], v[160:175]
    ds_read_b128 v[136:139], v104 offset:0
    ds_read_b128 v[140:143], v104 offset:4096
    ds_read_b64_tr_b16 v[112:113], v152 offset:0
    s_add_u32 m0, s26, 24832
    s_nop 0
    buffer_load_dwordx4 v108, s[4:7], s24 offen offset:0 lds
    buffer_load_dwordx4 v109, s[4:7], s24 offen offset:1024 lds
    buffer_load_dwordx4 v110, s[4:7], s24 offen offset:2048 lds
    s_add_u32 s24, s24, s25
    s_cmp_eq_u32 s22, 2
    s_cbranch_scc1 L_nx2_11_0
    s_add_u32 m0, s28, 32768
    s_nop 0
    buffer_load_dwordx4 v98, s[8:11], s53 offen lds
L_nx2_11_0:
    v_mfma_f32_32x32x16_bf16 v[208:223], v[124:127], v[148:151], v[208:223]
    ds_read_b64_tr_b16 v[114:115], v152 offset:1536
    ds_read_b64_tr_b16 v[116:117], v153 offset:0
    ds_read_b64_tr_b16 v[118:119], v153 offset:1536
    v_min3_u32 v6, v32, v33, v36
    v_min3_u32 v6, v6, v37, v40
    v_min3_u32 v6, v6, v41, v44
    v_min3_u32 v6, v6, v45, v48
    v_min_u32 v6, v6, v49
    v_cmp_eq_u32 vcc, 0, v6
    s_nop 4
    s_cmp_eq_u64 vcc, 0
    s_cbranch_scc0 L_ev2_slow
L_ev2_ok:
    v_add_f32 v32, v32, v36
    v_add_f32 v33, v33, v37
    v_mfma_f32_32x32x16_bf16 v[176:191], v[128:131], v[144:147], v[176:191]
    v_add_f32 v32, v32, v40
    v_add_f32 v33, v33, v41
    v_add_f32 v32, v32, v44
    v_mfma_f32_32x32x16_bf16 v[224:239], v[128:131], v[148:151], v[224:239]
    v_add_f32 v33, v33, v45
    v_add_f32 v32, v32, v48
    v_add_f32 v33, v33, v49
    s_waitcnt lgkmcnt(2)
    v_mfma_f32_32x32x16_bf16 v[160:175], v[112:115], v[136:139], v[160:175]
    ds_read_b128 v[144:147], v105 offset:0
    ds_read_b128 v[148:151], v105 offset:4096
    ds_read_b64_tr_b16 v[124:125], v152 offset:6144
    v_mov_b32 v76, 0
    v_mov_b32 v77, 0
    v_mov_b32 v78, 0
    v_mfma_f32_32x32x16_bf16 v[208:223], v[112:115], v[140:143], v[208:223]
    ds_read_b64_tr_b16 v[126:127], v152 offset:7680
    ds_read_b64_tr_b16 v[128:129], v153 offset:6144
    ds_read_b64_tr_b16 v[130:131], v153 offset:7680
    v_mov_b32 v79, 0
    v_mov_b32 v80, 0
    s_waitcnt lgkmcnt(6)
    v_mfma_f32_32x32x16_bf16 v[176:191], v[116:119], v[136:139], v[176:191]
    v_mov_b32 v81, 0
    v_mov_b32 v82, 0
    v_mfma_f32_32x32x16_bf16 v[224:239], v[116:119], v[140:143], v[224:239]
    v_mov_b32 v83, 0
    v_mov_b32 v36, v32
    v_mov_b32 v37, v33
    s_nop 1
    v_permlane32_swap_b32 v32, v36
    v_permlane32_swap_b32 v33, v37
    v_xor_b32 v2, 0x80000000, v2
    v_xor_b32 v4, 0x80000000, v4
    v_add_f32 v32, v32, v36
    v_add_f32 v33, v33, v37
    s_waitcnt vmcnt(6) lgkmcnt(0)
    s_barrier
    v_mfma_f32_32x32x16_bf16 v[160:175], v[124:127], v[144:147], v[160:175]
    ds_read_b128 v[136:139], v106 offset:0
    ds_read_b128 v[140:143], v106 offset:4096
    ds_read_b64_tr_b16 v[112:113], v152 offset:24832
    s_add_u32 m0, s26, 49664
    s_nop 0
    buffer_load_dwordx4 v108, s[4:7], s24 offen offset:0 lds
    buffer_load_dwordx4 v109, s[4:7], s24 offen offset:1024 lds
    buffer_load_dwordx4 v110, s[4:7], s24 offen offset:2048 lds
    s_add_u32 s24, s24, s25
    s_cmp_eq_u32 s22, 2
    s_cbranch_scc1 L_nx2_11_1
    s_add_u32 m0, s28, 33792
    s_nop 0
    buffer_load_dwordx4 v99, s[8:11], s53 offen lds
L_nx2_11_1:
    v_mfma_f32_32x32x16_bf16 v[208:223], v[124:127], v[148:151], v[208:223]
    ds_read_b64_tr_b16 v[114:115], v152 offset:26368
    ds_read_b64_tr_b16 v[116:117], v153 offset:24832
    ds_read_b64_tr_b16 v[118:119], v153 offset:26368
    s_add_u32 s53, s53, s54
    s_mov_b32 s34, 0x07060302
    s_mov_b64 exec, 0xffffffff
    v_perm_b32 v76, v2, v2, s34
    v_lshrrev_b32 v77, 16, v2
    v_perm_b32 v80, v4, v4, s34
    v_lshrrev_b32 v81, 16, v4
    s_mov_b64 exec, -1
    v_and_b32 v36, 0xffff0000, v32
    v_sub_f32 v36, v32, v36
    v_mfma_f32_32x32x16_bf16 v[176:191], v[128:131], v[144:147], v[176:191]
    v_and_b32 v40, 0xffff0000, v36
    s_mov_b32 s34, 0x07060302
    v_perm_b32 v64, v36, v32, s34
    v_sub_f32 v40, v36, v40
    v_mfma_f32_32x32x16_bf16 v[224:239], v[128:131], v[148:151], v[224:239]
    v_mov_b32 v66, 0
    v_mov_b32 v67, 0
    v_cvt_pk_bf16_f32 v65, v40, 0
    s_waitcnt lgkmcnt(2)
    v_mfma_f32_32x32x16_bf16 v[160:175], v[112:115], v[136:139], v[160:175]
    ds_read_b128 v[144:147], v107 offset:0
    ds_read_b128 v[148:151], v107 offset:4096
    ds_read_b64_tr_b16 v[124:125], v152 offset:30976
    v_and_b32 v37, 0xffff0000, v33
    v_sub_f32 v37, v33, v37
    v_mfma_f32_32x32x16_bf16 v[208:223], v[112:115], v[140:143], v[208:223]
    ds_read_b64_tr_b16 v[126:127], v152 offset:32512
    ds_read_b64_tr_b16 v[128:129], v153 offset:30976
    ds_read_b64_tr_b16 v[130:131], v153 offset:32512
    v_and_b32 v41, 0xffff0000, v37
    s_mov_b32 s34, 0x07060302
    v_perm_b32 v68, v37, v33, s34
    s_waitcnt lgkmcnt(6)
    v_mfma_f32_32x32x16_bf16 v[176:191], v[116:119], v[136:139], v[176:191]
    v_sub_f32 v41, v37, v41
    v_mov_b32 v70, 0
    v_mfma_f32_32x32x16_bf16 v[224:239], v[116:119], v[140:143], v[224:239]
    v_mov_b32 v71, 0
    v_cvt_pk_bf16_f32 v69, v41, 0
    s_waitcnt lgkmcnt(0)
    s_barrier
    v_mfma_f32_32x32x16_bf16 v[160:175], v[124:127], v[144:147], v[160:175]
    s_add_u32 m0, s26, 74496
    s_nop 0
    buffer_load_dwordx4 v108, s[4:7], s24 offen offset:0 lds
    buffer_load_dwordx4 v109, s[4:7], s24 offen offset:1024 lds
    v_mfma_f32_32x32x16_bf16 v[208:223], v[124:127], v[148:151], v[208:223]
    buffer_load_dwordx4 v110, s[4:7], s24 offen offset:2048 lds
    s_add_u32 s24, s24, s25
    v_mfma_f32_32x32x16_bf16 v[176:191], v[128:131], v[144:147], v[176:191]
    s_cmp_eq_u32 s22, 2
    s_cbranch_scc1 L_nx2_12_0
    s_add_u32 m0, s28, 0
    s_nop 0
    buffer_load_dwordx4 v98, s[8:11], s53 offen lds
L_nx2_12_0:
    v_mfma_f32_32x32x16_bf16 v[224:239], v[128:131], v[148:151], v[224:239]
    s_cmp_eq_u32 s22, 2
    s_cbranch_scc1 L_nx2_12_1
    s_add_u32 m0, s28, 1024
    s_nop 0
    buffer_load_dwordx4 v99, s[8:11], s53 offen lds
L_nx2_12_1:
    v_mfma_f32_32x32x16_bf16 v[160:175], v[64:67], v[76:79], v[160:175]
    v_mfma_f32_32x32x16_bf16 v[208:223], v[64:67], v[80:83], v[208:223]
    v_mfma_f32_32x32x16_bf16 v[176:191], v[68:71], v[76:79], v[176:191]
    v_mfma_f32_32x32x16_bf16 v[224:239], v[68:71], v[80:83], v[224:239]
    s_cmp_eq_u32 s22, 2
    s_cbranch_scc1 L_kv2
    v_mul_f32 v6, 0x3fb8aa3b, v3
    v_mul_f32 v8, 0x3fb8aa3b, v5
    v_mov_b32 v14, 0x35c1a2a0
    s_mov_b32 s68, 0x3f317218
    v_bfe_u32 v12, v1, 4, 1
    v_lshlrev_b32 v12, 10, v12
    v_lshrrev_b32 v13, 5, v1
    v_lshl_add_u32 v12, v13, 8, v12
    v_and_b32 v13, 15, v1
    v_lshl_add_u32 v12, v13, 4, v12
    s_lshl_b32 s55, s20, 1
    s_add_u32 s55, s55, s50
    s_mul_i32 s55, s55, 20
    s_mul_i32 s56, s23, 10
    s_add_u32 s55, s55, s56
    s_lshl_b32 s55, s55, 12
    s_add_u32 s55, s55, 7340032
    s_add_u32 s57, s51, 0
    s_lshr_b32 s33, s57, 1
    s_lshl_b32 s33, s33, 12
    s_and_b32 s57, s57, 1
    s_lshl_b32 s57, s57, 9
    s_add_u32 s33, s33, s57
    s_add_u32 s33, s33, s55
    s_add_u32 s56, s33, 20480
    v_fma_f32 v160, v160, v6, v14
    v_fma_f32 v161, v161, v6, v14
    v_fma_f32 v162, v162, v6, v14
    v_fma_f32 v163, v163, v6, v14
    v_fma_f32 v164, v164, v6, v14
    v_fma_f32 v165, v165, v6, v14
    v_fma_f32 v166, v166, v6, v14
    v_fma_f32 v167, v167, v6, v14
    v_fma_f32 v168, v168, v6, v14
    v_fma_f32 v169, v169, v6, v14
    v_fma_f32 v170, v170, v6, v14
    v_fma_f32 v171, v171, v6, v14
    v_fma_f32 v172, v172, v6, v14
    v_fma_f32 v173, v173, v6, v14
    v_fma_f32 v174, v174, v6, v14
    v_fma_f32 v175, v175, v6, v14
    v_exp_f32 v48, v160 clamp
    v_exp_f32 v49, v161 clamp
    v_exp_f32 v50, v162 clamp
    v_exp_f32 v51, v163 clamp
    v_exp_f32 v52, v164 clamp
    v_exp_f32 v53, v165 clamp
    v_exp_f32 v54, v166 clamp
    v_exp_f32 v55, v167 clamp
    v_exp_f32 v56, v168 clamp
    v_exp_f32 v57, v169 clamp
    v_exp_f32 v58, v170 clamp
    v_exp_f32 v59, v171 clamp
    v_exp_f32 v60, v172 clamp
    v_exp_f32 v61, v173 clamp
    v_exp_f32 v62, v174 clamp
    v_exp_f32 v63, v175 clamp
    v_max_f32 v160, v160, v14
    v_max_f32 v161, v161, v14
    v_max_f32 v162, v162, v14
    v_max_f32 v163, v163, v14
    v_max_f32 v164, v164, v14
    v_max_f32 v165, v165, v14
    v_max_f32 v166, v166, v14
    v_max_f32 v167, v167, v14
    v_max_f32 v168, v168, v14
    v_max_f32 v169, v169, v14
    v_max_f32 v170, v170, v14
    v_max_f32 v171, v171, v14
    v_max_f32 v172, v172, v14
    v_max_f32 v173, v173, v14
    v_max_f32 v174, v174, v14
    v_max_f32 v175, v175, v14
    v_fmac_f32 v48, s68, v160
    v_fmac_f32 v49, s68, v161
    v_fmac_f32 v50, s68, v162
    v_fmac_f32 v51, s68, v163
    v_fmac_f32 v52, s68, v164
    v_fmac_f32 v53, s68, v165
    v_fmac_f32 v54, s68, v166
    v_fmac_f32 v55, s68, v167
    v_fmac_f32 v56, s68, v168
    v_fmac_f32 v57, s68, v169
    v_fmac_f32 v58, s68, v170
    v_fmac_f32 v59, s68, v171
    v_fmac_f32 v60, s68, v172
    v_fmac_f32 v61, s68, v173
    v_fmac_f32 v62, s68, v174
    v_fmac_f32 v63, s68, v175
    v_cvt_pk_bf16_f32 v160, v48, v49
    v_cvt_pk_bf16_f32 v161, v50, v51
    v_cvt_pk_bf16_f32 v162, v52, v53
    v_cvt_pk_bf16_f32 v163, v54, v55
    v_cvt_pk_bf16_f32 v164, v56, v57
    v_cvt_pk_bf16_f32 v165, v58, v59
    v_cvt_pk_bf16_f32 v166, v60, v61
    v_cvt_pk_bf16_f32 v167, v62, v63
    buffer_store_dwordx4 v[160:163], v12, s[12:15], s33 offen offset:0 sc1
    buffer_store_dwordx4 v[164:167], v12, s[12:15], s56 offen offset:0 sc1
    v_fma_f32 v208, v208, v8, v14
    v_fma_f32 v209, v209, v8, v14
    v_fma_f32 v210, v210, v8, v14
    v_fma_f32 v211, v211, v8, v14
    v_fma_f32 v212, v212, v8, v14
    v_fma_f32 v213, v213, v8, v14
    v_fma_f32 v214, v214, v8, v14
    v_fma_f32 v215, v215, v8, v14
    v_fma_f32 v216, v216, v8, v14
    v_fma_f32 v217, v217, v8, v14
    v_fma_f32 v218, v218, v8, v14
    v_fma_f32 v219, v219, v8, v14
    v_fma_f32 v220, v220, v8, v14
    v_fma_f32 v221, v221, v8, v14
    v_fma_f32 v222, v222, v8, v14
    v_fma_f32 v223, v223, v8, v14
    v_exp_f32 v48, v208 clamp
    v_exp_f32 v49, v209 clamp
    v_exp_f32 v50, v210 clamp
    v_exp_f32 v51, v211 clamp
    v_exp_f32 v52, v212 clamp
    v_exp_f32 v53, v213 clamp
    v_exp_f32 v54, v214 clamp
    v_exp_f32 v55, v215 clamp
    v_exp_f32 v56, v216 clamp
    v_exp_f32 v57, v217 clamp
    v_exp_f32 v58, v218 clamp
    v_exp_f32 v59, v219 clamp
    v_exp_f32 v60, v220 clamp
    v_exp_f32 v61, v221 clamp
    v_exp_f32 v62, v222 clamp
    v_exp_f32 v63, v223 clamp
    v_max_f32 v208, v208, v14
    v_max_f32 v209, v209, v14
    v_max_f32 v210, v210, v14
    v_max_f32 v211, v211, v14
    v_max_f32 v212, v212, v14
    v_max_f32 v213, v213, v14
    v_max_f32 v214, v214, v14
    v_max_f32 v215, v215, v14
    v_max_f32 v216, v216, v14
    v_max_f32 v217, v217, v14
    v_max_f32 v218, v218, v14
    v_max_f32 v219, v219, v14
    v_max_f32 v220, v220, v14
    v_max_f32 v221, v221, v14
    v_max_f32 v222, v222, v14
    v_max_f32 v223, v223, v14
    v_fmac_f32 v48, s68, v208
    v_fmac_f32 v49, s68, v209
    v_fmac_f32 v50, s68, v210
    v_fmac_f32 v51, s68, v211
    v_fmac_f32 v52, s68, v212
    v_fmac_f32 v53, s68, v213
    v_fmac_f32 v54, s68, v214
    v_fmac_f32 v55, s68, v215
    v_fmac_f32 v56, s68, v216
    v_fmac_f32 v57, s68, v217
    v_fmac_f32 v58, s68, v218
    v_fmac_f32 v59, s68, v219
    v_fmac_f32 v60, s68, v220
    v_fmac_f32 v61, s68, v221
    v_fmac_f32 v62, s68, v222
    v_fmac_f32 v63, s68, v223
    v_cvt_pk_bf16_f32 v208, v48, v49
    v_cvt_pk_bf16_f32 v209, v50, v51
    v_cvt_pk_bf16_f32 v210, v52, v53
    v_cvt_pk_bf16_f32 v211, v54, v55
    v_cvt_pk_bf16_f32 v212, v56, v57
    v_cvt_pk_bf16_f32 v213, v58, v59
    v_cvt_pk_bf16_f32 v214, v60, v61
    v_cvt_pk_bf16_f32 v215, v62, v63
    buffer_store_dwordx4 v[208:211], v12, s[12:15], s33 offen offset:2048 sc1
    buffer_store_dwordx4 v[212:215], v12, s[12:15], s56 offen offset:2048 sc1
    s_add_u32 s57, s51, 1
    s_lshr_b32 s33, s57, 1
    s_lshl_b32 s33, s33, 12
    s_and_b32 s57, s57, 1
    s_lshl_b32 s57, s57, 9
    s_add_u32 s33, s33, s57
    s_add_u32 s33, s33, s55
    s_add_u32 s56, s33, 20480
    v_fma_f32 v176, v176, v6, v14
    v_fma_f32 v177, v177, v6, v14
    v_fma_f32 v178, v178, v6, v14
    v_fma_f32 v179, v179, v6, v14
    v_fma_f32 v180, v180, v6, v14
    v_fma_f32 v181, v181, v6, v14
    v_fma_f32 v182, v182, v6, v14
    v_fma_f32 v183, v183, v6, v14
    v_fma_f32 v184, v184, v6, v14
    v_fma_f32 v185, v185, v6, v14
    v_fma_f32 v186, v186, v6, v14
    v_fma_f32 v187, v187, v6, v14
    v_fma_f32 v188, v188, v6, v14
    v_fma_f32 v189, v189, v6, v14
    v_fma_f32 v190, v190, v6, v14
    v_fma_f32 v191, v191, v6, v14
    v_exp_f32 v48, v176 clamp
    v_exp_f32 v49, v177 clamp
    v_exp_f32 v50, v178 clamp
    v_exp_f32 v51, v179 clamp
    v_exp_f32 v52, v180 clamp
    v_exp_f32 v53, v181 clamp
    v_exp_f32 v54, v182 clamp
    v_exp_f32 v55, v183 clamp
    v_exp_f32 v56, v184 clamp
    v_exp_f32 v57, v185 clamp
    v_exp_f32 v58, v186 clamp
    v_exp_f32 v59, v187 clamp
    v_exp_f32 v60, v188 clamp
    v_exp_f32 v61, v189 clamp
    v_exp_f32 v62, v190 clamp
    v_exp_f32 v63, v191 clamp
    v_max_f32 v176, v176, v14
    v_max_f32 v177, v177, v14
    v_max_f32 v178, v178, v14
    v_max_f32 v179, v179, v14
    v_max_f32 v180, v180, v14
    v_max_f32 v181, v181, v14
    v_max_f32 v182, v182, v14
    v_max_f32 v183, v183, v14
    v_max_f32 v184, v184, v14
    v_max_f32 v185, v185, v14
    v_max_f32 v186, v186, v14
    v_max_f32 v187, v187, v14
    v_max_f32 v188, v188, v14
    v_max_f32 v189, v189, v14
    v_max_f32 v190, v190, v14
    v_max_f32 v191, v191, v14
    v_fmac_f32 v48, s68, v176
    v_fmac_f32 v49, s68, v177
    v_fmac_f32 v50, s68, v178
    v_fmac_f32 v51, s68, v179
    v_fmac_f32 v52, s68, v180
    v_fmac_f32 v53, s68, v181
    v_fmac_f32 v54, s68, v182
    v_fmac_f32 v55, s68, v183
    v_fmac_f32 v56, s68, v184
    v_fmac_f32 v57, s68, v185
    v_fmac_f32 v58, s68, v186
    v_fmac_f32 v59, s68, v187
    v_fmac_f32 v60, s68, v188
    v_fmac_f32 v61, s68, v189
    v_fmac_f32 v62, s68, v190
    v_fmac_f32 v63, s68, v191
    v_cvt_pk_bf16_f32 v176, v48, v49
    v_cvt_pk_bf16_f32 v177, v50, v51
    v_cvt_pk_bf16_f32 v178, v52, v53
    v_cvt_pk_bf16_f32 v179, v54, v55
    v_cvt_pk_bf16_f32 v180, v56, v57
    v_cvt_pk_bf16_f32 v181, v58, v59
    v_cvt_pk_bf16_f32 v182, v60, v61
    v_cvt_pk_bf16_f32 v183, v62, v63
    buffer_store_dwordx4 v[176:179], v12, s[12:15], s33 offen offset:0 sc1
    buffer_store_dwordx4 v[180:183], v12, s[12:15], s56 offen offset:0 sc1
    v_fma_f32 v224, v224, v8, v14
    v_fma_f32 v225, v225, v8, v14
    v_fma_f32 v226, v226, v8, v14
    v_fma_f32 v227, v227, v8, v14
    v_fma_f32 v228, v228, v8, v14
    v_fma_f32 v229, v229, v8, v14
    v_fma_f32 v230, v230, v8, v14
    v_fma_f32 v231, v231, v8, v14
    v_fma_f32 v232, v232, v8, v14
    v_fma_f32 v233, v233, v8, v14
    v_fma_f32 v234, v234, v8, v14
    v_fma_f32 v235, v235, v8, v14
    v_fma_f32 v236, v236, v8, v14
    v_fma_f32 v237, v237, v8, v14
    v_fma_f32 v238, v238, v8, v14
    v_fma_f32 v239, v239, v8, v14
    v_exp_f32 v48, v224 clamp
    v_exp_f32 v49, v225 clamp
    v_exp_f32 v50, v226 clamp
    v_exp_f32 v51, v227 clamp
    v_exp_f32 v52, v228 clamp
    v_exp_f32 v53, v229 clamp
    v_exp_f32 v54, v230 clamp
    v_exp_f32 v55, v231 clamp
    v_exp_f32 v56, v232 clamp
    v_exp_f32 v57, v233 clamp
    v_exp_f32 v58, v234 clamp
    v_exp_f32 v59, v235 clamp
    v_exp_f32 v60, v236 clamp
    v_exp_f32 v61, v237 clamp
    v_exp_f32 v62, v238 clamp
    v_exp_f32 v63, v239 clamp
    v_max_f32 v224, v224, v14
    v_max_f32 v225, v225, v14
    v_max_f32 v226, v226, v14
    v_max_f32 v227, v227, v14
    v_max_f32 v228, v228, v14
    v_max_f32 v229, v229, v14
    v_max_f32 v230, v230, v14
    v_max_f32 v231, v231, v14
    v_max_f32 v232, v232, v14
    v_max_f32 v233, v233, v14
    v_max_f32 v234, v234, v14
    v_max_f32 v235, v235, v14
    v_max_f32 v236, v236, v14
    v_max_f32 v237, v237, v14
    v_max_f32 v238, v238, v14
    v_max_f32 v239, v239, v14
    v_fmac_f32 v48, s68, v224
    v_fmac_f32 v49, s68, v225
    v_fmac_f32 v50, s68, v226
    v_fmac_f32 v51, s68, v227
    v_fmac_f32 v52, s68, v228
    v_fmac_f32 v53, s68, v229
    v_fmac_f32 v54, s68, v230
    v_fmac_f32 v55, s68, v231
    v_fmac_f32 v56, s68, v232
    v_fmac_f32 v57, s68, v233
    v_fmac_f32 v58, s68, v234
    v_fmac_f32 v59, s68, v235
    v_fmac_f32 v60, s68, v236
    v_fmac_f32 v61, s68, v237
    v_fmac_f32 v62, s68, v238
    v_fmac_f32 v63, s68, v239
    v_cvt_pk_bf16_f32 v224, v48, v49
    v_cvt_pk_bf16_f32 v225, v50, v51
    v_cvt_pk_bf16_f32 v226, v52, v53
    v_cvt_pk_bf16_f32 v227, v54, v55
    v_cvt_pk_bf16_f32 v228, v56, v57
    v_cvt_pk_bf16_f32 v229, v58, v59
    v_cvt_pk_bf16_f32 v230, v60, v61
    v_cvt_pk_bf16_f32 v231, v62, v63
    buffer_store_dwordx4 v[224:227], v12, s[12:15], s33 offen offset:2048 sc1
    buffer_store_dwordx4 v[228:231], v12, s[12:15], s56 offen offset:2048 sc1
    s_branch L_p1_done
L_kv2:
    s_cmp_ge_u32 s3, 4
    s_cbranch_scc1 L_el2_no
    s_mul_i32 s34, s3, 14
    s_cmp_eq_u32 s3, 3
    s_cselect_b32 s35, 1, 0
    s_sub_u32 s34, s34, s35
    s_mul_i32 s35, s59, 74
    s_add_u32 s34, s34, s35
    s_mul_i32 s56, s34, 5120
    s_add_u32 s56, s56, 10485760
    s_add_u32 s56, s56, 35840
L_el2:
    s_add_u32 s57, s56, 4096
    buffer_load_dwordx4 v[96:99], v155, s[12:15], s56 offen offset:0
    buffer_load_dwordx4 v[100:103], v155, s[12:15], s56 offen offset:1024
    buffer_load_dwordx4 v[104:107], v155, s[12:15], s56 offen offset:2048
    buffer_load_dwordx4 v[108:111], v155, s[12:15], s56 offen offset:3072
    buffer_load_dwordx4 v[112:115], v155, s[12:15], s57 offen
    s_add_u32 s56, s56, 5120
    s_add_u32 s57, s57, 5120
    buffer_load_dwordx4 v[116:119], v155, s[12:15], s56 offen offset:0
    buffer_load_dwordx4 v[120:123], v155, s[12:15], s56 offen offset:1024
    buffer_load_dwordx4 v[124:127], v155, s[12:15], s56 offen offset:2048
    buffer_load_dwordx4 v[128:131], v155, s[12:15], s56 offen offset:3072
    buffer_load_dwordx4 v[132:135], v155, s[12:15], s57 offen
    s_add_u32 s56, s56, 5120
    s_add_u32 s57, s57, 5120
    buffer_load_dwordx4 v[136:139], v155, s[12:15], s56 offen offset:0
    buffer_load_dwordx4 v[140:143], v155, s[12:15], s56 offen offset:1024
    buffer_load_dwordx4 v[144:147], v155, s[12:15], s56 offen offset:2048
    buffer_load_dwordx4 v[148:151], v155, s[12:15], s56 offen offset:3072
    buffer_load_dwordx4 v[152:155], v155, s[12:15], s57 offen
L_el2_no:
    v_mul_f32 v6, 0x3fb8aa3b, v3
    v_mul_f32 v8, 0x3fb8aa3b, v5
    v_mov_b32 v14, 0x35c1a2a0
    s_mov_b32 s68, 0x3f317218
    v_and_b32 v12, 31, v1
    s_lshl_b32 s55, s50, 5
    v_add_u32 v12, s55, v12
    v_mul_u32_u24 v12, 336, v12
    v_lshrrev_b32 v13, 5, v1
    v_lshl_add_u32 v12, v13, 4, v12
    s_lshl_b32 s55, s51, 5
    s_add_u32 s55, s55, 99328
    v_add_u32 v12, s55, v12
    v_lshrrev_b32 v9, 5, v1
    v_bfe_u32 v10, v1, 2, 2
    v_lshl_add_u32 v9, v10, 2, v9
    v_mul_u32_u24 v9, 336, v9
    v_bfe_u32 v10, v1, 4, 1
    v_lshl_add_u32 v9, v10, 5, v9
    v_and_b32 v10, 3, v1
    v_lshl_add_u32 v9, v10, 3, v9
    s_mul_i32 s55, s3, 40
    s_add_u32 s55, s55, 99328
    v_add_u32 v9, s55, v9
    v_mov_b32 v88, s52
    v_mov_b32 v89, s52
    v_mov_b32 v90, s52
    v_mov_b32 v91, s52
    v_fma_f32 v160, v160, v6, v14
    v_fma_f32 v161, v161, v6, v14
    v_fma_f32 v162, v162, v6, v14
    v_fma_f32 v163, v163, v6, v14
    v_fma_f32 v164, v164, v6, v14
    v_fma_f32 v165, v165, v6, v14
    v_fma_f32 v166, v166, v6, v14
    v_fma_f32 v167, v167, v6, v14
    v_exp_f32 v48, v160 clamp
    v_exp_f32 v49, v161 clamp
    v_exp_f32 v50, v162 clamp
    v_exp_f32 v51, v163 clamp
    v_exp_f32 v52, v164 clamp
    v_exp_f32 v53, v165 clamp
    v_exp_f32 v54, v166 clamp
    v_exp_f32 v55, v167 clamp
    v_max_f32 v160, v160, v14
    v_max_f32 v161, v161, v14
    v_max_f32 v162, v162, v14
    v_max_f32 v163, v163, v14
    v_max_f32 v164, v164, v14
    v_max_f32 v165, v165, v14
    v_max_f32 v166, v166, v14
    v_max_f32 v167, v167, v14
    v_fmac_f32 v48, s68, v160
    v_fmac_f32 v49, s68, v161
    v_fmac_f32 v50, s68, v162
    v_fmac_f32 v51, s68, v163
    v_fmac_f32 v52, s68, v164
    v_fmac_f32 v53, s68, v165
    v_fmac_f32 v54, s68, v166
    v_fmac_f32 v55, s68, v167
    v_mul_f32 v168, v168, v3
    v_mul_f32 v169, v169, v3
    v_mul_f32 v170, v170, v3
    v_mul_f32 v171, v171, v3
    v_mul_f32 v172, v172, v3
    v_mul_f32 v173, v173, v3
    v_mul_f32 v174, v174, v3
    v_mul_f32 v175, v175, v3
    v_cvt_pk_bf16_f32 v160, v48, v49
    v_cvt_pk_bf16_f32 v161, v50, v51
    v_cvt_pk_bf16_f32 v162, v52, v53
    v_cvt_pk_bf16_f32 v163, v54, v55
    v_cvt_pk_bf16_f32 v164, v168, v169
    v_cvt_pk_bf16_f32 v165, v170, v171
    v_cvt_pk_bf16_f32 v166, v172, v173
    v_cvt_pk_bf16_f32 v167, v174, v175
    ds_write_b128 v12, v[160:163] offset:0
    ds_write_b128 v12, v[164:167] offset:21504
    v_fma_f32 v176, v176, v6, v14
    v_fma_f32 v177, v177, v6, v14
    v_fma_f32 v178, v178, v6, v14
    v_fma_f32 v179, v179, v6, v14
    v_fma_f32 v180, v180, v6, v14
    v_fma_f32 v181, v181, v6, v14
    v_fma_f32 v182, v182, v6, v14
    v_fma_f32 v183, v183, v6, v14
    v_exp_f32 v48, v176 clamp
    v_exp_f32 v49, v177 clamp
    v_exp_f32 v50, v178 clamp
    v_exp_f32 v51, v179 clamp
    v_exp_f32 v52, v180 clamp
    v_exp_f32 v53, v181 clamp
    v_exp_f32 v54, v182 clamp
    v_exp_f32 v55, v183 clamp
    v_max_f32 v176, v176, v14
    v_max_f32 v177, v177, v14
    v_max_f32 v178, v178, v14
    v_max_f32 v179, v179, v14
    v_max_f32 v180, v180, v14
    v_max_f32 v181, v181, v14
    v_max_f32 v182, v182, v14
    v_max_f32 v183, v183, v14
    v_fmac_f32 v48, s68, v176
    v_fmac_f32 v49, s68, v177
    v_fmac_f32 v50, s68, v178
    v_fmac_f32 v51, s68, v179
    v_fmac_f32 v52, s68, v180
    v_fmac_f32 v53, s68, v181
    v_fmac_f32 v54, s68, v182
    v_fmac_f32 v55, s68, v183
    v_mul_f32 v184, v184, v3
    v_mul_f32 v185, v185, v3
    v_mul_f32 v186, v186, v3
    v_mul_f32 v187, v187, v3
    v_mul_f32 v188, v188, v3
    v_mul_f32 v189, v189, v3
    v_mul_f32 v190, v190, v3
    v_mul_f32 v191, v191, v3
    v_cvt_pk_bf16_f32 v176, v48, v49
    v_cvt_pk_bf16_f32 v177, v50, v51
    v_cvt_pk_bf16_f32 v178, v52, v53
    v_cvt_pk_bf16_f32 v179, v54, v55
    v_cvt_pk_bf16_f32 v180, v184, v185
    v_cvt_pk_bf16_f32 v181, v186, v187
    v_cvt_pk_bf16_f32 v182, v188, v189
    v_cvt_pk_bf16_f32 v183, v190, v191
    ds_write_b128 v12, v[176:179] offset:32
    ds_write_b128 v12, v[180:183] offset:21536
    s_waitcnt lgkmcnt(0)
    s_barrier
    ds_read_b64_tr_b16 v[16:17], v9 offset:0
    ds_read_b64_tr_b16 v[18:19], v9 offset:672
    ds_read_b64_tr_b16 v[20:21], v9 offset:21504
    ds_read_b64_tr_b16 v[22:23], v9 offset:22176
    ds_read_b64_tr_b16 v[24:25], v9 offset:5376
    ds_read_b64_tr_b16 v[26:27], v9 offset:6048
    ds_read_b64_tr_b16 v[28:29], v9 offset:26880
    ds_read_b64_tr_b16 v[30:31], v9 offset:27552
    ds_read_b64_tr_b16 v[32:33], v9 offset:10752
    ds_read_b64_tr_b16 v[34:35], v9 offset:11424
    ds_read_b64_tr_b16 v[36:37], v9 offset:32256
    ds_read_b64_tr_b16 v[38:39], v9 offset:32928
    ds_read_b64_tr_b16 v[40:41], v9 offset:16128
    ds_read_b64_tr_b16 v[42:43], v9 offset:16800
    ds_read_b64_tr_b16 v[44:45], v9 offset:37632
    ds_read_b64_tr_b16 v[46:47], v9 offset:38304
    v_fma_f32 v208, v208, v8, v14
    v_fma_f32 v209, v209, v8, v14
    v_fma_f32 v210, v210, v8, v14
    v_fma_f32 v211, v211, v8, v14
    v_fma_f32 v212, v212, v8, v14
    v_fma_f32 v213, v213, v8, v14
    v_fma_f32 v214, v214, v8, v14
    v_fma_f32 v215, v215, v8, v14
    v_exp_f32 v48, v208 clamp
    v_exp_f32 v49, v209 clamp
    v_exp_f32 v50, v210 clamp
    v_exp_f32 v51, v211 clamp
    v_exp_f32 v52, v212 clamp
    v_exp_f32 v53, v213 clamp
    v_exp_f32 v54, v214 clamp
    v_exp_f32 v55, v215 clamp
    v_max_f32 v208, v208, v14
    v_max_f32 v209, v209, v14
    v_max_f32 v210, v210, v14
    v_max_f32 v211, v211, v14
    v_max_f32 v212, v212, v14
    v_max_f32 v213, v213, v14
    v_max_f32 v214, v214, v14
    v_max_f32 v215, v215, v14
    v_fmac_f32 v48, s68, v208
    v_fmac_f32 v49, s68, v209
    v_fmac_f32 v50, s68, v210
    v_fmac_f32 v51, s68, v211
    v_fmac_f32 v52, s68, v212
    v_fmac_f32 v53, s68, v213
    v_fmac_f32 v54, s68, v214
    v_fmac_f32 v55, s68, v215
    v_mul_f32 v216, v216, v5
    v_mul_f32 v217, v217, v5
    v_mul_f32 v218, v218, v5
    v_mul_f32 v219, v219, v5
    v_mul_f32 v220, v220, v5
    v_mul_f32 v221, v221, v5
    v_mul_f32 v222, v222, v5
    v_mul_f32 v223, v223, v5
    v_cvt_pk_bf16_f32 v208, v48, v49
    v_cvt_pk_bf16_f32 v209, v50, v51
    v_cvt_pk_bf16_f32 v210, v52, v53
    v_cvt_pk_bf16_f32 v211, v54, v55
    v_cvt_pk_bf16_f32 v212, v216, v217
    v_cvt_pk_bf16_f32 v213, v218, v219
    v_cvt_pk_bf16_f32 v214, v220, v221
    v_cvt_pk_bf16_f32 v215, v222, v223
    s_waitcnt lgkmcnt(0)
    v_mfma_f32_32x32x16_bf16 v[160:175], v[16:19], v[20:23], 0
    v_mfma_f32_32x32x16_bf16 v[176:191], v[16:19], v[88:91], 0
    v_mfma_f32_32x32x16_bf16 v[160:175], v[24:27], v[28:31], v[160:175]
    v_mfma_f32_32x32x16_bf16 v[176:191], v[24:27], v[88:91], v[176:191]
    v_mfma_f32_32x32x16_bf16 v[160:175], v[32:35], v[36:39], v[160:175]
    v_mfma_f32_32x32x16_bf16 v[176:191], v[32:35], v[88:91], v[176:191]
    v_mfma_f32_32x32x16_bf16 v[160:175], v[40:43], v[44:47], v[160:175]
    v_mfma_f32_32x32x16_bf16 v[176:191], v[40:43], v[88:91], v[176:191]
    v_fma_f32 v224, v224, v8, v14
    v_fma_f32 v225, v225, v8, v14
    v_fma_f32 v226, v226, v8, v14
    v_fma_f32 v227, v227, v8, v14
    v_fma_f32 v228, v228, v8, v14
    v_fma_f32 v229, v229, v8, v14
    v_fma_f32 v230, v230, v8, v14
    v_fma_f32 v231, v231, v8, v14
    v_exp_f32 v48, v224 clamp
    v_exp_f32 v49, v225 clamp
    v_exp_f32 v50, v226 clamp
    v_exp_f32 v51, v227 clamp
    v_exp_f32 v52, v228 clamp
    v_exp_f32 v53, v229 clamp
    v_exp_f32 v54, v230 clamp
    v_exp_f32 v55, v231 clamp
    v_max_f32 v224, v224, v14
    v_max_f32 v225, v225, v14
    v_max_f32 v226, v226, v14
    v_max_f32 v227, v227, v14
    v_max_f32 v228, v228, v14
    v_max_f32 v229, v229, v14
    v_max_f32 v230, v230, v14
    v_max_f32 v231, v231, v14
    v_fmac_f32 v48, s68, v224
    v_fmac_f32 v49, s68, v225
    v_fmac_f32 v50, s68, v226
    v_fmac_f32 v51, s68, v227
    v_fmac_f32 v52, s68, v228
    v_fmac_f32 v53, s68, v229
    v_fmac_f32 v54, s68, v230
    v_fmac_f32 v55, s68, v231
    v_mul_f32 v232, v232, v5
    v_mul_f32 v233, v233, v5
    v_mul_f32 v234, v234, v5
    v_mul_f32 v235, v235, v5
    v_mul_f32 v236, v236, v5
    v_mul_f32 v237, v237, v5
    v_mul_f32 v238, v238, v5
    v_mul_f32 v239, v239, v5
    v_cvt_pk_bf16_f32 v224, v48, v49
    v_cvt_pk_bf16_f32 v225, v50, v51
    v_cvt_pk_bf16_f32 v226, v52, v53
    v_cvt_pk_bf16_f32 v227, v54, v55
    v_cvt_pk_bf16_f32 v228, v232, v233
    v_cvt_pk_bf16_f32 v229, v234, v235
    v_cvt_pk_bf16_f32 v230, v236, v237
    v_cvt_pk_bf16_f32 v231, v238, v239
    s_barrier
    ds_write_b128 v12, v[208:211] offset:0
    ds_write_b128 v12, v[212:215] offset:21504
    ds_write_b128 v12, v[224:227] offset:32
    ds_write_b128 v12, v[228:231] offset:21536
    s_waitcnt lgkmcnt(0)
    s_barrier
    ds_read_b64_tr_b16 v[56:57], v9 offset:0
    ds_read_b64_tr_b16 v[58:59], v9 offset:672
    ds_read_b64_tr_b16 v[60:61], v9 offset:21504
    ds_read_b64_tr_b16 v[62:63], v9 offset:22176
    ds_read_b64_tr_b16 v[64:65], v9 offset:5376
    ds_read_b64_tr_b16 v[66:67], v9 offset:6048
    ds_read_b64_tr_b16 v[68:69], v9 offset:26880
    ds_read_b64_tr_b16 v[70:71], v9 offset:27552
    ds_read_b64_tr_b16 v[72:73], v9 offset:10752
    ds_read_b64_tr_b16 v[74:75], v9 offset:11424
    ds_read_b64_tr_b16 v[76:77], v9 offset:32256
    ds_read_b64_tr_b16 v[78:79], v9 offset:32928
    ds_read_b64_tr_b16 v[80:81], v9 offset:16128
    ds_read_b64_tr_b16 v[82:83], v9 offset:16800
    ds_read_b64_tr_b16 v[84:85], v9 offset:37632
    ds_read_b64_tr_b16 v[86:87], v9 offset:38304
    v_and_b32 v8, 31, v1
    v_lshrrev_b32 v13, 5, v1
    v_mul_u32_u24 v10, 80, v8
    s_lshl_b32 s55, s23, 3
    s_add_u32 s55, s55, s3
    s_lshl_b32 s55, s55, 4
    s_add_u32 s55, s55, s20
    s_mul_i32 s55, s55, 1792
    s_add_u32 s55, s55, 15728640
    v_cmp_eq_u32 vcc, 20, v8
    v_lshl_add_u32 v10, v13, 4, v10
    s_waitcnt lgkmcnt(12)
    v_mfma_f32_32x32x16_bf16 v[160:175], v[56:59], v[60:63], v[160:175]
    v_mfma_f32_32x32x16_bf16 v[176:191], v[56:59], v[88:91], v[176:191]
    s_waitcnt lgkmcnt(8)
    v_mfma_f32_32x32x16_bf16 v[160:175], v[64:67], v[68:71], v[160:175]
    v_mfma_f32_32x32x16_bf16 v[176:191], v[64:67], v[88:91], v[176:191]
    s_waitcnt lgkmcnt(4)
    v_mfma_f32_32x32x16_bf16 v[160:175], v[72:75], v[76:79], v[160:175]
    v_mfma_f32_32x32x16_bf16 v[176:191], v[72:75], v[88:91], v[176:191]
    s_waitcnt lgkmcnt(0)
    v_mfma_f32_32x32x16_bf16 v[160:175], v[80:83], v[84:87], v[160:175]
    v_mfma_f32_32x32x16_bf16 v[176:191], v[80:83], v[88:91], v[176:191]
    s_nop 7
    s_nop 3
    v_cndmask_b32 v160, v160, v176, vcc
    v_cndmask_b32 v161, v161, v177, vcc
    v_cndmask_b32 v162, v162, v178, vcc
    v_cndmask_b32 v163, v163, v179, vcc
    v_cndmask_b32 v164, v164, v180, vcc
    v_cndmask_b32 v165, v165, v181, vcc
    v_cndmask_b32 v166, v166, v182, vcc
    v_cndmask_b32 v167, v167, v183, vcc
    v_cndmask_b32 v168, v168, v184, vcc
    v_cndmask_b32 v169, v169, v185, vcc
    v_cndmask_b32 v170, v170, v186, vcc
    v_cndmask_b32 v171, v171, v187, vcc
    v_or_b32 v160, 1, v160
    v_or_b32 v164, 1, v164
    v_or_b32 v168, 1, v168
    v_cmp_ge_u32 vcc, 20, v8
    s_and_saveexec_b64 s[56:57], vcc
    buffer_store_dwordx4 v[160:163], v10, s[12:15], s55 offen sc1
    buffer_store_dwordx4 v[164:167], v10, s[12:15], s55 offen offset:32 sc1
    v_cmp_eq_u32 vcc, 0, v13
    s_and_b64 exec, exec, vcc
    buffer_store_dwordx4 v[168:171], v10, s[12:15], s55 offen offset:64 sc1
    s_mov_b64 exec, s[56:57]
    s_waitcnt vmcnt(3)
    s_barrier
    s_branch L_p1_posted
L_p1_done:
    s_lshl_b32 s34, s21, 1
    s_min_u32 s32, s34, 14
    s_max_u32 s33, s34, 2
    s_sub_u32 s33, s33, 2
    s_sub_u32 s35, s34, 1
    s_bitcmp1_b32 s21, 0
    s_cselect_b32 s32, s35, s32
    s_cselect_b32 s33, s35, s33
    s_sub_u32 s35, s21, 9
    s_lshl_b32 s35, s35, 3
    s_add_u32 s35, s35, 3
    s_add_u32 s34, s35, 4
    s_cmp_ge_u32 s21, 9
    s_cselect_b32 s32, s35, s32
    s_cselect_b32 s33, s34, s33
    s_lshl_b32 s32, s32, 2
    s_lshl_b32 s33, s33, 2
    s_lshl_b32 s34, s20, 1
    v_and_b32 v16, 1, v1
    v_add_u32 v16, s34, v16
    v_lshrrev_b32 v17, 2, v16
    v_and_b32 v16, 3, v16
    v_lshl_add_u32 v17, v16, 3, v17
    v_bfe_u32 v16, v1, 1, 3
    v_lshl_add_u32 v17, v16, 5, v17
    v_lshlrev_b32 v17, 7, v17
    v_mov_b32 v16, s32
    v_mov_b32 v18, s33
    v_cmp_gt_u32 vcc, 16, v1
    s_nop 1
    v_cndmask_b32 v16, v18, v16, vcc
    v_add_u32 v17, v17, v16
    v_add_u32 v15, 17170432, v17
    s_waitcnt vmcnt(0) lgkmcnt(0)
    s_barrier
    s_cmp_lg_u32 s3, 0
    s_cbranch_scc1 L_f1_54
    v_mov_b32 v7, 1
    s_mov_b64 exec, 0xffffffff
    buffer_store_dword v7, v15, s[12:15], 0 offen sc1
    s_mov_b64 exec, -1
L_f1_54:
L_p1_posted:
    s_and_b32 s28, s3, 3
    s_mov_b32 s27, 0x7f000000
    v_lshlrev_b32 v2, 4, v1
    s_mul_i32 s34, s28, 3072
    v_add_u32 v7, s34, v2
    v_add_u32 v8, 74496, v7
    s_lshl_b32 s34, s28, 12
    s_add_u32 s34, s34, 99328
    v_add_u32 v9, s34, v2
    s_lshl_b32 s34, s28, 2
    s_add_u32 s34, s34, 163584
    v_mov_b32 v10, s34
    s_add_u32 s34, s28, 0
    s_and_b32 s34, s34, 3
    s_lshl_b32 s34, s34, 10
    v_add_u32 v3, s34, v2
    s_add_u32 s34, s28, 1
    s_and_b32 s34, s34, 3
    s_lshl_b32 s34, s34, 10
    v_add_u32 v4, s34, v2
    s_add_u32 s34, s28, 2
    s_and_b32 s34, s34, 3
    s_lshl_b32 s34, s34, 10
    v_add_u32 v5, s34, v2
    s_add_u32 s34, s28, 3
    s_and_b32 s34, s34, 3
    s_lshl_b32 s34, s34, 10
    v_add_u32 v6, s34, v2
L_p2_go:
    s_cmp_ge_u32 s3, 4
    s_cbranch_scc1 L_p2_aux
    s_mul_i32 s33, s28, 14
    s_cmp_eq_u32 s28, 3
    s_cselect_b32 s35, 1, 0
    s_sub_u32 s33, s33, s35
    s_mul_i32 s34, s59, 74
    s_add_u32 s34, s34, s33
    s_mul_i32 s30, s34, 5120
    s_add_u32 s30, s30, 10485760
    s_mul_i32 s34, s58, 54
    s_add_u32 s34, s34, s33
    s_lshl_b32 s24, s34, 12
    s_add_u32 s24, s24, 0
    s_cmp_eq_u32 s22, 3
    s_cbranch_scc0 L_p2_wring
    v_lshlrev_b32 v11, 7, v1
    v_add_u32 v76, 17203200, v11
    v_add_u32 v77, 8192, v76
    s_mov_b32 s34, 0xffffffff
    s_mov_b32 s35, 0xffffffff
    s_mov_b64 exec, s[34:35]
    s_mov_b32 s71, 0
L_p2_fw_spin:
    buffer_load_dword v11, v76, s[12:15], 0 offen sc1
    s_waitcnt vmcnt(0)
    v_cmp_ne_u32 vcc, 0, v11
    s_add_u32 s71, s71, 1
    s_nop 3
    s_cmp_eq_u64 vcc, s[34:35]
    s_cbranch_scc1 L_p2_fw_ok
    s_cmp_lt_u32 s71, 2097152
    s_cbranch_scc1 L_p2_fw_spin
L_p2_fw_ok:
    s_mov_b64 exec, -1
    s_mov_b32 s34, 0x3ff
    s_mov_b32 s35, 0x0
    s_mov_b64 exec, s[34:35]
    s_mov_b32 s71, 0
L_p2_fx_spin:
    buffer_load_dword v11, v77, s[12:15], 0 offen sc1
    s_waitcnt vmcnt(0)
    v_cmp_ne_u32 vcc, 0, v11
    s_add_u32 s71, s71, 1
    s_nop 3
    s_cmp_eq_u64 vcc, s[34:35]
    s_cbranch_scc1 L_p2_fx_ok
    s_cmp_lt_u32 s71, 2097152
    s_cbranch_scc1 L_p2_fx_spin
L_p2_fx_ok:
    s_mov_b64 exec, -1
    s_mul_i32 s32, s28, 3072
    s_mov_b32 s33, s30
    s_add_u32 m0, s32, 0
    s_nop 0
    buffer_load_dwordx4 v2, s[12:15], s33 offen offset:0 lds
    buffer_load_dwordx4 v2, s[12:15], s33 offen offset:1024 lds
    buffer_load_dwordx4 v2, s[12:15], s33 offen offset:2048 lds
    s_add_u32 s33, s33, 3072
    s_add_u32 m0, s32, 12416
    s_nop 0
    buffer_load_dwordx4 v2, s[12:15], s33 offen offset:0 lds
    buffer_load_dwordx4 v2, s[12:15], s33 offen offset:1024 lds
    buffer_load_dwordx4 v2, s[12:15], s33 offen offset:2048 lds
    s_add_u32 s33, s33, 3072
    s_add_u32 m0, s32, 24832
    s_nop 0
    buffer_load_dwordx4 v2, s[12:15], s33 offen offset:0 lds
    buffer_load_dwordx4 v2, s[12:15], s33 offen offset:1024 lds
    buffer_load_dwordx4 v2, s[12:15], s33 offen offset:2048 lds
    s_add_u32 s33, s33, 3072
    s_add_u32 m0, s32, 37248
    s_nop 0
    buffer_load_dwordx4 v2, s[12:15], s33 offen offset:0 lds
    buffer_load_dwordx4 v2, s[12:15], s33 offen offset:1024 lds
    buffer_load_dwordx4 v2, s[12:15], s33 offen offset:2048 lds
    s_add_u32 s33, s33, 3072
    s_add_u32 m0, s32, 49664
    s_nop 0
    buffer_load_dwordx4 v2, s[12:15], s33 offen offset:0 lds
    buffer_load_dwordx4 v2, s[12:15], s33 offen offset:1024 lds
    buffer_load_dwordx4 v2, s[12:15], s33 offen offset:2048 lds
    s_add_u32 s33, s33, 3072
    s_add_u32 m0, s32, 62080
    s_nop 0
    buffer_load_dwordx4 v2, s[12:15], s33 offen offset:0 lds
    buffer_load_dwordx4 v2, s[12:15], s33 offen offset:1024 lds
    buffer_load_dwordx4 v2, s[12:15], s33 offen offset:2048 lds
    s_add_u32 s33, s33, 3072
    s_add_u32 m0, s32, 74496
    s_nop 0
    buffer_load_dwordx4 v2, s[12:15], s33 offen offset:0 lds
    buffer_load_dwordx4 v2, s[12:15], s33 offen offset:1024 lds
    buffer_load_dwordx4 v2, s[12:15], s33 offen offset:2048 lds
    s_add_u32 s33, s33, 3072
    s_add_u32 m0, s32, 86912
    s_nop 0
    buffer_load_dwordx4 v2, s[12:15], s33 offen offset:0 lds
    buffer_load_dwordx4 v2, s[12:15], s33 offen offset:1024 lds
    buffer_load_dwordx4 v2, s[12:15], s33 offen offset:2048 lds
L_p2_wring:
    s_add_u32 s33, s30, 35840
    s_add_u32 s32, s33, 4096
    s_cmp_eq_u32 s22, 2
    s_cbranch_scc1 L_p2_noea
    buffer_load_dwordx4 v[96:99], v2, s[12:15], s33 offen offset:0
    buffer_load_dwordx4 v[100:103], v2, s[12:15], s33 offen offset:1024
    buffer_load_dwordx4 v[104:107], v2, s[12:15], s33 offen offset:2048
    buffer_load_dwordx4 v[108:111], v2, s[12:15], s33 offen offset:3072
    buffer_load_dwordx4 v[112:115], v2, s[12:15], s32 offen
    s_add_u32 s33, s33, 5120
    s_add_u32 s32, s32, 5120
    buffer_load_dwordx4 v[116:119], v2, s[12:15], s33 offen offset:0
    buffer_load_dwordx4 v[120:123], v2, s[12:15], s33 offen offset:1024
    buffer_load_dwordx4 v[124:127], v2, s[12:15], s33 offen offset:2048
    buffer_load_dwordx4 v[128:131], v2, s[12:15], s33 offen offset:3072
    buffer_load_dwordx4 v[132:135], v2, s[12:15], s32 offen
    s_add_u32 s33, s33, 5120
    s_add_u32 s32, s32, 5120
    buffer_load_dwordx4 v[136:139], v2, s[12:15], s33 offen offset:0
    buffer_load_dwordx4 v[140:143], v2, s[12:15], s33 offen offset:1024
    buffer_load_dwordx4 v[144:147], v2, s[12:15], s33 offen offset:2048
    buffer_load_dwordx4 v[148:151], v2, s[12:15], s33 offen offset:3072
    buffer_load_dwordx4 v[152:155], v2, s[12:15], s32 offen
L_p2_noea:
    s_cmp_lt_u32 s22, 2
    s_cbranch_scc1 L_p2_loaded
    s_add_u32 s33, s30, 24576
    s_lshl_b32 s32, s28, 12
    s_add_u32 s32, s32, 99328
    s_add_u32 m0, s32, 16384
    s_nop 0
    buffer_load_dwordx4 v2, s[12:15], s33 offen offset:0 lds
    buffer_load_dwordx4 v2, s[12:15], s33 offen offset:1024 lds
    buffer_load_dwordx4 v2, s[12:15], s33 offen offset:2048 lds
    buffer_load_dwordx4 v2, s[12:15], s33 offen offset:3072 lds
    s_add_u32 s33, s33, 4096
    s_add_u32 m0, s32, 32768
    s_nop 0
    buffer_load_dwordx4 v2, s[12:15], s33 offen offset:0 lds
    buffer_load_dwordx4 v2, s[12:15], s33 offen offset:1024 lds
    buffer_load_dwordx4 v2, s[12:15], s33 offen offset:2048 lds
    buffer_load_dwordx4 v2, s[12:15], s33 offen offset:3072 lds
    s_add_u32 s33, s33, 4096
    s_add_u32 m0, s32, 0
    s_nop 0
    buffer_load_dwordx4 v2, s[12:15], s33 offen offset:0 lds
    buffer_load_dwordx4 v2, s[12:15], s33 offen offset:1024 lds
    buffer_load_dwordx4 v2, s[12:15], s33 offen offset:2048 lds
    s_cmp_eq_u32 s22, 3
    s_cbranch_scc0 L_p2_loaded
    s_waitcnt vmcnt(0)
L_p2_loaded:
    s_add_u32 s25, s30, 51200
    s_add_u32 s26, s25, 4096
    s_lshl_b32 s32, s2, 7
    s_lshl_b32 s34, s28, 4
    s_add_u32 s32, s32, s34
    s_add_u32 s32, s32, 17170432
    s_mov_b32 s71, 0
L_p2_h_spin:
    s_buffer_load_dwordx4 s[76:79], s[12:15], s32 glc
    s_add_u32 s71, s71, 1
    s_waitcnt lgkmcnt(0)
    s_min_u32 s76, s76, s77
    s_min_u32 s76, s76, s78
    s_cmp_lg_u32 s76, 0
    s_cbranch_scc1 L_p2_h_ok
    s_cmp_lt_u32 s71, 2097152
    s_cbranch_scc1 L_p2_h_spin
L_p2_h_ok:
    buffer_load_dwordx4 v[12:15], v3, s[12:15], s24 offen
    buffer_load_dwordx4 v[16:19], v4, s[12:15], s24 offen
    buffer_load_dwordx4 v[20:23], v5, s[12:15], s24 offen
    buffer_load_dwordx4 v[24:27], v6, s[12:15], s24 offen
    s_add_u32 s24, s24, 4096
    buffer_load_dwordx4 v[28:31], v3, s[12:15], s24 offen
    buffer_load_dwordx4 v[32:35], v4, s[12:15], s24 offen
    buffer_load_dwordx4 v[36:39], v5, s[12:15], s24 offen
    buffer_load_dwordx4 v[40:43], v6, s[12:15], s24 offen
    s_add_u32 s24, s24, 4096
    buffer_load_dwordx4 v[44:47], v3, s[12:15], s24 offen
    buffer_load_dwordx4 v[48:51], v4, s[12:15], s24 offen
    buffer_load_dwordx4 v[52:55], v5, s[12:15], s24 offen
    buffer_load_dwordx4 v[56:59], v6, s[12:15], s24 offen
    s_add_u32 s24, s24, 4096
    buffer_load_dwordx4 v[60:63], v3, s[12:15], s24 offen
    buffer_load_dwordx4 v[64:67], v4, s[12:15], s24 offen
    buffer_load_dwordx4 v[68:71], v5, s[12:15], s24 offen
    buffer_load_dwordx4 v[72:75], v6, s[12:15], s24 offen
    s_add_u32 s24, s24, 4096
    s_cmp_eq_u32 s21, 9
    s_cselect_b32 s34, 3, s22
    s_cmp_eq_u32 s34, 3
    s_cbranch_scc0 L_p2_nogate
    v_mov_b32 v79, 163648
    s_mov_b32 s71, 0
L_p2_gate_spin:
    ds_read_b128 v[80:83], v79
    s_add_u32 s71, s71, 1
    s_waitcnt lgkmcnt(0)
    v_min_u32 v80, v80, v81
    v_min3_u32 v80, v80, v82, v83
    s_nop 0
    v_readfirstlane_b32 s34, v80
    s_nop 1
    s_cmp_lg_u32 s34, 0
    s_cbranch_scc1 L_p2_gate_ok
    s_cmp_lt_u32 s71, 2097152
    s_cbranch_scc1 L_p2_gate_spin
L_p2_gate_ok:
L_p2_nogate:
    ds_read_b128 v[76:79], v7 offset:0
    ds_read_b128 v[80:83], v7 offset:1024
    ds_read_b128 v[84:87], v7 offset:2048
    ds_read_b128 v[88:91], v7 offset:12416
    ds_read_b128 v[92:95], v7 offset:13440
    ds_read_b128 v[240:243], v7 offset:14464
    ds_read_b128 v[244:247], v7 offset:24832
    ds_read_b128 v[248:251], v7 offset:25856
    ds_read_b128 v[252:255], v7 offset:26880
    ds_read_b128 v[156:159], v7 offset:37248
    s_waitcnt lgkmcnt(5)
    s_waitcnt vmcnt(15)
    v_mfma_f32_16x16x32_bf16 v[160:163], v[76:79], v[12:15], 0
    v_mfma_f32_16x16x32_bf16 v[164:167], v[80:83], v[12:15], 0
    v_mfma_f32_16x16x32_bf16 v[168:171], v[84:87], v[12:15], 0
    v_mfma_f32_16x16x32_bf16 v[172:175], v[88:91], v[12:15], 0
    v_mfma_f32_16x16x32_bf16 v[176:179], v[92:95], v[12:15], 0
    buffer_load_dwordx4 v[12:15], v3, s[12:15], s24 offen
    s_waitcnt vmcnt(15)
    v_mfma_f32_16x16x32_bf16 v[180:183], v[76:79], v[16:19], 0
    v_mfma_f32_16x16x32_bf16 v[184:187], v[80:83], v[16:19], 0
    v_mfma_f32_16x16x32_bf16 v[188:191], v[84:87], v[16:19], 0
    v_mfma_f32_16x16x32_bf16 v[192:195], v[88:91], v[16:19], 0
    v_mfma_f32_16x16x32_bf16 v[196:199], v[92:95], v[16:19], 0
    buffer_load_dwordx4 v[16:19], v4, s[12:15], s24 offen
    s_waitcnt vmcnt(15)
    v_mfma_f32_16x16x32_bf16 v[200:203], v[76:79], v[20:23], 0
    v_mfma_f32_16x16x32_bf16 v[204:207], v[80:83], v[20:23], 0
    v_mfma_f32_16x16x32_bf16 v[208:211], v[84:87], v[20:23], 0
    v_mfma_f32_16x16x32_bf16 v[212:215], v[88:91], v[20:23], 0
    v_mfma_f32_16x16x32_bf16 v[216:219], v[92:95], v[20:23], 0
    buffer_load_dwordx4 v[20:23], v5, s[12:15], s24 offen
    s_waitcnt vmcnt(15)
    v_mfma_f32_16x16x32_bf16 v[220:223], v[76:79], v[24:27], 0
    ds_read_b128 v[76:79], v7 offset:38272
    v_mfma_f32_16x16x32_bf16 v[224:227], v[80:83], v[24:27], 0
    ds_read_b128 v[80:83], v7 offset:39296
    v_mfma_f32_16x16x32_bf16 v[228:231], v[84:87], v[24:27], 0
    ds_read_b128 v[84:87], v7 offset:49664
    v_mfma_f32_16x16x32_bf16 v[232:235], v[88:91], v[24:27], 0
    ds_read_b128 v[88:91], v7 offset:50688
    v_mfma_f32_16x16x32_bf16 v[236:239], v[92:95], v[24:27], 0
    ds_read_b128 v[92:95], v7 offset:51712
    buffer_load_dwordx4 v[24:27], v6, s[12:15], s24 offen
    s_add_u32 s24, s24, 4096
    s_waitcnt lgkmcnt(5)
    s_waitcnt vmcnt(15)
    v_mfma_f32_16x16x32_bf16 v[160:163], v[240:243], v[28:31], v[160:163]
    v_mfma_f32_16x16x32_bf16 v[164:167], v[244:247], v[28:31], v[164:167]
    v_mfma_f32_16x16x32_bf16 v[168:171], v[248:251], v[28:31], v[168:171]
    v_mfma_f32_16x16x32_bf16 v[172:175], v[252:255], v[28:31], v[172:175]
    v_mfma_f32_16x16x32_bf16 v[176:179], v[156:159], v[28:31], v[176:179]
    buffer_load_dwordx4 v[28:31], v3, s[12:15], s24 offen
    s_waitcnt vmcnt(15)
    v_mfma_f32_16x16x32_bf16 v[180:183], v[240:243], v[32:35], v[180:183]
    v_mfma_f32_16x16x32_bf16 v[184:187], v[244:247], v[32:35], v[184:187]
    v_mfma_f32_16x16x32_bf16 v[188:191], v[248:251], v[32:35], v[188:191]
    v_mfma_f32_16x16x32_bf16 v[192:195], v[252:255], v[32:35], v[192:195]
    v_mfma_f32_16x16x32_bf16 v[196:199], v[156:159], v[32:35], v[196:199]
    buffer_load_dwordx4 v[32:35], v4, s[12:15], s24 offen
    s_waitcnt vmcnt(15)
    v_mfma_f32_16x16x32_bf16 v[200:203], v[240:243], v[36:39], v[200:203]
    v_mfma_f32_16x16x32_bf16 v[204:207], v[244:247], v[36:39], v[204:207]
    v_mfma_f32_16x16x32_bf16 v[208:211], v[248:251], v[36:39], v[208:211]
    v_mfma_f32_16x16x32_bf16 v[212:215], v[252:255], v[36:39], v[212:215]
    v_mfma_f32_16x16x32_bf16 v[216:219], v[156:159], v[36:39], v[216:219]
    buffer_load_dwordx4 v[36:39], v5, s[12:15], s24 offen
    s_waitcnt vmcnt(15)
    v_mfma_f32_16x16x32_bf16 v[220:223], v[240:243], v[40:43], v[220:223]
    ds_read_b128 v[240:243], v7 offset:62080
    v_mfma_f32_16x16x32_bf16 v[224:227], v[244:247], v[40:43], v[224:227]
    ds_read_b128 v[244:247], v7 offset:63104
    v_mfma_f32_16x16x32_bf16 v[228:231], v[248:251], v[40:43], v[228:231]
    ds_read_b128 v[248:251], v7 offset:64128
    v_mfma_f32_16x16x32_bf16 v[232:235], v[252:255], v[40:43], v[232:235]
    ds_read_b128 v[252:255], v8 offset:0
    v_mfma_f32_16x16x32_bf16 v[236:239], v[156:159], v[40:43], v[236:239]
    ds_read_b128 v[156:159], v8 offset:1024
    buffer_load_dwordx4 v[40:43], v6, s[12:15], s24 offen
    s_add_u32 s24, s24, 4096
    s_waitcnt lgkmcnt(5)
    s_waitcnt vmcnt(15)
    v_mfma_f32_16x16x32_bf16 v[160:163], v[76:79], v[44:47], v[160:163]
    v_mfma_f32_16x16x32_bf16 v[164:167], v[80:83], v[44:47], v[164:167]
    v_mfma_f32_16x16x32_bf16 v[168:171], v[84:87], v[44:47], v[168:171]
    v_mfma_f32_16x16x32_bf16 v[172:175], v[88:91], v[44:47], v[172:175]
    v_mfma_f32_16x16x32_bf16 v[176:179], v[92:95], v[44:47], v[176:179]
    buffer_load_dwordx4 v[44:47], v3, s[12:15], s24 offen
    s_waitcnt vmcnt(15)
    v_mfma_f32_16x16x32_bf16 v[180:183], v[76:79], v[48:51], v[180:183]
    v_mfma_f32_16x16x32_bf16 v[184:187], v[80:83], v[48:51], v[184:187]
    v_mfma_f32_16x16x32_bf16 v[188:191], v[84:87], v[48:51], v[188:191]
    v_mfma_f32_16x16x32_bf16 v[192:195], v[88:91], v[48:51], v[192:195]
    v_mfma_f32_16x16x32_bf16 v[196:199], v[92:95], v[48:51], v[196:199]
    buffer_load_dwordx4 v[48:51], v4, s[12:15], s24 offen
    s_waitcnt vmcnt(15)
    v_mfma_f32_16x16x32_bf16 v[200:203], v[76:79], v[52:55], v[200:203]
    v_mfma_f32_16x16x32_bf16 v[204:207], v[80:83], v[52:55], v[204:207]
    v_mfma_f32_16x16x32_bf16 v[208:211], v[84:87], v[52:55], v[208:211]
    v_mfma_f32_16x16x32_bf16 v[212:215], v[88:91], v[52:55], v[212:215]
    v_mfma_f32_16x16x32_bf16 v[216:219], v[92:95], v[52:55], v[216:219]
    buffer_load_dwordx4 v[52:55], v5, s[12:15], s24 offen
    s_waitcnt vmcnt(15)
    v_mfma_f32_16x16x32_bf16 v[220:223], v[76:79], v[56:59], v[220:223]
    ds_read_b128 v[76:79], v8 offset:2048
    v_mfma_f32_16x16x32_bf16 v[224:227], v[80:83], v[56:59], v[224:227]
    ds_read_b128 v[80:83], v8 offset:12416
    v_mfma_f32_16x16x32_bf16 v[228:231], v[84:87], v[56:59], v[228:231]
    ds_read_b128 v[84:87], v8 offset:13440
    v_mfma_f32_16x16x32_bf16 v[232:235], v[88:91], v[56:59], v[232:235]
    ds_read_b128 v[88:91], v8 offset:14464
    v_mfma_f32_16x16x32_bf16 v[236:239], v[92:95], v[56:59], v[236:239]
    ds_read_b128 v[92:95], v9 offset:16384
    buffer_load_dwordx4 v[56:59], v6, s[12:15], s24 offen
    s_add_u32 s24, s24, 4096
    s_waitcnt lgkmcnt(5)
    s_waitcnt vmcnt(15)
    v_mfma_f32_16x16x32_bf16 v[160:163], v[240:243], v[60:63], v[160:163]
    v_mfma_f32_16x16x32_bf16 v[164:167], v[244:247], v[60:63], v[164:167]
    v_mfma_f32_16x16x32_bf16 v[168:171], v[248:251], v[60:63], v[168:171]
    v_mfma_f32_16x16x32_bf16 v[172:175], v[252:255], v[60:63], v[172:175]
    v_mfma_f32_16x16x32_bf16 v[176:179], v[156:159], v[60:63], v[176:179]
    buffer_load_dwordx4 v[60:63], v3, s[12:15], s24 offen
    s_waitcnt vmcnt(15)
    v_mfma_f32_16x16x32_bf16 v[180:183], v[240:243], v[64:67], v[180:183]
    v_mfma_f32_16x16x32_bf16 v[184:187], v[244:247], v[64:67], v[184:187]
    v_mfma_f32_16x16x32_bf16 v[188:191], v[248:251], v[64:67], v[188:191]
    v_mfma_f32_16x16x32_bf16 v[192:195], v[252:255], v[64:67], v[192:195]
    v_mfma_f32_16x16x32_bf16 v[196:199], v[156:159], v[64:67], v[196:199]
    buffer_load_dwordx4 v[64:67], v4, s[12:15], s24 offen
    s_waitcnt vmcnt(15)
    v_mfma_f32_16x16x32_bf16 v[200:203], v[240:243], v[68:71], v[200:203]
    v_mfma_f32_16x16x32_bf16 v[204:207], v[244:247], v[68:71], v[204:207]
    v_mfma_f32_16x16x32_bf16 v[208:211], v[248:251], v[68:71], v[208:211]
    v_mfma_f32_16x16x32_bf16 v[212:215], v[252:255], v[68:71], v[212:215]
    v_mfma_f32_16x16x32_bf16 v[216:219], v[156:159], v[68:71], v[216:219]
    buffer_load_dwordx4 v[68:71], v5, s[12:15], s24 offen
    s_waitcnt vmcnt(15)
    v_mfma_f32_16x16x32_bf16 v[220:223], v[240:243], v[72:75], v[220:223]
    ds_read_b128 v[240:243], v9 offset:17408
    v_mfma_f32_16x16x32_bf16 v[224:227], v[244:247], v[72:75], v[224:227]
    ds_read_b128 v[244:247], v9 offset:18432
    v_mfma_f32_16x16x32_bf16 v[228:231], v[248:251], v[72:75], v[228:231]
    ds_read_b128 v[248:251], v9 offset:19456
    v_mfma_f32_16x16x32_bf16 v[232:235], v[252:255], v[72:75], v[232:235]
    ds_read_b128 v[252:255], v9 offset:32768
    v_mfma_f32_16x16x32_bf16 v[236:239], v[156:159], v[72:75], v[236:239]
    ds_read_b128 v[156:159], v9 offset:33792
    buffer_load_dwordx4 v[72:75], v6, s[12:15], s24 offen
    s_add_u32 s24, s24, 4096
    s_waitcnt lgkmcnt(5)
    s_waitcnt vmcnt(15)
    v_mfma_f32_16x16x32_bf16 v[160:163], v[76:79], v[12:15], v[160:163]
    v_mfma_f32_16x16x32_bf16 v[164:167], v[80:83], v[12:15], v[164:167]
    v_mfma_f32_16x16x32_bf16 v[168:171], v[84:87], v[12:15], v[168:171]
    v_mfma_f32_16x16x32_bf16 v[172:175], v[88:91], v[12:15], v[172:175]
    v_mfma_f32_16x16x32_bf16 v[176:179], v[92:95], v[12:15], v[176:179]
    buffer_load_dwordx4 v[12:15], v3, s[12:15], s24 offen
    s_waitcnt vmcnt(15)
    v_mfma_f32_16x16x32_bf16 v[180:183], v[76:79], v[16:19], v[180:183]
    v_mfma_f32_16x16x32_bf16 v[184:187], v[80:83], v[16:19], v[184:187]
    v_mfma_f32_16x16x32_bf16 v[188:191], v[84:87], v[16:19], v[188:191]
    v_mfma_f32_16x16x32_bf16 v[192:195], v[88:91], v[16:19], v[192:195]
    v_mfma_f32_16x16x32_bf16 v[196:199], v[92:95], v[16:19], v[196:199]
    buffer_load_dwordx4 v[16:19], v4, s[12:15], s24 offen
    s_waitcnt vmcnt(15)
    v_mfma_f32_16x16x32_bf16 v[200:203], v[76:79], v[20:23], v[200:203]
    v_mfma_f32_16x16x32_bf16 v[204:207], v[80:83], v[20:23], v[204:207]
    v_mfma_f32_16x16x32_bf16 v[208:211], v[84:87], v[20:23], v[208:211]
    v_mfma_f32_16x16x32_bf16 v[212:215], v[88:91], v[20:23], v[212:215]
    v_mfma_f32_16x16x32_bf16 v[216:219], v[92:95], v[20:23], v[216:219]
    buffer_load_dwordx4 v[20:23], v5, s[12:15], s24 offen
    s_waitcnt vmcnt(15)
    v_mfma_f32_16x16x32_bf16 v[220:223], v[76:79], v[24:27], v[220:223]
    ds_read_b128 v[76:79], v9 offset:34816
    v_mfma_f32_16x16x32_bf16 v[224:227], v[80:83], v[24:27], v[224:227]
    ds_read_b128 v[80:83], v9 offset:35840
    v_mfma_f32_16x16x32_bf16 v[228:231], v[84:87], v[24:27], v[228:231]
    ds_read_b128 v[84:87], v9 offset:0
    v_mfma_f32_16x16x32_bf16 v[232:235], v[88:91], v[24:27], v[232:235]
    ds_read_b128 v[88:91], v9 offset:1024
    v_mfma_f32_16x16x32_bf16 v[236:239], v[92:95], v[24:27], v[236:239]
    ds_read_b128 v[92:95], v9 offset:2048
    buffer_load_dwordx4 v[24:27], v6, s[12:15], s24 offen
    s_add_u32 s24, s24, 4096
    s_waitcnt lgkmcnt(5)
    ds_write_b32 v10, v10 offset:4
    s_waitcnt vmcnt(15)
    v_mfma_f32_16x16x32_bf16 v[160:163], v[240:243], v[28:31], v[160:163]
    v_mfma_f32_16x16x32_bf16 v[164:167], v[244:247], v[28:31], v[164:167]
    v_mfma_f32_16x16x32_bf16 v[168:171], v[248:251], v[28:31], v[168:171]
    v_mfma_f32_16x16x32_bf16 v[172:175], v[252:255], v[28:31], v[172:175]
    v_mfma_f32_16x16x32_bf16 v[176:179], v[156:159], v[28:31], v[176:179]
    buffer_load_dwordx4 v[28:31], v3, s[12:15], s24 offen
    s_waitcnt vmcnt(15)
    v_mfma_f32_16x16x32_bf16 v[180:183], v[240:243], v[32:35], v[180:183]
    v_mfma_f32_16x16x32_bf16 v[184:187], v[244:247], v[32:35], v[184:187]
    v_mfma_f32_16x16x32_bf16 v[188:191], v[248:251], v[32:35], v[188:191]
    v_mfma_f32_16x16x32_bf16 v[192:195], v[252:255], v[32:35], v[192:195]
    v_mfma_f32_16x16x32_bf16 v[196:199], v[156:159], v[32:35], v[196:199]
    buffer_load_dwordx4 v[32:35], v4, s[12:15], s24 offen
    s_waitcnt vmcnt(15)
    v_mfma_f32_16x16x32_bf16 v[200:203], v[240:243], v[36:39], v[200:203]
    v_mfma_f32_16x16x32_bf16 v[204:207], v[244:247], v[36:39], v[204:207]
    v_mfma_f32_16x16x32_bf16 v[208:211], v[248:251], v[36:39], v[208:211]
    v_mfma_f32_16x16x32_bf16 v[212:215], v[252:255], v[36:39], v[212:215]
    v_mfma_f32_16x16x32_bf16 v[216:219], v[156:159], v[36:39], v[216:219]
    buffer_load_dwordx4 v[36:39], v5, s[12:15], s24 offen
    s_waitcnt vmcnt(15)
    v_mfma_f32_16x16x32_bf16 v[220:223], v[240:243], v[40:43], v[220:223]
    buffer_load_dwordx4 v[240:243], v2, s[12:15], s25 offen offset:0
    v_mfma_f32_16x16x32_bf16 v[224:227], v[244:247], v[40:43], v[224:227]
    buffer_load_dwordx4 v[244:247], v2, s[12:15], s25 offen offset:1024
    v_mfma_f32_16x16x32_bf16 v[228:231], v[248:251], v[40:43], v[228:231]
    buffer_load_dwordx4 v[248:251], v2, s[12:15], s25 offen offset:2048
    v_mfma_f32_16x16x32_bf16 v[232:235], v[252:255], v[40:43], v[232:235]
    buffer_load_dwordx4 v[252:255], v2, s[12:15], s25 offen offset:3072
    v_mfma_f32_16x16x32_bf16 v[236:239], v[156:159], v[40:43], v[236:239]
    buffer_load_dwordx4 v[156:159], v2, s[12:15], s26 offen
    buffer_load_dwordx4 v[40:43], v6, s[12:15], s24 offen
    s_add_u32 s24, s24, 4096
    s_add_u32 s25, s25, 5120
    s_add_u32 s26, s26, 5120
    s_waitcnt lgkmcnt(1)
    s_waitcnt vmcnt(20)
    v_mfma_f32_16x16x32_bf16 v[160:163], v[76:79], v[44:47], v[160:163]
    v_mfma_f32_16x16x32_bf16 v[164:167], v[80:83], v[44:47], v[164:167]
    v_mfma_f32_16x16x32_bf16 v[168:171], v[84:87], v[44:47], v[168:171]
    v_mfma_f32_16x16x32_bf16 v[172:175], v[88:91], v[44:47], v[172:175]
    v_mfma_f32_16x16x32_bf16 v[176:179], v[92:95], v[44:47], v[176:179]
    buffer_load_dwordx4 v[44:47], v3, s[12:15], s24 offen
    s_waitcnt vmcnt(20)
    v_mfma_f32_16x16x32_bf16 v[180:183], v[76:79], v[48:51], v[180:183]
    v_mfma_f32_16x16x32_bf16 v[184:187], v[80:83], v[48:51], v[184:187]
    v_mfma_f32_16x16x32_bf16 v[188:191], v[84:87], v[48:51], v[188:191]
    v_mfma_f32_16x16x32_bf16 v[192:195], v[88:91], v[48:51], v[192:195]
    v_mfma_f32_16x16x32_bf16 v[196:199], v[92:95], v[48:51], v[196:199]
    buffer_load_dwordx4 v[48:51], v4, s[12:15], s24 offen
    s_waitcnt vmcnt(20)
    v_mfma_f32_16x16x32_bf16 v[200:203], v[76:79], v[52:55], v[200:203]
    v_mfma_f32_16x16x32_bf16 v[204:207], v[80:83], v[52:55], v[204:207]
    v_mfma_f32_16x16x32_bf16 v[208:211], v[84:87], v[52:55], v[208:211]
    v_mfma_f32_16x16x32_bf16 v[212:215], v[88:91], v[52:55], v[212:215]
    v_mfma_f32_16x16x32_bf16 v[216:219], v[92:95], v[52:55], v[216:219]
    buffer_load_dwordx4 v[52:55], v5, s[12:15], s24 offen
    s_waitcnt vmcnt(20)
    v_mfma_f32_16x16x32_bf16 v[220:223], v[76:79], v[56:59], v[220:223]
    buffer_load_dwordx4 v[76:79], v2, s[12:15], s25 offen offset:0
    v_mfma_f32_16x16x32_bf16 v[224:227], v[80:83], v[56:59], v[224:227]
    buffer_load_dwordx4 v[80:83], v2, s[12:15], s25 offen offset:1024
    v_mfma_f32_16x16x32_bf16 v[228:231], v[84:87], v[56:59], v[228:231]
    buffer_load_dwordx4 v[84:87], v2, s[12:15], s25 offen offset:2048
    v_mfma_f32_16x16x32_bf16 v[232:235], v[88:91], v[56:59], v[232:235]
    buffer_load_dwordx4 v[88:91], v2, s[12:15], s25 offen offset:3072
    v_mfma_f32_16x16x32_bf16 v[236:239], v[92:95], v[56:59], v[236:239]
    buffer_load_dwordx4 v[92:95], v2, s[12:15], s26 offen
    buffer_load_dwordx4 v[56:59], v6, s[12:15], s24 offen
    s_add_u32 s24, s24, 4096
    s_add_u32 s25, s25, 5120
    s_add_u32 s26, s26, 5120
    s_waitcnt vmcnt(25)
    v_mfma_f32_16x16x32_bf16 v[160:163], v[96:99], v[60:63], v[160:163]
    v_mfma_f32_16x16x32_bf16 v[164:167], v[100:103], v[60:63], v[164:167]
    v_mfma_f32_16x16x32_bf16 v[168:171], v[104:107], v[60:63], v[168:171]
    v_mfma_f32_16x16x32_bf16 v[172:175], v[108:111], v[60:63], v[172:175]
    v_mfma_f32_16x16x32_bf16 v[176:179], v[112:115], v[60:63], v[176:179]
    buffer_load_dwordx4 v[60:63], v3, s[12:15], s24 offen
    s_waitcnt vmcnt(25)
    v_mfma_f32_16x16x32_bf16 v[180:183], v[96:99], v[64:67], v[180:183]
    v_mfma_f32_16x16x32_bf16 v[184:187], v[100:103], v[64:67], v[184:187]
    v_mfma_f32_16x16x32_bf16 v[188:191], v[104:107], v[64:67], v[188:191]
    v_mfma_f32_16x16x32_bf16 v[192:195], v[108:111], v[64:67], v[192:195]
    v_mfma_f32_16x16x32_bf16 v[196:199], v[112:115], v[64:67], v[196:199]
    buffer_load_dwordx4 v[64:67], v4, s[12:15], s24 offen
    s_waitcnt vmcnt(25)
    v_mfma_f32_16x16x32_bf16 v[200:203], v[96:99], v[68:71], v[200:203]
    v_mfma_f32_16x16x32_bf16 v[204:207], v[100:103], v[68:71], v[204:207]
    v_mfma_f32_16x16x32_bf16 v[208:211], v[104:107], v[68:71], v[208:211]
    v_mfma_f32_16x16x32_bf16 v[212:215], v[108:111], v[68:71], v[212:215]
    v_mfma_f32_16x16x32_bf16 v[216:219], v[112:115], v[68:71], v[216:219]
    buffer_load_dwordx4 v[68:71], v5, s[12:15], s24 offen
    s_waitcnt vmcnt(25)
    v_mfma_f32_16x16x32_bf16 v[220:223], v[96:99], v[72:75], v[220:223]
    buffer_load_dwordx4 v[96:99], v2, s[12:15], s25 offen offset:0
    v_mfma_f32_16x16x32_bf16 v[224:227], v[100:103], v[72:75], v[224:227]
    buffer_load_dwordx4 v[100:103], v2, s[12:15], s25 offen offset:1024
    v_mfma_f32_16x16x32_bf16 v[228:231], v[104:107], v[72:75], v[228:231]
    buffer_load_dwordx4 v[104:107], v2, s[12:15], s25 offen offset:2048
    v_mfma_f32_16x16x32_bf16 v[232:235], v[108:111], v[72:75], v[232:235]
    buffer_load_dwordx4 v[108:111], v2, s[12:15], s25 offen offset:3072
    v_mfma_f32_16x16x32_bf16 v[236:239], v[112:115], v[72:75], v[236:239]
    buffer_load_dwordx4 v[112:115], v2, s[12:15], s26 offen
    buffer_load_dwordx4 v[72:75], v6, s[12:15], s24 offen
    s_add_u32 s24, s24, 4096
    s_add_u32 s25, s25, 5120
    s_add_u32 s26, s26, 5120
    s_waitcnt vmcnt(30)
    v_mfma_f32_16x16x32_bf16 v[160:163], v[116:119], v[12:15], v[160:163]
    v_mfma_f32_16x16x32_bf16 v[164:167], v[120:123], v[12:15], v[164:167]
    v_mfma_f32_16x16x32_bf16 v[168:171], v[124:127], v[12:15], v[168:171]
    v_mfma_f32_16x16x32_bf16 v[172:175], v[128:131], v[12:15], v[172:175]
    v_mfma_f32_16x16x32_bf16 v[176:179], v[132:135], v[12:15], v[176:179]
    buffer_load_dwordx4 v[12:15], v3, s[12:15], s24 offen
    s_waitcnt vmcnt(30)
    v_mfma_f32_16x16x32_bf16 v[180:183], v[116:119], v[16:19], v[180:183]
    v_mfma_f32_16x16x32_bf16 v[184:187], v[120:123], v[16:19], v[184:187]
    v_mfma_f32_16x16x32_bf16 v[188:191], v[124:127], v[16:19], v[188:191]
    v_mfma_f32_16x16x32_bf16 v[192:195], v[128:131], v[16:19], v[192:195]
    v_mfma_f32_16x16x32_bf16 v[196:199], v[132:135], v[16:19], v[196:199]
    buffer_load_dwordx4 v[16:19], v4, s[12:15], s24 offen
    s_waitcnt vmcnt(30)
    v_mfma_f32_16x16x32_bf16 v[200:203], v[116:119], v[20:23], v[200:203]
    v_mfma_f32_16x16x32_bf16 v[204:207], v[120:123], v[20:23], v[204:207]
    v_mfma_f32_16x16x32_bf16 v[208:211], v[124:127], v[20:23], v[208:211]
    v_mfma_f32_16x16x32_bf16 v[212:215], v[128:131], v[20:23], v[212:215]
    v_mfma_f32_16x16x32_bf16 v[216:219], v[132:135], v[20:23], v[216:219]
    buffer_load_dwordx4 v[20:23], v5, s[12:15], s24 offen
    s_waitcnt vmcnt(30)
    v_mfma_f32_16x16x32_bf16 v[220:223], v[116:119], v[24:27], v[220:223]
    s_cmp_ge_u32 s28, 2
    s_cselect_b32 s25, s27, s25
    s_cselect_b32 s26, s27, s26
    buffer_load_dwordx4 v[116:119], v2, s[12:15], s25 offen offset:0
    v_mfma_f32_16x16x32_bf16 v[224:227], v[120:123], v[24:27], v[224:227]
    buffer_load_dwordx4 v[120:123], v2, s[12:15], s25 offen offset:1024
    v_mfma_f32_16x16x32_bf16 v[228:231], v[124:127], v[24:27], v[228:231]
    buffer_load_dwordx4 v[124:127], v2, s[12:15], s25 offen offset:2048
    v_mfma_f32_16x16x32_bf16 v[232:235], v[128:131], v[24:27], v[232:235]
    buffer_load_dwordx4 v[128:131], v2, s[12:15], s25 offen offset:3072
    v_mfma_f32_16x16x32_bf16 v[236:239], v[132:135], v[24:27], v[236:239]
    buffer_load_dwordx4 v[132:135], v2, s[12:15], s26 offen
    buffer_load_dwordx4 v[24:27], v6, s[12:15], s24 offen
    s_add_u32 s24, s24, 4096
    s_cmp_ge_u32 s28, 2
    s_cselect_b32 s24, s27, s24
    s_add_u32 s25, s25, 5120
    s_add_u32 s26, s26, 5120
    s_waitcnt vmcnt(35)
    v_mfma_f32_16x16x32_bf16 v[160:163], v[136:139], v[28:31], v[160:163]
    v_mfma_f32_16x16x32_bf16 v[164:167], v[140:143], v[28:31], v[164:167]
    v_mfma_f32_16x16x32_bf16 v[168:171], v[144:147], v[28:31], v[168:171]
    v_mfma_f32_16x16x32_bf16 v[172:175], v[148:151], v[28:31], v[172:175]
    v_mfma_f32_16x16x32_bf16 v[176:179], v[152:155], v[28:31], v[176:179]
    buffer_load_dwordx4 v[28:31], v3, s[12:15], s24 offen
    s_waitcnt vmcnt(35)
    v_mfma_f32_16x16x32_bf16 v[180:183], v[136:139], v[32:35], v[180:183]
    v_mfma_f32_16x16x32_bf16 v[184:187], v[140:143], v[32:35], v[184:187]
    v_mfma_f32_16x16x32_bf16 v[188:191], v[144:147], v[32:35], v[188:191]
    v_mfma_f32_16x16x32_bf16 v[192:195], v[148:151], v[32:35], v[192:195]
    v_mfma_f32_16x16x32_bf16 v[196:199], v[152:155], v[32:35], v[196:199]
    buffer_load_dwordx4 v[32:35], v4, s[12:15], s24 offen
    s_waitcnt vmcnt(35)
    v_mfma_f32_16x16x32_bf16 v[200:203], v[136:139], v[36:39], v[200:203]
    v_mfma_f32_16x16x32_bf16 v[204:207], v[140:143], v[36:39], v[204:207]
    v_mfma_f32_16x16x32_bf16 v[208:211], v[144:147], v[36:39], v[208:211]
    v_mfma_f32_16x16x32_bf16 v[212:215], v[148:151], v[36:39], v[212:215]
    v_mfma_f32_16x16x32_bf16 v[216:219], v[152:155], v[36:39], v[216:219]
    buffer_load_dwordx4 v[36:39], v5, s[12:15], s24 offen
    s_waitcnt vmcnt(30)
    v_mfma_f32_16x16x32_bf16 v[220:223], v[136:139], v[40:43], v[220:223]
    s_mul_i32 s34, s59, 74
    s_mul_i32 s35, s28, 5
    s_add_u32 s34, s34, s35
    s_add_u32 s34, s34, 54
    s_mul_i32 s25, s34, 5120
    s_add_u32 s25, s25, 10485760
    s_add_u32 s26, s25, 4096
    buffer_load_dwordx4 v[136:139], v2, s[12:15], s25 offen offset:0
    v_mfma_f32_16x16x32_bf16 v[224:227], v[140:143], v[40:43], v[224:227]
    buffer_load_dwordx4 v[140:143], v2, s[12:15], s25 offen offset:1024
    v_mfma_f32_16x16x32_bf16 v[228:231], v[144:147], v[40:43], v[228:231]
    buffer_load_dwordx4 v[144:147], v2, s[12:15], s25 offen offset:2048
    v_mfma_f32_16x16x32_bf16 v[232:235], v[148:151], v[40:43], v[232:235]
    buffer_load_dwordx4 v[148:151], v2, s[12:15], s25 offen offset:3072
    v_mfma_f32_16x16x32_bf16 v[236:239], v[152:155], v[40:43], v[236:239]
    buffer_load_dwordx4 v[152:155], v2, s[12:15], s26 offen
    buffer_load_dwordx4 v[40:43], v6, s[12:15], s24 offen
    s_add_u32 s24, s24, 4096
    s_add_u32 s25, s25, 5120
    s_add_u32 s26, s26, 5120
    s_waitcnt vmcnt(35)
    v_mfma_f32_16x16x32_bf16 v[160:163], v[240:243], v[44:47], v[160:163]
    v_mfma_f32_16x16x32_bf16 v[164:167], v[244:247], v[44:47], v[164:167]
    v_mfma_f32_16x16x32_bf16 v[168:171], v[248:251], v[44:47], v[168:171]
    v_mfma_f32_16x16x32_bf16 v[172:175], v[252:255], v[44:47], v[172:175]
    v_mfma_f32_16x16x32_bf16 v[176:179], v[156:159], v[44:47], v[176:179]
    s_waitcnt vmcnt(34)
    v_mfma_f32_16x16x32_bf16 v[180:183], v[240:243], v[48:51], v[180:183]
    v_mfma_f32_16x16x32_bf16 v[184:187], v[244:247], v[48:51], v[184:187]
    v_mfma_f32_16x16x32_bf16 v[188:191], v[248:251], v[48:51], v[188:191]
    v_mfma_f32_16x16x32_bf16 v[192:195], v[252:255], v[48:51], v[192:195]
    v_mfma_f32_16x16x32_bf16 v[196:199], v[156:159], v[48:51], v[196:199]
    s_waitcnt vmcnt(33)
    v_mfma_f32_16x16x32_bf16 v[200:203], v[240:243], v[52:55], v[200:203]
    v_mfma_f32_16x16x32_bf16 v[204:207], v[244:247], v[52:55], v[204:207]
    v_mfma_f32_16x16x32_bf16 v[208:211], v[248:251], v[52:55], v[208:211]
    v_mfma_f32_16x16x32_bf16 v[212:215], v[252:255], v[52:55], v[212:215]
    v_mfma_f32_16x16x32_bf16 v[216:219], v[156:159], v[52:55], v[216:219]
    s_waitcnt vmcnt(27)
    v_mfma_f32_16x16x32_bf16 v[220:223], v[240:243], v[56:59], v[220:223]
    buffer_load_dwordx4 v[240:243], v2, s[12:15], s25 offen offset:0
    v_mfma_f32_16x16x32_bf16 v[224:227], v[244:247], v[56:59], v[224:227]
    buffer_load_dwordx4 v[244:247], v2, s[12:15], s25 offen offset:1024
    v_mfma_f32_16x16x32_bf16 v[228:231], v[248:251], v[56:59], v[228:231]
    buffer_load_dwordx4 v[248:251], v2, s[12:15], s25 offen offset:2048
    v_mfma_f32_16x16x32_bf16 v[232:235], v[252:255], v[56:59], v[232:235]
    buffer_load_dwordx4 v[252:255], v2, s[12:15], s25 offen offset:3072
    v_mfma_f32_16x16x32_bf16 v[236:239], v[156:159], v[56:59], v[236:239]
    buffer_load_dwordx4 v[156:159], v2, s[12:15], s26 offen
    s_add_u32 s25, s25, 5120
    s_add_u32 s26, s26, 5120
    s_waitcnt vmcnt(31)
    v_mfma_f32_16x16x32_bf16 v[160:163], v[76:79], v[60:63], v[160:163]
    v_mfma_f32_16x16x32_bf16 v[164:167], v[80:83], v[60:63], v[164:167]
    v_mfma_f32_16x16x32_bf16 v[168:171], v[84:87], v[60:63], v[168:171]
    v_mfma_f32_16x16x32_bf16 v[172:175], v[88:91], v[60:63], v[172:175]
    v_mfma_f32_16x16x32_bf16 v[176:179], v[92:95], v[60:63], v[176:179]
    s_waitcnt vmcnt(30)
    v_mfma_f32_16x16x32_bf16 v[180:183], v[76:79], v[64:67], v[180:183]
    v_mfma_f32_16x16x32_bf16 v[184:187], v[80:83], v[64:67], v[184:187]
    v_mfma_f32_16x16x32_bf16 v[188:191], v[84:87], v[64:67], v[188:191]
    v_mfma_f32_16x16x32_bf16 v[192:195], v[88:91], v[64:67], v[192:195]
    v_mfma_f32_16x16x32_bf16 v[196:199], v[92:95], v[64:67], v[196:199]
    s_waitcnt vmcnt(29)
    v_mfma_f32_16x16x32_bf16 v[200:203], v[76:79], v[68:71], v[200:203]
    v_mfma_f32_16x16x32_bf16 v[204:207], v[80:83], v[68:71], v[204:207]
    v_mfma_f32_16x16x32_bf16 v[208:211], v[84:87], v[68:71], v[208:211]
    v_mfma_f32_16x16x32_bf16 v[212:215], v[88:91], v[68:71], v[212:215]
    v_mfma_f32_16x16x32_bf16 v[216:219], v[92:95], v[68:71], v[216:219]
    s_waitcnt vmcnt(23)
    v_mfma_f32_16x16x32_bf16 v[220:223], v[76:79], v[72:75], v[220:223]
    buffer_load_dwordx4 v[76:79], v2, s[12:15], s25 offen offset:0
    v_mfma_f32_16x16x32_bf16 v[224:227], v[80:83], v[72:75], v[224:227]
    buffer_load_dwordx4 v[80:83], v2, s[12:15], s25 offen offset:1024
    v_mfma_f32_16x16x32_bf16 v[228:231], v[84:87], v[72:75], v[228:231]
    buffer_load_dwordx4 v[84:87], v2, s[12:15], s25 offen offset:2048
    v_mfma_f32_16x16x32_bf16 v[232:235], v[88:91], v[72:75], v[232:235]
    buffer_load_dwordx4 v[88:91], v2, s[12:15], s25 offen offset:3072
    v_mfma_f32_16x16x32_bf16 v[236:239], v[92:95], v[72:75], v[236:239]
    buffer_load_dwordx4 v[92:95], v2, s[12:15], s26 offen
    s_add_u32 s25, s25, 5120
    s_add_u32 s26, s26, 5120
    s_waitcnt vmcnt(27)
    v_mfma_f32_16x16x32_bf16 v[160:163], v[96:99], v[12:15], v[160:163]
    v_mfma_f32_16x16x32_bf16 v[164:167], v[100:103], v[12:15], v[164:167]
    v_mfma_f32_16x16x32_bf16 v[168:171], v[104:107], v[12:15], v[168:171]
    v_mfma_f32_16x16x32_bf16 v[172:175], v[108:111], v[12:15], v[172:175]
    v_mfma_f32_16x16x32_bf16 v[176:179], v[112:115], v[12:15], v[176:179]
    s_waitcnt vmcnt(26)
    v_mfma_f32_16x16x32_bf16 v[180:183], v[96:99], v[16:19], v[180:183]
    v_mfma_f32_16x16x32_bf16 v[184:187], v[100:103], v[16:19], v[184:187]
    v_mfma_f32_16x16x32_bf16 v[188:191], v[104:107], v[16:19], v[188:191]
    v_mfma_f32_16x16x32_bf16 v[192:195], v[108:111], v[16:19], v[192:195]
    v_mfma_f32_16x16x32_bf16 v[196:199], v[112:115], v[16:19], v[196:199]
    s_waitcnt vmcnt(25)
    v_mfma_f32_16x16x32_bf16 v[200:203], v[96:99], v[20:23], v[200:203]
    v_mfma_f32_16x16x32_bf16 v[204:207], v[100:103], v[20:23], v[204:207]
    v_mfma_f32_16x16x32_bf16 v[208:211], v[104:107], v[20:23], v[208:211]
    v_mfma_f32_16x16x32_bf16 v[212:215], v[108:111], v[20:23], v[212:215]
    v_mfma_f32_16x16x32_bf16 v[216:219], v[112:115], v[20:23], v[216:219]
    s_waitcnt vmcnt(19)
    v_mfma_f32_16x16x32_bf16 v[220:223], v[96:99], v[24:27], v[220:223]
    buffer_load_dwordx4 v[96:99], v2, s[12:15], s25 offen offset:0
    v_mfma_f32_16x16x32_bf16 v[224:227], v[100:103], v[24:27], v[224:227]
    buffer_load_dwordx4 v[100:103], v2, s[12:15], s25 offen offset:1024
    v_mfma_f32_16x16x32_bf16 v[228:231], v[104:107], v[24:27], v[228:231]
    buffer_load_dwordx4 v[104:107], v2, s[12:15], s25 offen offset:2048
    v_mfma_f32_16x16x32_bf16 v[232:235], v[108:111], v[24:27], v[232:235]
    buffer_load_dwordx4 v[108:111], v2, s[12:15], s25 offen offset:3072
    v_mfma_f32_16x16x32_bf16 v[236:239], v[112:115], v[24:27], v[236:239]
    buffer_load_dwordx4 v[112:115], v2, s[12:15], s26 offen
    s_add_u32 s25, s25, 5120
    s_add_u32 s26, s26, 5120
    s_waitcnt vmcnt(23)
    v_mfma_f32_16x16x32_bf16 v[160:163], v[116:119], v[28:31], v[160:163]
    v_mfma_f32_16x16x32_bf16 v[164:167], v[120:123], v[28:31], v[164:167]
    v_mfma_f32_16x16x32_bf16 v[168:171], v[124:127], v[28:31], v[168:171]
    v_mfma_f32_16x16x32_bf16 v[172:175], v[128:131], v[28:31], v[172:175]
    v_mfma_f32_16x16x32_bf16 v[176:179], v[132:135], v[28:31], v[176:179]
    s_waitcnt vmcnt(22)
    v_mfma_f32_16x16x32_bf16 v[180:183], v[116:119], v[32:35], v[180:183]
    v_mfma_f32_16x16x32_bf16 v[184:187], v[120:123], v[32:35], v[184:187]
    v_mfma_f32_16x16x32_bf16 v[188:191], v[124:127], v[32:35], v[188:191]
    v_mfma_f32_16x16x32_bf16 v[192:195], v[128:131], v[32:35], v[192:195]
    v_mfma_f32_16x16x32_bf16 v[196:199], v[132:135], v[32:35], v[196:199]
    s_waitcnt vmcnt(21)
    v_mfma_f32_16x16x32_bf16 v[200:203], v[116:119], v[36:39], v[200:203]
    v_mfma_f32_16x16x32_bf16 v[204:207], v[120:123], v[36:39], v[204:207]
    v_mfma_f32_16x16x32_bf16 v[208:211], v[124:127], v[36:39], v[208:211]
    v_mfma_f32_16x16x32_bf16 v[212:215], v[128:131], v[36:39], v[212:215]
    v_mfma_f32_16x16x32_bf16 v[216:219], v[132:135], v[36:39], v[216:219]
    s_waitcnt vmcnt(15)
    v_mfma_f32_16x16x32_bf16 v[220:223], v[116:119], v[40:43], v[220:223]
    buffer_load_dwordx4 v[116:119], v2, s[12:15], s25 offen offset:0
    v_mfma_f32_16x16x32_bf16 v[224:227], v[120:123], v[40:43], v[224:227]
    buffer_load_dwordx4 v[120:123], v2, s[12:15], s25 offen offset:1024
    v_mfma_f32_16x16x32_bf16 v[228:231], v[124:127], v[40:43], v[228:231]
    buffer_load_dwordx4 v[124:127], v2, s[12:15], s25 offen offset:2048
    v_mfma_f32_16x16x32_bf16 v[232:235], v[128:131], v[40:43], v[232:235]
    buffer_load_dwordx4 v[128:131], v2, s[12:15], s25 offen offset:3072
    v_mfma_f32_16x16x32_bf16 v[236:239], v[132:135], v[40:43], v[236:239]
    buffer_load_dwordx4 v[132:135], v2, s[12:15], s26 offen
    s_add_u32 s25, s25, 5120
    s_add_u32 s26, s26, 5120
    v_and_b32 v3, 15, v1
    s_lshl_b32 s34, s58, 6
    s_lshl_b32 s35, s28, 4
    s_add_u32 s34, s34, s35
    v_add_u32 v3, s34, v3
    v_mul_u32_u24 v3, 1280, v3
    v_lshrrev_b32 v4, 4, v1
    v_lshl_add_u32 v3, v4, 3, v3
    s_mul_i32 s34, s59, 160
    v_add_u32 v3, s34, v3
    s_mov_b32 s8, s36
    s_mov_b32 s9, s37
    s_mov_b32 s10, 2621440
    s_mov_b32 s11, 0x20000
    s_mov_b32 s4, s64
    s_mov_b32 s5, s65
    s_mov_b32 s6, 2621440
    s_mov_b32 s7, 0x20000
    s_sub_u32 s34, s28, 1
    s_and_b32 s34, s34, 3
    s_mul_i32 s34, s34, 3072
    v_add_u32 v4, s34, v2
    s_sub_u32 s34, s28, 2
    s_and_b32 s34, s34, 3
    s_mul_i32 s34, s34, 3072
    v_add_u32 v5, s34, v2
    s_sub_u32 s34, s28, 3
    s_and_b32 s34, s34, 3
    s_mul_i32 s34, s34, 3072
    v_add_u32 v6, s34, v2
    s_mov_b32 s71, 0
L_p2_rd_spin:
    ds_read_b32 v11, v10 offset:20
    s_add_u32 s71, s71, 1
    s_waitcnt lgkmcnt(0)
    v_readfirstlane_b32 s34, v11
    s_nop 1
    s_cmp_ge_u32 s34, 1
    s_cbranch_scc1 L_p2_rd_ok
    s_cmp_lt_u32 s71, 2097152
    s_cbranch_scc1 L_p2_rd_spin
L_p2_rd_ok:
    s_cmp_ge_u32 s34, 5
    s_cbranch_scc1 L_p2_all
    ds_read_b128 v[12:15], v7 offset:0
    ds_read_b128 v[16:19], v7 offset:1024
    ds_read_b128 v[20:23], v7 offset:2048
    ds_read_b128 v[24:27], v7 offset:12416
    s_waitcnt lgkmcnt(3)
    v_mfma_f32_16x16x32_bf16 v[160:163], v[136:139], v[12:15], v[160:163]
    v_mfma_f32_16x16x32_bf16 v[164:167], v[140:143], v[12:15], v[164:167]
    v_mfma_f32_16x16x32_bf16 v[168:171], v[144:147], v[12:15], v[168:171]
    v_mfma_f32_16x16x32_bf16 v[172:175], v[148:151], v[12:15], v[172:175]
    v_mfma_f32_16x16x32_bf16 v[176:179], v[152:155], v[12:15], v[176:179]
    s_waitcnt lgkmcnt(2)
    v_mfma_f32_16x16x32_bf16 v[180:183], v[136:139], v[16:19], v[180:183]
    v_mfma_f32_16x16x32_bf16 v[184:187], v[140:143], v[16:19], v[184:187]
    v_mfma_f32_16x16x32_bf16 v[188:191], v[144:147], v[16:19], v[188:191]
    v_mfma_f32_16x16x32_bf16 v[192:195], v[148:151], v[16:19], v[192:195]
    v_mfma_f32_16x16x32_bf16 v[196:199], v[152:155], v[16:19], v[196:199]
    s_waitcnt lgkmcnt(1)
    v_mfma_f32_16x16x32_bf16 v[200:203], v[136:139], v[20:23], v[200:203]
    v_mfma_f32_16x16x32_bf16 v[204:207], v[140:143], v[20:23], v[204:207]
    v_mfma_f32_16x16x32_bf16 v[208:211], v[144:147], v[20:23], v[208:211]
    v_mfma_f32_16x16x32_bf16 v[212:215], v[148:151], v[20:23], v[212:215]
    v_mfma_f32_16x16x32_bf16 v[216:219], v[152:155], v[20:23], v[216:219]
    s_waitcnt lgkmcnt(0)
    v_mfma_f32_16x16x32_bf16 v[220:223], v[136:139], v[24:27], v[220:223]
    v_mfma_f32_16x16x32_bf16 v[224:227], v[140:143], v[24:27], v[224:227]
    v_mfma_f32_16x16x32_bf16 v[228:231], v[144:147], v[24:27], v[228:231]
    v_mfma_f32_16x16x32_bf16 v[232:235], v[148:151], v[24:27], v[232:235]
    v_mfma_f32_16x16x32_bf16 v[236:239], v[152:155], v[24:27], v[236:239]
    buffer_load_dwordx2 v[136:137], v3, s[8:11], 0 offen offset:0
    buffer_load_dwordx2 v[138:139], v3, s[8:11], 0 offen offset:32
    buffer_load_dwordx2 v[140:141], v3, s[8:11], 0 offen offset:64
    buffer_load_dwordx2 v[142:143], v3, s[8:11], 0 offen offset:96
    buffer_load_dwordx2 v[144:145], v3, s[8:11], 0 offen offset:128
    s_mov_b32 s71, 0
L_p2_rd1_spin:
    ds_read_b32 v11, v10 offset:20
    s_add_u32 s71, s71, 1
    s_waitcnt lgkmcnt(0)
    v_readfirstlane_b32 s34, v11
    s_nop 1
    s_cmp_ge_u32 s34, 2
    s_cbranch_scc1 L_p2_rd1_ok
    s_cmp_lt_u32 s71, 2097152
    s_cbranch_scc1 L_p2_rd1_spin
L_p2_rd1_ok:
    ds_read_b128 v[28:31], v7 offset:13440
    ds_read_b128 v[32:35], v7 offset:14464
    ds_read_b128 v[36:39], v7 offset:24832
    ds_read_b128 v[40:43], v7 offset:25856
    s_waitcnt vmcnt(20)
    s_waitcnt lgkmcnt(3)
    v_mfma_f32_16x16x32_bf16 v[160:163], v[240:243], v[28:31], v[160:163]
    v_mfma_f32_16x16x32_bf16 v[164:167], v[244:247], v[28:31], v[164:167]
    v_mfma_f32_16x16x32_bf16 v[168:171], v[248:251], v[28:31], v[168:171]
    v_mfma_f32_16x16x32_bf16 v[172:175], v[252:255], v[28:31], v[172:175]
    v_mfma_f32_16x16x32_bf16 v[176:179], v[156:159], v[28:31], v[176:179]
    s_waitcnt lgkmcnt(2)
    v_mfma_f32_16x16x32_bf16 v[180:183], v[240:243], v[32:35], v[180:183]
    v_mfma_f32_16x16x32_bf16 v[184:187], v[244:247], v[32:35], v[184:187]
    v_mfma_f32_16x16x32_bf16 v[188:191], v[248:251], v[32:35], v[188:191]
    v_mfma_f32_16x16x32_bf16 v[192:195], v[252:255], v[32:35], v[192:195]
    v_mfma_f32_16x16x32_bf16 v[196:199], v[156:159], v[32:35], v[196:199]
    s_waitcnt lgkmcnt(1)
    v_mfma_f32_16x16x32_bf16 v[200:203], v[240:243], v[36:39], v[200:203]
    v_mfma_f32_16x16x32_bf16 v[204:207], v[244:247], v[36:39], v[204:207]
    v_mfma_f32_16x16x32_bf16 v[208:211], v[248:251], v[36:39], v[208:211]
    v_mfma_f32_16x16x32_bf16 v[212:215], v[252:255], v[36:39], v[212:215]
    v_mfma_f32_16x16x32_bf16 v[216:219], v[156:159], v[36:39], v[216:219]
    s_waitcnt lgkmcnt(0)
    v_mfma_f32_16x16x32_bf16 v[220:223], v[240:243], v[40:43], v[220:223]
    v_mfma_f32_16x16x32_bf16 v[224:227], v[244:247], v[40:43], v[224:227]
    v_mfma_f32_16x16x32_bf16 v[228:231], v[248:251], v[40:43], v[228:231]
    v_mfma_f32_16x16x32_bf16 v[232:235], v[252:255], v[40:43], v[232:235]
    v_mfma_f32_16x16x32_bf16 v[236:239], v[156:159], v[40:43], v[236:239]
    s_mov_b32 s71, 0
L_p2_rd2_spin:
    ds_read_b32 v11, v10 offset:20
    s_add_u32 s71, s71, 1
    s_waitcnt lgkmcnt(0)
    v_readfirstlane_b32 s34, v11
    s_nop 1
    s_cmp_ge_u32 s34, 3
    s_cbranch_scc1 L_p2_rd2_ok
    s_cmp_lt_u32 s71, 2097152
    s_cbranch_scc1 L_p2_rd2_spin
L_p2_rd2_ok:
    ds_read_b128 v[44:47], v7 offset:26880
    ds_read_b128 v[48:51], v7 offset:37248
    ds_read_b128 v[52:55], v7 offset:38272
    ds_read_b128 v[56:59], v7 offset:39296
    s_waitcnt vmcnt(15)
    s_waitcnt lgkmcnt(3)
    v_mfma_f32_16x16x32_bf16 v[160:163], v[76:79], v[44:47], v[160:163]
    v_mfma_f32_16x16x32_bf16 v[164:167], v[80:83], v[44:47], v[164:167]
    v_mfma_f32_16x16x32_bf16 v[168:171], v[84:87], v[44:47], v[168:171]
    v_mfma_f32_16x16x32_bf16 v[172:175], v[88:91], v[44:47], v[172:175]
    v_mfma_f32_16x16x32_bf16 v[176:179], v[92:95], v[44:47], v[176:179]
    s_waitcnt lgkmcnt(2)
    v_mfma_f32_16x16x32_bf16 v[180:183], v[76:79], v[48:51], v[180:183]
    v_mfma_f32_16x16x32_bf16 v[184:187], v[80:83], v[48:51], v[184:187]
    v_mfma_f32_16x16x32_bf16 v[188:191], v[84:87], v[48:51], v[188:191]
    v_mfma_f32_16x16x32_bf16 v[192:195], v[88:91], v[48:51], v[192:195]
    v_mfma_f32_16x16x32_bf16 v[196:199], v[92:95], v[48:51], v[196:199]
    s_waitcnt lgkmcnt(1)
    v_mfma_f32_16x16x32_bf16 v[200:203], v[76:79], v[52:55], v[200:203]
    v_mfma_f32_16x16x32_bf16 v[204:207], v[80:83], v[52:55], v[204:207]
    v_mfma_f32_16x16x32_bf16 v[208:211], v[84:87], v[52:55], v[208:211]
    v_mfma_f32_16x16x32_bf16 v[212:215], v[88:91], v[52:55], v[212:215]
    v_mfma_f32_16x16x32_bf16 v[216:219], v[92:95], v[52:55], v[216:219]
    s_waitcnt lgkmcnt(0)
    v_mfma_f32_16x16x32_bf16 v[220:223], v[76:79], v[56:59], v[220:223]
    v_mfma_f32_16x16x32_bf16 v[224:227], v[80:83], v[56:59], v[224:227]
    v_mfma_f32_16x16x32_bf16 v[228:231], v[84:87], v[56:59], v[228:231]
    v_mfma_f32_16x16x32_bf16 v[232:235], v[88:91], v[56:59], v[232:235]
    v_mfma_f32_16x16x32_bf16 v[236:239], v[92:95], v[56:59], v[236:239]
    s_mov_b32 s71, 0
L_p2_rd3_spin:
    ds_read_b32 v11, v10 offset:20
    s_add_u32 s71, s71, 1
    s_waitcnt lgkmcnt(0)
    v_readfirstlane_b32 s34, v11
    s_nop 1
    s_cmp_ge_u32 s34, 4
    s_cbranch_scc1 L_p2_rd3_ok
    s_cmp_lt_u32 s71, 2097152
    s_cbranch_scc1 L_p2_rd3_spin
L_p2_rd3_ok:
    ds_read_b128 v[60:63], v7 offset:49664
    ds_read_b128 v[64:67], v7 offset:50688
    ds_read_b128 v[68:71], v7 offset:51712
    ds_read_b128 v[72:75], v7 offset:62080
    s_waitcnt vmcnt(10)
    s_waitcnt lgkmcnt(3)
    v_mfma_f32_16x16x32_bf16 v[160:163], v[96:99], v[60:63], v[160:163]
    v_mfma_f32_16x16x32_bf16 v[164:167], v[100:103], v[60:63], v[164:167]
    v_mfma_f32_16x16x32_bf16 v[168:171], v[104:107], v[60:63], v[168:171]
    v_mfma_f32_16x16x32_bf16 v[172:175], v[108:111], v[60:63], v[172:175]
    v_mfma_f32_16x16x32_bf16 v[176:179], v[112:115], v[60:63], v[176:179]
    s_waitcnt lgkmcnt(2)
    v_mfma_f32_16x16x32_bf16 v[180:183], v[96:99], v[64:67], v[180:183]
    v_mfma_f32_16x16x32_bf16 v[184:187], v[100:103], v[64:67], v[184:187]
    v_mfma_f32_16x16x32_bf16 v[188:191], v[104:107], v[64:67], v[188:191]
    v_mfma_f32_16x16x32_bf16 v[192:195], v[108:111], v[64:67], v[192:195]
    v_mfma_f32_16x16x32_bf16 v[196:199], v[112:115], v[64:67], v[196:199]
    s_waitcnt lgkmcnt(1)
    v_mfma_f32_16x16x32_bf16 v[200:203], v[96:99], v[68:71], v[200:203]
    v_mfma_f32_16x16x32_bf16 v[204:207], v[100:103], v[68:71], v[204:207]
    v_mfma_f32_16x16x32_bf16 v[208:211], v[104:107], v[68:71], v[208:211]
    v_mfma_f32_16x16x32_bf16 v[212:215], v[108:111], v[68:71], v[212:215]
    v_mfma_f32_16x16x32_bf16 v[216:219], v[112:115], v[68:71], v[216:219]
    s_waitcnt lgkmcnt(0)
    v_mfma_f32_16x16x32_bf16 v[220:223], v[96:99], v[72:75], v[220:223]
    v_mfma_f32_16x16x32_bf16 v[224:227], v[100:103], v[72:75], v[224:227]
    v_mfma_f32_16x16x32_bf16 v[228:231], v[104:107], v[72:75], v[228:231]
    v_mfma_f32_16x16x32_bf16 v[232:235], v[108:111], v[72:75], v[232:235]
    v_mfma_f32_16x16x32_bf16 v[236:239], v[112:115], v[72:75], v[236:239]
    s_mov_b32 s71, 0
L_p2_rd4_spin:
    ds_read_b32 v11, v10 offset:20
    s_add_u32 s71, s71, 1
    s_waitcnt lgkmcnt(0)
    v_readfirstlane_b32 s34, v11
    s_nop 1
    s_cmp_ge_u32 s34, 5
    s_cbranch_scc1 L_p2_rd4_ok
    s_cmp_lt_u32 s71, 2097152
    s_cbranch_scc1 L_p2_rd4_spin
L_p2_rd4_ok:
    ds_read_b128 v[16:19], v7 offset:64128
    ds_read_b128 v[20:23], v8 offset:0
    ds_read_b128 v[24:27], v8 offset:1024
    ds_read_b128 v[12:15], v7 offset:63104
    s_waitcnt vmcnt(5)
    s_waitcnt lgkmcnt(3)
    v_mfma_f32_16x16x32_bf16 v[180:183], v[116:119], v[16:19], v[180:183]
    v_mfma_f32_16x16x32_bf16 v[184:187], v[120:123], v[16:19], v[184:187]
    v_mfma_f32_16x16x32_bf16 v[188:191], v[124:127], v[16:19], v[188:191]
    v_mfma_f32_16x16x32_bf16 v[192:195], v[128:131], v[16:19], v[192:195]
    v_mfma_f32_16x16x32_bf16 v[196:199], v[132:135], v[16:19], v[196:199]
    s_waitcnt lgkmcnt(2)
    v_mfma_f32_16x16x32_bf16 v[200:203], v[116:119], v[20:23], v[200:203]
    v_mfma_f32_16x16x32_bf16 v[204:207], v[120:123], v[20:23], v[204:207]
    v_mfma_f32_16x16x32_bf16 v[208:211], v[124:127], v[20:23], v[208:211]
    v_mfma_f32_16x16x32_bf16 v[212:215], v[128:131], v[20:23], v[212:215]
    v_mfma_f32_16x16x32_bf16 v[216:219], v[132:135], v[20:23], v[216:219]
    s_waitcnt lgkmcnt(0)
    v_mfma_f32_16x16x32_bf16 v[220:223], v[116:119], v[24:27], v[220:223]
    ds_write_b128 v7, v[180:183] offset:0
    v_mfma_f32_16x16x32_bf16 v[224:227], v[120:123], v[24:27], v[224:227]
    ds_write_b128 v7, v[184:187] offset:1024
    v_mfma_f32_16x16x32_bf16 v[228:231], v[124:127], v[24:27], v[228:231]
    ds_write_b128 v7, v[188:191] offset:2048
    v_mfma_f32_16x16x32_bf16 v[232:235], v[128:131], v[24:27], v[232:235]
    ds_write_b128 v7, v[192:195] offset:12416
    v_mfma_f32_16x16x32_bf16 v[236:239], v[132:135], v[24:27], v[236:239]
    ds_write_b128 v7, v[196:199] offset:13440
    v_mfma_f32_16x16x32_bf16 v[160:163], v[116:119], v[12:15], v[160:163]
    ds_write_b128 v7, v[200:203] offset:14464
    v_mfma_f32_16x16x32_bf16 v[164:167], v[120:123], v[12:15], v[164:167]
    ds_write_b128 v7, v[204:207] offset:24832
    v_mfma_f32_16x16x32_bf16 v[168:171], v[124:127], v[12:15], v[168:171]
    ds_write_b128 v7, v[208:211] offset:25856
    v_mfma_f32_16x16x32_bf16 v[172:175], v[128:131], v[12:15], v[172:175]
    ds_write_b128 v7, v[212:215] offset:26880
    v_mfma_f32_16x16x32_bf16 v[176:179], v[132:135], v[12:15], v[176:179]
    ds_write_b128 v7, v[216:219] offset:37248
    s_branch L_p2_red
L_p2_all:
    ds_read_b128 v[12:15], v7 offset:0
    ds_read_b128 v[16:19], v7 offset:1024
    ds_read_b128 v[20:23], v7 offset:2048
    ds_read_b128 v[24:27], v7 offset:12416
    ds_read_b128 v[28:31], v7 offset:13440
    ds_read_b128 v[32:35], v7 offset:14464
    ds_read_b128 v[36:39], v7 offset:24832
    ds_read_b128 v[40:43], v7 offset:25856
    ds_read_b128 v[44:47], v7 offset:26880
    ds_read_b128 v[48:51], v7 offset:37248
    ds_read_b128 v[52:55], v7 offset:38272
    ds_read_b128 v[56:59], v7 offset:39296
    ds_read_b128 v[60:63], v7 offset:49664
    ds_read_b128 v[64:67], v7 offset:50688
    ds_read_b128 v[68:71], v7 offset:51712
    ds_read_b128 v[72:75], v7 offset:62080
    s_waitcnt lgkmcnt(15)
    v_mfma_f32_16x16x32_bf16 v[160:163], v[136:139], v[12:15], v[160:163]
    v_mfma_f32_16x16x32_bf16 v[164:167], v[140:143], v[12:15], v[164:167]
    v_mfma_f32_16x16x32_bf16 v[168:171], v[144:147], v[12:15], v[168:171]
    v_mfma_f32_16x16x32_bf16 v[172:175], v[148:151], v[12:15], v[172:175]
    v_mfma_f32_16x16x32_bf16 v[176:179], v[152:155], v[12:15], v[176:179]
    ds_read_b128 v[12:15], v7 offset:63104
    s_waitcnt lgkmcnt(15)
    v_mfma_f32_16x16x32_bf16 v[180:183], v[136:139], v[16:19], v[180:183]
    v_mfma_f32_16x16x32_bf16 v[184:187], v[140:143], v[16:19], v[184:187]
    v_mfma_f32_16x16x32_bf16 v[188:191], v[144:147], v[16:19], v[188:191]
    v_mfma_f32_16x16x32_bf16 v[192:195], v[148:151], v[16:19], v[192:195]
    v_mfma_f32_16x16x32_bf16 v[196:199], v[152:155], v[16:19], v[196:199]
    ds_read_b128 v[16:19], v7 offset:64128
    s_waitcnt lgkmcnt(15)
    v_mfma_f32_16x16x32_bf16 v[200:203], v[136:139], v[20:23], v[200:203]
    v_mfma_f32_16x16x32_bf16 v[204:207], v[140:143], v[20:23], v[204:207]
    v_mfma_f32_16x16x32_bf16 v[208:211], v[144:147], v[20:23], v[208:211]
    v_mfma_f32_16x16x32_bf16 v[212:215], v[148:151], v[20:23], v[212:215]
    v_mfma_f32_16x16x32_bf16 v[216:219], v[152:155], v[20:23], v[216:219]
    ds_read_b128 v[20:23], v8 offset:0
    s_waitcnt lgkmcnt(15)
    v_mfma_f32_16x16x32_bf16 v[220:223], v[136:139], v[24:27], v[220:223]
    v_mfma_f32_16x16x32_bf16 v[224:227], v[140:143], v[24:27], v[224:227]
    v_mfma_f32_16x16x32_bf16 v[228:231], v[144:147], v[24:27], v[228:231]
    v_mfma_f32_16x16x32_bf16 v[232:235], v[148:151], v[24:27], v[232:235]
    v_mfma_f32_16x16x32_bf16 v[236:239], v[152:155], v[24:27], v[236:239]
    ds_read_b128 v[24:27], v8 offset:1024
    buffer_load_dwordx2 v[136:137], v3, s[8:11], 0 offen offset:0
    buffer_load_dwordx2 v[138:139], v3, s[8:11], 0 offen offset:32
    buffer_load_dwordx2 v[140:141], v3, s[8:11], 0 offen offset:64
    buffer_load_dwordx2 v[142:143], v3, s[8:11], 0 offen offset:96
    buffer_load_dwordx2 v[144:145], v3, s[8:11], 0 offen offset:128
    s_waitcnt vmcnt(20)
    s_waitcnt lgkmcnt(15)
    v_mfma_f32_16x16x32_bf16 v[160:163], v[240:243], v[28:31], v[160:163]
    v_mfma_f32_16x16x32_bf16 v[164:167], v[244:247], v[28:31], v[164:167]
    v_mfma_f32_16x16x32_bf16 v[168:171], v[248:251], v[28:31], v[168:171]
    v_mfma_f32_16x16x32_bf16 v[172:175], v[252:255], v[28:31], v[172:175]
    v_mfma_f32_16x16x32_bf16 v[176:179], v[156:159], v[28:31], v[176:179]
    s_waitcnt lgkmcnt(14)
    v_mfma_f32_16x16x32_bf16 v[180:183], v[240:243], v[32:35], v[180:183]
    v_mfma_f32_16x16x32_bf16 v[184:187], v[244:247], v[32:35], v[184:187]
    v_mfma_f32_16x16x32_bf16 v[188:191], v[248:251], v[32:35], v[188:191]
    v_mfma_f32_16x16x32_bf16 v[192:195], v[252:255], v[32:35], v[192:195]
    v_mfma_f32_16x16x32_bf16 v[196:199], v[156:159], v[32:35], v[196:199]
    s_waitcnt lgkmcnt(13)
    v_mfma_f32_16x16x32_bf16 v[200:203], v[240:243], v[36:39], v[200:203]
    v_mfma_f32_16x16x32_bf16 v[204:207], v[244:247], v[36:39], v[204:207]
    v_mfma_f32_16x16x32_bf16 v[208:211], v[248:251], v[36:39], v[208:211]
    v_mfma_f32_16x16x32_bf16 v[212:215], v[252:255], v[36:39], v[212:215]
    v_mfma_f32_16x16x32_bf16 v[216:219], v[156:159], v[36:39], v[216:219]
    s_waitcnt lgkmcnt(12)
    v_mfma_f32_16x16x32_bf16 v[220:223], v[240:243], v[40:43], v[220:223]
    v_mfma_f32_16x16x32_bf16 v[224:227], v[244:247], v[40:43], v[224:227]
    v_mfma_f32_16x16x32_bf16 v[228:231], v[248:251], v[40:43], v[228:231]
    v_mfma_f32_16x16x32_bf16 v[232:235], v[252:255], v[40:43], v[232:235]
    v_mfma_f32_16x16x32_bf16 v[236:239], v[156:159], v[40:43], v[236:239]
    s_waitcnt vmcnt(15)
    s_waitcnt lgkmcnt(11)
    v_mfma_f32_16x16x32_bf16 v[160:163], v[76:79], v[44:47], v[160:163]
    v_mfma_f32_16x16x32_bf16 v[164:167], v[80:83], v[44:47], v[164:167]
    v_mfma_f32_16x16x32_bf16 v[168:171], v[84:87], v[44:47], v[168:171]
    v_mfma_f32_16x16x32_bf16 v[172:175], v[88:91], v[44:47], v[172:175]
    v_mfma_f32_16x16x32_bf16 v[176:179], v[92:95], v[44:47], v[176:179]
    s_waitcnt lgkmcnt(10)
    v_mfma_f32_16x16x32_bf16 v[180:183], v[76:79], v[48:51], v[180:183]
    v_mfma_f32_16x16x32_bf16 v[184:187], v[80:83], v[48:51], v[184:187]
    v_mfma_f32_16x16x32_bf16 v[188:191], v[84:87], v[48:51], v[188:191]
    v_mfma_f32_16x16x32_bf16 v[192:195], v[88:91], v[48:51], v[192:195]
    v_mfma_f32_16x16x32_bf16 v[196:199], v[92:95], v[48:51], v[196:199]
    s_waitcnt lgkmcnt(9)
    v_mfma_f32_16x16x32_bf16 v[200:203], v[76:79], v[52:55], v[200:203]
    v_mfma_f32_16x16x32_bf16 v[204:207], v[80:83], v[52:55], v[204:207]
    v_mfma_f32_16x16x32_bf16 v[208:211], v[84:87], v[52:55], v[208:211]
    v_mfma_f32_16x16x32_bf16 v[212:215], v[88:91], v[52:55], v[212:215]
    v_mfma_f32_16x16x32_bf16 v[216:219], v[92:95], v[52:55], v[216:219]
    s_waitcnt lgkmcnt(8)
    v_mfma_f32_16x16x32_bf16 v[220:223], v[76:79], v[56:59], v[220:223]
    v_mfma_f32_16x16x32_bf16 v[224:227], v[80:83], v[56:59], v[224:227]
    v_mfma_f32_16x16x32_bf16 v[228:231], v[84:87], v[56:59], v[228:231]
    v_mfma_f32_16x16x32_bf16 v[232:235], v[88:91], v[56:59], v[232:235]
    v_mfma_f32_16x16x32_bf16 v[236:239], v[92:95], v[56:59], v[236:239]
    s_waitcnt vmcnt(10)
    s_waitcnt lgkmcnt(7)
    v_mfma_f32_16x16x32_bf16 v[160:163], v[96:99], v[60:63], v[160:163]
    v_mfma_f32_16x16x32_bf16 v[164:167], v[100:103], v[60:63], v[164:167]
    v_mfma_f32_16x16x32_bf16 v[168:171], v[104:107], v[60:63], v[168:171]
    v_mfma_f32_16x16x32_bf16 v[172:175], v[108:111], v[60:63], v[172:175]
    v_mfma_f32_16x16x32_bf16 v[176:179], v[112:115], v[60:63], v[176:179]
    s_waitcnt lgkmcnt(6)
    v_mfma_f32_16x16x32_bf16 v[180:183], v[96:99], v[64:67], v[180:183]
    v_mfma_f32_16x16x32_bf16 v[184:187], v[100:103], v[64:67], v[184:187]
    v_mfma_f32_16x16x32_bf16 v[188:191], v[104:107], v[64:67], v[188:191]
    v_mfma_f32_16x16x32_bf16 v[192:195], v[108:111], v[64:67], v[192:195]
    v_mfma_f32_16x16x32_bf16 v[196:199], v[112:115], v[64:67], v[196:199]
    s_waitcnt lgkmcnt(5)
    v_mfma_f32_16x16x32_bf16 v[200:203], v[96:99], v[68:71], v[200:203]
    v_mfma_f32_16x16x32_bf16 v[204:207], v[100:103], v[68:71], v[204:207]
    v_mfma_f32_16x16x32_bf16 v[208:211], v[104:107], v[68:71], v[208:211]
    v_mfma_f32_16x16x32_bf16 v[212:215], v[108:111], v[68:71], v[212:215]
    v_mfma_f32_16x16x32_bf16 v[216:219], v[112:115], v[68:71], v[216:219]
    s_waitcnt lgkmcnt(4)
    v_mfma_f32_16x16x32_bf16 v[220:223], v[96:99], v[72:75], v[220:223]
    v_mfma_f32_16x16x32_bf16 v[224:227], v[100:103], v[72:75], v[224:227]
    v_mfma_f32_16x16x32_bf16 v[228:231], v[104:107], v[72:75], v[228:231]
    v_mfma_f32_16x16x32_bf16 v[232:235], v[108:111], v[72:75], v[232:235]
    v_mfma_f32_16x16x32_bf16 v[236:239], v[112:115], v[72:75], v[236:239]
    s_waitcnt vmcnt(5)
    s_waitcnt lgkmcnt(2)
    v_mfma_f32_16x16x32_bf16 v[180:183], v[116:119], v[16:19], v[180:183]
    v_mfma_f32_16x16x32_bf16 v[184:187], v[120:123], v[16:19], v[184:187]
    v_mfma_f32_16x16x32_bf16 v[188:191], v[124:127], v[16:19], v[188:191]
    v_mfma_f32_16x16x32_bf16 v[192:195], v[128:131], v[16:19], v[192:195]
    v_mfma_f32_16x16x32_bf16 v[196:199], v[132:135], v[16:19], v[196:199]
    s_waitcnt lgkmcnt(1)
    v_mfma_f32_16x16x32_bf16 v[200:203], v[116:119], v[20:23], v[200:203]
    v_mfma_f32_16x16x32_bf16 v[204:207], v[120:123], v[20:23], v[204:207]
    v_mfma_f32_16x16x32_bf16 v[208:211], v[124:127], v[20:23], v[208:211]
    v_mfma_f32_16x16x32_bf16 v[212:215], v[128:131], v[20:23], v[212:215]
    v_mfma_f32_16x16x32_bf16 v[216:219], v[132:135], v[20:23], v[216:219]
    s_waitcnt lgkmcnt(0)
    v_mfma_f32_16x16x32_bf16 v[220:223], v[116:119], v[24:27], v[220:223]
    ds_write_b128 v7, v[180:183] offset:0
    v_mfma_f32_16x16x32_bf16 v[224:227], v[120:123], v[24:27], v[224:227]
    ds_write_b128 v7, v[184:187] offset:1024
    v_mfma_f32_16x16x32_bf16 v[228:231], v[124:127], v[24:27], v[228:231]
    ds_write_b128 v7, v[188:191] offset:2048
    v_mfma_f32_16x16x32_bf16 v[232:235], v[128:131], v[24:27], v[232:235]
    ds_write_b128 v7, v[192:195] offset:12416
    v_mfma_f32_16x16x32_bf16 v[236:239], v[132:135], v[24:27], v[236:239]
    ds_write_b128 v7, v[196:199] offset:13440
    v_mfma_f32_16x16x32_bf16 v[160:163], v[116:119], v[12:15], v[160:163]
    ds_write_b128 v7, v[200:203] offset:14464
    v_mfma_f32_16x16x32_bf16 v[164:167], v[120:123], v[12:15], v[164:167]
    ds_write_b128 v7, v[204:207] offset:24832
    v_mfma_f32_16x16x32_bf16 v[168:171], v[124:127], v[12:15], v[168:171]
    ds_write_b128 v7, v[208:211] offset:25856
    v_mfma_f32_16x16x32_bf16 v[172:175], v[128:131], v[12:15], v[172:175]
    ds_write_b128 v7, v[212:215] offset:26880
    v_mfma_f32_16x16x32_bf16 v[176:179], v[132:135], v[12:15], v[176:179]
    ds_write_b128 v7, v[216:219] offset:37248
L_p2_red:
    s_nop 1
    ds_write_b128 v7, v[220:223] offset:38272
    ds_write_b128 v7, v[224:227] offset:39296
    ds_write_b128 v7, v[228:231] offset:49664
    ds_write_b128 v7, v[232:235] offset:50688
    ds_write_b128 v7, v[236:239] offset:51712
    s_waitcnt lgkmcnt(0)
    s_barrier
    ds_read_b128 v[12:15], v4 offset:0
    ds_read_b128 v[16:19], v4 offset:1024
    ds_read_b128 v[20:23], v4 offset:2048
    ds_read_b128 v[24:27], v4 offset:12416
    ds_read_b128 v[28:31], v4 offset:13440
    ds_read_b128 v[32:35], v5 offset:14464
    ds_read_b128 v[36:39], v5 offset:24832
    ds_read_b128 v[40:43], v5 offset:25856
    ds_read_b128 v[44:47], v5 offset:26880
    ds_read_b128 v[48:51], v5 offset:37248
    ds_read_b128 v[52:55], v6 offset:38272
    ds_read_b128 v[56:59], v6 offset:39296
    ds_read_b128 v[60:63], v6 offset:49664
    ds_read_b128 v[64:67], v6 offset:50688
    ds_read_b128 v[68:71], v6 offset:51712
    s_mov_b32 s35, 0xffff0000
    s_waitcnt lgkmcnt(10)
    v_add_f32 v160, v160, v12
    v_add_f32 v161, v161, v13
    v_add_f32 v162, v162, v14
    v_add_f32 v163, v163, v15
    v_add_f32 v164, v164, v16
    v_add_f32 v165, v165, v17
    v_add_f32 v166, v166, v18
    v_add_f32 v167, v167, v19
    v_add_f32 v168, v168, v20
    v_add_f32 v169, v169, v21
    v_add_f32 v170, v170, v22
    v_add_f32 v171, v171, v23
    v_add_f32 v172, v172, v24
    v_add_f32 v173, v173, v25
    v_add_f32 v174, v174, v26
    v_add_f32 v175, v175, v27
    v_add_f32 v176, v176, v28
    v_add_f32 v177, v177, v29
    v_add_f32 v178, v178, v30
    v_add_f32 v179, v179, v31
    s_waitcnt lgkmcnt(5)
    v_add_f32 v160, v160, v32
    v_add_f32 v161, v161, v33
    v_add_f32 v162, v162, v34
    v_add_f32 v163, v163, v35
    v_add_f32 v164, v164, v36
    v_add_f32 v165, v165, v37
    v_add_f32 v166, v166, v38
    v_add_f32 v167, v167, v39
    v_add_f32 v168, v168, v40
    v_add_f32 v169, v169, v41
    v_add_f32 v170, v170, v42
    v_add_f32 v171, v171, v43
    v_add_f32 v172, v172, v44
    v_add_f32 v173, v173, v45
    v_add_f32 v174, v174, v46
    v_add_f32 v175, v175, v47
    v_add_f32 v176, v176, v48
    v_add_f32 v177, v177, v49
    v_add_f32 v178, v178, v50
    v_add_f32 v179, v179, v51
    s_waitcnt lgkmcnt(4)
    v_add_f32 v160, v160, v52
    v_add_f32 v161, v161, v53
    v_add_f32 v162, v162, v54
    v_add_f32 v163, v163, v55
    s_waitcnt vmcnt(0)
    v_lshlrev_b32 v76, 16, v136
    v_and_b32 v77, s35, v136
    v_lshlrev_b32 v78, 16, v137
    v_and_b32 v79, s35, v137
    v_add_f32 v160, v160, v76
    v_add_f32 v161, v161, v77
    v_add_f32 v162, v162, v78
    v_add_f32 v163, v163, v79
    v_cvt_pk_bf16_f32 v160, v160, v161
    v_cvt_pk_bf16_f32 v161, v162, v163
    buffer_store_dwordx2 v[160:161], v3, s[4:7], 0 offen offset:0
    s_waitcnt lgkmcnt(3)
    v_add_f32 v164, v164, v56
    v_add_f32 v165, v165, v57
    v_add_f32 v166, v166, v58
    v_add_f32 v167, v167, v59
    v_lshlrev_b32 v76, 16, v138
    v_and_b32 v77, s35, v138
    v_lshlrev_b32 v78, 16, v139
    v_and_b32 v79, s35, v139
    v_add_f32 v164, v164, v76
    v_add_f32 v165, v165, v77
    v_add_f32 v166, v166, v78
    v_add_f32 v167, v167, v79
    v_cvt_pk_bf16_f32 v164, v164, v165
    v_cvt_pk_bf16_f32 v165, v166, v167
    buffer_store_dwordx2 v[164:165], v3, s[4:7], 0 offen offset:32
    s_waitcnt lgkmcnt(2)
    v_add_f32 v168, v168, v60
    v_add_f32 v169, v169, v61
    v_add_f32 v170, v170, v62
    v_add_f32 v171, v171, v63
    v_lshlrev_b32 v76, 16, v140
    v_and_b32 v77, s35, v140
    v_lshlrev_b32 v78, 16, v141
    v_and_b32 v79, s35, v141
    v_add_f32 v168, v168, v76
    v_add_f32 v169, v169, v77
    v_add_f32 v170, v170, v78
    v_add_f32 v171, v171, v79
    v_cvt_pk_bf16_f32 v168, v168, v169
    v_cvt_pk_bf16_f32 v169, v170, v171
    buffer_store_dwordx2 v[168:169], v3, s[4:7], 0 offen offset:64
    s_waitcnt lgkmcnt(1)
    v_add_f32 v172, v172, v64
    v_add_f32 v173, v173, v65
    v_add_f32 v174, v174, v66
    v_add_f32 v175, v175, v67
    v_lshlrev_b32 v76, 16, v142
    v_and_b32 v77, s35, v142
    v_lshlrev_b32 v78, 16, v143
    v_and_b32 v79, s35, v143
    v_add_f32 v172, v172, v76
    v_add_f32 v173, v173, v77
    v_add_f32 v174, v174, v78
    v_add_f32 v175, v175, v79
    v_cvt_pk_bf16_f32 v172, v172, v173
    v_cvt_pk_bf16_f32 v173, v174, v175
    buffer_store_dwordx2 v[172:173], v3, s[4:7], 0 offen offset:96
    s_waitcnt lgkmcnt(0)
    v_add_f32 v176, v176, v68
    v_add_f32 v177, v177, v69
    v_add_f32 v178, v178, v70
    v_add_f32 v179, v179, v71
    v_lshlrev_b32 v76, 16, v144
    v_and_b32 v77, s35, v144
    v_lshlrev_b32 v78, 16, v145
    v_and_b32 v79, s35, v145
    v_add_f32 v176, v176, v76
    v_add_f32 v177, v177, v77
    v_add_f32 v178, v178, v78
    v_add_f32 v179, v179, v79
    v_cvt_pk_bf16_f32 v176, v176, v177
    v_cvt_pk_bf16_f32 v177, v178, v179
    buffer_store_dwordx2 v[176:177], v3, s[4:7], 0 offen offset:128
    s_endpgm
L_p2_aux:
    s_setprio 3
    s_cmp_eq_u32 s22, 3
    s_cselect_b32 s34, 3, 0
    s_cmp_eq_u32 s21, 9
    s_cselect_b32 s34, 1, s34
    s_cmp_lt_u32 s28, s34
    s_cselect_b32 s66, 1, 0
    s_cbranch_scc1 L_p2_duty
    ds_write_b32 v10, v10 offset:64
L_p2_duty:
    s_mov_b32 s54, 256
    s_lshl_b32 s55, s2, 7
    s_lshl_b32 s34, s28, 4
    s_add_u32 s55, s55, s34
    s_add_u32 s55, s55, 17170432
    s_mul_i32 s24, s28, 8192
    s_add_u32 s24, s24, 17104896
    v_cmp_le_u32 s[48:49], 16, v1
    v_cmp_le_u32 s[50:51], 32, v1
    v_cmp_le_u32 s[52:53], 48, v1
    s_mov_b32 s25, 0
    s_mov_b32 s26, 0
    s_mul_i32 s34, s58, 20
    s_mul_i32 s35, s28, 5
    s_add_u32 s34, s34, s35
    s_lshl_b32 s30, s34, 12
    s_add_u32 s30, s30, 7340032
L_p2_kv_again:
    v_lshrrev_b32 v220, 4, v1
    v_and_b32 v221, 15, v1
    v_mov_b32 v224, 163712
    s_lshl_b32 s35, s28, 12
    s_add_u32 s35, s35, 115712
    v_and_b32 v222, 3, v221
    v_add_u32 v222, 0, v222
    v_mul_u32_u24 v223, 984, v222
    v_lshl_add_u32 v223, v220, 4, v223
    v_add_u32 v223, 968, v223
    v_lshrrev_b32 v225, 2, v222
    v_mul_u32_u24 v225, 12288, v225
    v_add3_u32 v223, v223, v225, s35
    v_mul_u32_u24 v222, 20, v222
    v_lshlrev_b32 v252, 3, v220
    v_sub_u32 v222, v252, v222
    v_add_u32 v222, 4, v222
    v_add_u32 v165, 0, v222
    v_add_u32 v166, 0, v223
    v_cmp_ge_u32 vcc, 20, v165
    s_nop 1
    v_cndmask_b32 v164, v224, v166, vcc
    v_add_u32 v169, 32, v222
    v_add_u32 v170, 64, v223
    v_cmp_ge_u32 vcc, 20, v169
    s_nop 1
    v_cndmask_b32 v168, v224, v170, vcc
    v_add_u32 v173, 64, v222
    v_add_u32 v174, 128, v223
    v_cmp_ge_u32 vcc, 20, v173
    s_nop 1
    v_cndmask_b32 v172, v224, v174, vcc
    v_and_b32 v222, 3, v221
    v_add_u32 v222, 4, v222
    v_mul_u32_u24 v223, 984, v222
    v_lshl_add_u32 v223, v220, 4, v223
    v_add_u32 v223, 968, v223
    v_lshrrev_b32 v225, 2, v222
    v_mul_u32_u24 v225, 12288, v225
    v_add3_u32 v223, v223, v225, s35
    v_mul_u32_u24 v222, 20, v222
    v_lshlrev_b32 v252, 3, v220
    v_sub_u32 v222, v252, v222
    v_add_u32 v222, 4, v222
    v_add_u32 v177, 64, v222
    v_add_u32 v178, 128, v223
    v_cmp_ge_u32 vcc, 20, v177
    s_nop 1
    v_cndmask_b32 v176, v224, v178, vcc
    v_add_u32 v181, 96, v222
    v_add_u32 v182, 192, v223
    v_cmp_ge_u32 vcc, 20, v181
    s_nop 1
    v_cndmask_b32 v180, v224, v182, vcc
    v_add_u32 v185, 128, v222
    v_add_u32 v186, 256, v223
    v_cmp_ge_u32 vcc, 20, v185
    s_nop 1
    v_cndmask_b32 v184, v224, v186, vcc
    v_add_u32 v252, 0, v221
    v_mul_u32_u24 v222, 205, v252
    v_lshrrev_b32 v222, 12, v222
    v_mul_u32_u24 v223, 24, v222
    v_mad_u32_u24 v223, v252, 48, v223
    v_lshl_add_u32 v223, v220, 4, v223
    v_add_u32 v223, 8, v223
    v_lshrrev_b32 v225, 2, v222
    v_mul_u32_u24 v225, 12288, v225
    v_add3_u32 v223, v223, v225, s35
    v_mul_u32_u24 v222, 20, v222
    v_lshlrev_b32 v252, 3, v220
    v_sub_u32 v222, v252, v222
    v_add_u32 v222, 4, v222
    v_add_u32 v93, 0, v222
    v_add_u32 v94, 0, v223
    v_cmp_ge_u32 vcc, 20, v93
    s_nop 1
    v_cndmask_b32 v92, v224, v94, vcc
    v_add_u32 v252, 16, v221
    v_mul_u32_u24 v222, 205, v252
    v_lshrrev_b32 v222, 12, v222
    v_mul_u32_u24 v223, 24, v222
    v_mad_u32_u24 v223, v252, 48, v223
    v_lshl_add_u32 v223, v220, 4, v223
    v_add_u32 v223, 8, v223
    v_lshrrev_b32 v225, 2, v222
    v_mul_u32_u24 v225, 12288, v225
    v_add3_u32 v223, v223, v225, s35
    v_mul_u32_u24 v222, 20, v222
    v_lshlrev_b32 v252, 3, v220
    v_sub_u32 v222, v252, v222
    v_add_u32 v222, 4, v222
    v_add_u32 v97, 0, v222
    v_add_u32 v98, 0, v223
    v_cmp_ge_u32 vcc, 20, v97
    s_nop 1
    v_cndmask_b32 v96, v224, v98, vcc
    v_add_u32 v101, 32, v222
    v_add_u32 v102, 64, v223
    v_cmp_ge_u32 vcc, 20, v101
    s_nop 1
    v_cndmask_b32 v100, v224, v102, vcc
    v_add_u32 v252, 32, v221
    v_mul_u32_u24 v222, 205, v252
    v_lshrrev_b32 v222, 12, v222
    v_mul_u32_u24 v223, 24, v222
    v_mad_u32_u24 v223, v252, 48, v223
    v_lshl_add_u32 v223, v220, 4, v223
    v_add_u32 v223, 8, v223
    v_lshrrev_b32 v225, 2, v222
    v_mul_u32_u24 v225, 12288, v225
    v_add3_u32 v223, v223, v225, s35
    v_mul_u32_u24 v222, 20, v222
    v_lshlrev_b32 v252, 3, v220
    v_sub_u32 v222, v252, v222
    v_add_u32 v222, 4, v222
    v_add_u32 v105, 0, v222
    v_add_u32 v106, 0, v223
    v_cmp_ge_u32 vcc, 20, v105
    s_nop 1
    v_cndmask_b32 v104, v224, v106, vcc
    v_add_u32 v109, 32, v222
    v_add_u32 v110, 64, v223
    v_cmp_ge_u32 vcc, 20, v109
    s_nop 1
    v_cndmask_b32 v108, v224, v110, vcc
    v_add_u32 v252, 48, v221
    v_mul_u32_u24 v222, 205, v252
    v_lshrrev_b32 v222, 12, v222
    v_mul_u32_u24 v223, 24, v222
    v_mad_u32_u24 v223, v252, 48, v223
    v_lshl_add_u32 v223, v220, 4, v223
    v_add_u32 v223, 8, v223
    v_lshrrev_b32 v225, 2, v222
    v_mul_u32_u24 v225, 12288, v225
    v_add3_u32 v223, v223, v225, s35
    v_mul_u32_u24 v222, 20, v222
    v_lshlrev_b32 v252, 3, v220
    v_sub_u32 v222, v252, v222
    v_add_u32 v222, 4, v222
    v_add_u32 v113, 32, v222
    v_add_u32 v114, 64, v223
    v_cmp_ge_u32 vcc, 20, v113
    s_nop 1
    v_cndmask_b32 v112, v224, v114, vcc
    v_add_u32 v117, 64, v222
    v_add_u32 v118, 128, v223
    v_cmp_ge_u32 vcc, 20, v117
    s_nop 1
    v_cndmask_b32 v116, v224, v118, vcc
    v_add_u32 v252, 64, v221
    v_mul_u32_u24 v222, 205, v252
    v_lshrrev_b32 v222, 12, v222
    v_mul_u32_u24 v223, 24, v222
    v_mad_u32_u24 v223, v252, 48, v223
    v_lshl_add_u32 v223, v220, 4, v223
    v_add_u32 v223, 8, v223
    v_lshrrev_b32 v225, 2, v222
    v_mul_u32_u24 v225, 12288, v225
    v_add3_u32 v223, v223, v225, s35
    v_mul_u32_u24 v222, 20, v222
    v_lshlrev_b32 v252, 3, v220
    v_sub_u32 v222, v252, v222
    v_add_u32 v222, 4, v222
    v_add_u32 v121, 32, v222
    v_add_u32 v122, 64, v223
    v_cmp_ge_u32 vcc, 20, v121
    s_nop 1
    v_cndmask_b32 v120, v224, v122, vcc
    v_add_u32 v125, 64, v222
    v_add_u32 v126, 128, v223
    v_cmp_ge_u32 vcc, 20, v125
    s_nop 1
    v_cndmask_b32 v124, v224, v126, vcc
    v_add_u32 v252, 80, v221
    v_mul_u32_u24 v222, 205, v252
    v_lshrrev_b32 v222, 12, v222
    v_mul_u32_u24 v223, 24, v222
    v_mad_u32_u24 v223, v252, 48, v223
    v_lshl_add_u32 v223, v220, 4, v223
    v_add_u32 v223, 8, v223
    v_lshrrev_b32 v225, 2, v222
    v_mul_u32_u24 v225, 12288, v225
    v_add3_u32 v223, v223, v225, s35
    v_mul_u32_u24 v222, 20, v222
    v_lshlrev_b32 v252, 3, v220
    v_sub_u32 v222, v252, v222
    v_add_u32 v222, 4, v222
    v_add_u32 v129, 64, v222
    v_add_u32 v130, 128, v223
    v_cmp_ge_u32 vcc, 20, v129
    s_nop 1
    v_cndmask_b32 v128, v224, v130, vcc
    v_add_u32 v133, 96, v222
    v_add_u32 v134, 192, v223
    v_cmp_ge_u32 vcc, 20, v133
    s_nop 1
    v_cndmask_b32 v132, v224, v134, vcc
    v_add_u32 v252, 96, v221
    v_mul_u32_u24 v222, 205, v252
    v_lshrrev_b32 v222, 12, v222
    v_mul_u32_u24 v223, 24, v222
    v_mad_u32_u24 v223, v252, 48, v223
    v_lshl_add_u32 v223, v220, 4, v223
    v_add_u32 v223, 8, v223
    v_lshrrev_b32 v225, 2, v222
    v_mul_u32_u24 v225, 12288, v225
    v_add3_u32 v223, v223, v225, s35
    v_mul_u32_u24 v222, 20, v222
    v_lshlrev_b32 v252, 3, v220
    v_sub_u32 v222, v252, v222
    v_add_u32 v222, 4, v222
    v_add_u32 v137, 64, v222
    v_add_u32 v138, 128, v223
    v_cmp_ge_u32 vcc, 20, v137
    s_nop 1
    v_cndmask_b32 v136, v224, v138, vcc
    v_add_u32 v141, 96, v222
    v_add_u32 v142, 192, v223
    v_cmp_ge_u32 vcc, 20, v141
    s_nop 1
    v_cndmask_b32 v140, v224, v142, vcc
    v_add_u32 v252, 112, v221
    v_mul_u32_u24 v222, 205, v252
    v_lshrrev_b32 v222, 12, v222
    v_mul_u32_u24 v223, 24, v222
    v_mad_u32_u24 v223, v252, 48, v223
    v_lshl_add_u32 v223, v220, 4, v223
    v_add_u32 v223, 8, v223
    v_lshrrev_b32 v225, 2, v222
    v_mul_u32_u24 v225, 12288, v225
    v_add3_u32 v223, v223, v225, s35
    v_mul_u32_u24 v222, 20, v222
    v_lshlrev_b32 v252, 3, v220
    v_sub_u32 v222, v252, v222
    v_add_u32 v222, 4, v222
    v_add_u32 v145, 96, v222
    v_add_u32 v146, 192, v223
    v_cmp_ge_u32 vcc, 20, v145
    s_nop 1
    v_cndmask_b32 v144, v224, v146, vcc
    v_add_u32 v149, 128, v222
    v_add_u32 v150, 256, v223
    v_cmp_ge_u32 vcc, 20, v149
    s_nop 1
    v_cndmask_b32 v148, v224, v150, vcc
    v_add_u32 v252, 128, v221
    v_mul_u32_u24 v222, 205, v252
    v_lshrrev_b32 v222, 12, v222
    v_mul_u32_u24 v223, 24, v222
    v_mad_u32_u24 v223, v252, 48, v223
    v_lshl_add_u32 v223, v220, 4, v223
    v_add_u32 v223, 8, v223
    v_lshrrev_b32 v225, 2, v222
    v_mul_u32_u24 v225, 12288, v225
    v_add3_u32 v223, v223, v225, s35
    v_mul_u32_u24 v222, 20, v222
    v_lshlrev_b32 v252, 3, v220
    v_sub_u32 v222, v252, v222
    v_add_u32 v222, 4, v222
    v_add_u32 v153, 96, v222
    v_add_u32 v154, 192, v223
    v_cmp_ge_u32 vcc, 20, v153
    s_nop 1
    v_cndmask_b32 v152, v224, v154, vcc
    v_add_u32 v157, 128, v222
    v_add_u32 v158, 256, v223
    v_cmp_ge_u32 vcc, 20, v157
    s_nop 1
    v_cndmask_b32 v156, v224, v158, vcc
    v_add_u32 v252, 144, v221
    v_mul_u32_u24 v222, 205, v252
    v_lshrrev_b32 v222, 12, v222
    v_mul_u32_u24 v223, 24, v222
    v_mad_u32_u24 v223, v252, 48, v223
    v_lshl_add_u32 v223, v220, 4, v223
    v_add_u32 v223, 8, v223
    v_lshrrev_b32 v225, 2, v222
    v_mul_u32_u24 v225, 12288, v225
    v_add3_u32 v223, v223, v225, s35
    v_mul_u32_u24 v222, 20, v222
    v_lshlrev_b32 v252, 3, v220
    v_sub_u32 v222, v252, v222
    v_add_u32 v222, 4, v222
    v_add_u32 v161, 128, v222
    v_add_u32 v162, 256, v223
    v_cmp_ge_u32 vcc, 20, v161
    s_nop 1
    v_cndmask_b32 v160, v224, v162, vcc
    s_cmp_lg_u32 s26, 0
    s_cbranch_scc1 L_p2_kload
    s_mov_b32 s26, 1
    s_cmp_eq_u32 s66, 0
    s_cbranch_scc1 L_p2_nom
    v_mov_b32 v252, s27
    v_mov_b32 v253, s27
    v_mov_b32 v254, s27
    v_mov_b32 v255, s27
    s_lshl_b32 s29, s20, 1
    s_lshr_b32 s35, s28, 1
    s_and_b32 s34, s28, 1
    s_cmp_eq_u32 s22, 1
    s_cselect_b32 s34, 1, s34
    s_cselect_b32 s35, 1, s35
    s_add_u32 s29, s29, s35
    s_lshl_b32 s31, s29, 4
    s_mul_i32 s31, s31, 1792
    s_add_u32 s31, s31, 15728640
    s_mov_b32 s67, s34
    s_mul_i32 s35, s34, 55
    s_lshl_b32 s32, s35, 4
    s_add_u32 s32, s32, s31
    v_add_u32 v11, s35, v1
    s_mul_i32 s34, s34, 5
    s_sub_u32 s34, 55, s34
    v_cmp_gt_u32 s[56:57], s34, v1
    v_lshlrev_b32 v252, 4, v11
    v_mov_b32 v255, s27
    v_mul_u32_u24 v253, 205, v11
    v_lshrrev_b32 v253, 10, v253
    v_cndmask_b32 v252, v255, v252, s[56:57]
    v_mul_u32_u24 v254, 5, v253
    v_sub_u32 v254, v11, v254
    v_mul_u32_u24 v253, 48, v253
    v_lshl_add_u32 v253, v254, 3, v253
    s_mul_i32 s34, s29, 1024
    s_add_u32 s34, s34, 17104904
    v_add_u32 v253, s34, v253
    v_cndmask_b32 v253, v255, v253, s[56:57]
    s_lshr_b32 s34, s29, 3
    s_lshl_b32 s34, s34, 7
    s_and_b32 s35, s29, 7
    s_lshl_b32 s35, s35, 3
    s_add_u32 s34, s34, s35
    s_lshl_b32 s35, s67, 2
    s_add_u32 s34, s34, s35
    s_add_u32 s34, s34, 17235968
    v_lshlrev_b32 v254, 9, v1
    v_add_u32 v254, s34, v254
    s_mov_b32 s71, 0
L_m_kv_spin:
    s_buffer_load_dword s72, s[12:15], s32 offset:0 glc
    s_buffer_load_dword s73, s[12:15], s32 offset:1792 glc
    s_buffer_load_dword s74, s[12:15], s32 offset:3584 glc
    s_buffer_load_dword s75, s[12:15], s32 offset:5376 glc
    s_buffer_load_dword s76, s[12:15], s32 offset:7168 glc
    s_buffer_load_dword s77, s[12:15], s32 offset:8960 glc
    s_buffer_load_dword s78, s[12:15], s32 offset:10752 glc
    s_buffer_load_dword s79, s[12:15], s32 offset:12544 glc
    s_buffer_load_dword s80, s[12:15], s32 offset:14336 glc
    s_buffer_load_dword s81, s[12:15], s32 offset:16128 glc
    s_buffer_load_dword s82, s[12:15], s32 offset:17920 glc
    s_buffer_load_dword s83, s[12:15], s32 offset:19712 glc
    s_buffer_load_dword s84, s[12:15], s32 offset:21504 glc
    s_buffer_load_dword s85, s[12:15], s32 offset:23296 glc
    s_buffer_load_dword s86, s[12:15], s32 offset:25088 glc
    s_buffer_load_dword s87, s[12:15], s32 offset:26880 glc
    s_buffer_load_dwordx4 s[92:95], s[12:15], s55 glc
    s_add_u32 s71, s71, 1
    s_waitcnt lgkmcnt(0)
    s_bitcmp1_b32 s54, 8
    s_cbranch_scc1 L_m_he
    s_min_u32 s34, s92, s93
    s_min_u32 s34, s34, s94
    s_cmp_eq_u32 s34, 0
    s_cbranch_scc1 L_m_he
    ds_write_b32 v10, v10 offset:36
    s_bitset1_b32 s54, 8
L_m_he:
    s_bitcmp1_b32 s54, 9
    s_cbranch_scc1 L_m_qe
    s_cmp_eq_u32 s95, 0
    s_cbranch_scc1 L_m_qe
    buffer_load_dwordx4 v[12:15], v3, s[12:15], s30 offen
    buffer_load_dwordx4 v[16:19], v4, s[12:15], s30 offen
    buffer_load_dwordx4 v[20:23], v5, s[12:15], s30 offen
    buffer_load_dwordx4 v[24:27], v6, s[12:15], s30 offen
    s_add_u32 s30, s30, 4096
    buffer_load_dwordx4 v[28:31], v3, s[12:15], s30 offen
    buffer_load_dwordx4 v[32:35], v4, s[12:15], s30 offen
    buffer_load_dwordx4 v[36:39], v5, s[12:15], s30 offen
    buffer_load_dwordx4 v[40:43], v6, s[12:15], s30 offen
    s_add_u32 s30, s30, 4096
    buffer_load_dwordx4 v[44:47], v3, s[12:15], s30 offen
    buffer_load_dwordx4 v[48:51], v4, s[12:15], s30 offen
    buffer_load_dwordx4 v[52:55], v5, s[12:15], s30 offen
    buffer_load_dwordx4 v[56:59], v6, s[12:15], s30 offen
    s_add_u32 s30, s30, 4096
    buffer_load_dwordx4 v[60:63], v3, s[12:15], s30 offen
    buffer_load_dwordx4 v[64:67], v4, s[12:15], s30 offen
    buffer_load_dwordx4 v[68:71], v5, s[12:15], s30 offen
    buffer_load_dwordx4 v[72:75], v6, s[12:15], s30 offen
    s_add_u32 s30, s30, 4096
    buffer_load_dwordx4 v[76:79], v3, s[12:15], s30 offen
    buffer_load_dwordx4 v[80:83], v4, s[12:15], s30 offen
    buffer_load_dwordx4 v[84:87], v5, s[12:15], s30 offen
    buffer_load_dwordx4 v[88:91], v6, s[12:15], s30 offen
    s_bitset1_b32 s54, 9
L_m_qe:
    s_and_b32 s72, s72, s73
    s_and_b32 s72, s72, s74
    s_and_b32 s72, s72, s75
    s_and_b32 s72, s72, s76
    s_and_b32 s72, s72, s77
    s_and_b32 s72, s72, s78
    s_and_b32 s72, s72, s79
    s_and_b32 s72, s72, s80
    s_and_b32 s72, s72, s81
    s_and_b32 s72, s72, s82
    s_and_b32 s72, s72, s83
    s_and_b32 s72, s72, s84
    s_and_b32 s72, s72, s85
    s_and_b32 s72, s72, s86
    s_and_b32 s72, s72, s87
    s_bitcmp1_b32 s72, 0
    s_cbranch_scc1 L_m_kv_ok
    s_cmp_lt_u32 s71, 2097152
    s_cbranch_scc1 L_m_kv_spin
L_m_kv_ok:
    s_mov_b32 s32, s31
    buffer_load_dwordx4 v[188:191], v252, s[12:15], s32 offen sc1
    s_add_u32 s32, s32, 1792
    buffer_load_dwordx4 v[192:195], v252, s[12:15], s32 offen sc1
    s_add_u32 s32, s32, 1792
    buffer_load_dwordx4 v[196:199], v252, s[12:15], s32 offen sc1
    s_add_u32 s32, s32, 1792
    buffer_load_dwordx4 v[200:203], v252, s[12:15], s32 offen sc1
    s_add_u32 s32, s32, 1792
    buffer_load_dwordx4 v[204:207], v252, s[12:15], s32 offen sc1
    s_add_u32 s32, s32, 1792
    buffer_load_dwordx4 v[208:211], v252, s[12:15], s32 offen sc1
    s_add_u32 s32, s32, 1792
    buffer_load_dwordx4 v[212:215], v252, s[12:15], s32 offen sc1
    s_add_u32 s32, s32, 1792
    buffer_load_dwordx4 v[216:219], v252, s[12:15], s32 offen sc1
    s_add_u32 s32, s32, 1792
    buffer_load_dwordx4 v[220:223], v252, s[12:15], s32 offen sc1
    s_add_u32 s32, s32, 1792
    buffer_load_dwordx4 v[224:227], v252, s[12:15], s32 offen sc1
    s_add_u32 s32, s32, 1792
    buffer_load_dwordx4 v[228:231], v252, s[12:15], s32 offen sc1
    s_add_u32 s32, s32, 1792
    buffer_load_dwordx4 v[232:235], v252, s[12:15], s32 offen sc1
    s_add_u32 s32, s32, 1792
    buffer_load_dwordx4 v[236:239], v252, s[12:15], s32 offen sc1
    s_add_u32 s32, s32, 1792
    buffer_load_dwordx4 v[240:243], v252, s[12:15], s32 offen sc1
    s_add_u32 s32, s32, 1792
    buffer_load_dwordx4 v[244:247], v252, s[12:15], s32 offen sc1
    s_add_u32 s32, s32, 1792
    buffer_load_dwordx4 v[248:251], v252, s[12:15], s32 offen sc1
    ds_write_b32 v10, v10 offset:64
    s_waitcnt vmcnt(0)
    v_and_b32 v11, v188, v192
    v_and_b32 v11, v11, v196
    v_and_b32 v11, v11, v200
    v_and_b32 v11, v11, v204
    v_and_b32 v11, v11, v208
    v_and_b32 v11, v11, v212
    v_and_b32 v11, v11, v216
    v_and_b32 v11, v11, v220
    v_and_b32 v11, v11, v224
    v_and_b32 v11, v11, v228
    v_and_b32 v11, v11, v232
    v_and_b32 v11, v11, v236
    v_and_b32 v11, v11, v240
    v_and_b32 v11, v11, v244
    v_and_b32 v11, v11, v248
    v_and_b32 v11, 1, v11
    s_nop 0
    v_cndmask_b32 v11, 1, v11, s[56:57]
    v_cmp_ne_u32 vcc, 0, v11
    s_nop 4
    s_cmp_eq_u64 vcc, -1
    s_cbranch_scc1 L_m_valid
    s_mov_b32 s70, 0
L_m_again:
    s_mov_b32 s32, s31
    buffer_load_dwordx4 v[188:191], v252, s[12:15], s32 offen sc1
    s_add_u32 s32, s32, 1792
    buffer_load_dwordx4 v[192:195], v252, s[12:15], s32 offen sc1
    s_add_u32 s32, s32, 1792
    buffer_load_dwordx4 v[196:199], v252, s[12:15], s32 offen sc1
    s_add_u32 s32, s32, 1792
    buffer_load_dwordx4 v[200:203], v252, s[12:15], s32 offen sc1
    s_add_u32 s32, s32, 1792
    buffer_load_dwordx4 v[204:207], v252, s[12:15], s32 offen sc1
    s_add_u32 s32, s32, 1792
    buffer_load_dwordx4 v[208:211], v252, s[12:15], s32 offen sc1
    s_add_u32 s32, s32, 1792
    buffer_load_dwordx4 v[212:215], v252, s[12:15], s32 offen sc1
    s_add_u32 s32, s32, 1792
    buffer_load_dwordx4 v[216:219], v252, s[12:15], s32 offen sc1
    s_add_u32 s32, s32, 1792
    buffer_load_dwordx4 v[220:223], v252, s[12:15], s32 offen sc1
    s_add_u32 s32, s32, 1792
    buffer_load_dwordx4 v[224:227], v252, s[12:15], s32 offen sc1
    s_add_u32 s32, s32, 1792
    buffer_load_dwordx4 v[228:231], v252, s[12:15], s32 offen sc1
    s_add_u32 s32, s32, 1792
    buffer_load_dwordx4 v[232:235], v252, s[12:15], s32 offen sc1
    s_add_u32 s32, s32, 1792
    buffer_load_dwordx4 v[236:239], v252, s[12:15], s32 offen sc1
    s_add_u32 s32, s32, 1792
    buffer_load_dwordx4 v[240:243], v252, s[12:15], s32 offen sc1
    s_add_u32 s32, s32, 1792
    buffer_load_dwordx4 v[244:247], v252, s[12:15], s32 offen sc1
    s_add_u32 s32, s32, 1792
    buffer_load_dwordx4 v[248:251], v252, s[12:15], s32 offen sc1
    s_add_u32 s70, s70, 1
    s_waitcnt vmcnt(0)
    v_and_b32 v11, v188, v192
    v_and_b32 v11, v11, v196
    v_and_b32 v11, v11, v200
    v_and_b32 v11, v11, v204
    v_and_b32 v11, v11, v208
    v_and_b32 v11, v11, v212
    v_and_b32 v11, v11, v216
    v_and_b32 v11, v11, v220
    v_and_b32 v11, v11, v224
    v_and_b32 v11, v11, v228
    v_and_b32 v11, v11, v232
    v_and_b32 v11, v11, v236
    v_and_b32 v11, v11, v240
    v_and_b32 v11, v11, v244
    v_and_b32 v11, v11, v248
    v_and_b32 v11, 1, v11
    s_nop 0
    v_cndmask_b32 v11, 1, v11, s[56:57]
    v_cmp_ne_u32 vcc, 0, v11
    s_nop 4
    s_cmp_eq_u64 vcc, -1
    s_cbranch_scc1 L_m_valid
    s_cmp_lt_u32 s70, 131072
    s_cbranch_scc1 L_m_again
L_m_valid:
    v_add_f32 v188, v188, v220
    v_add_f32 v189, v189, v221
    v_add_f32 v190, v190, v222
    v_add_f32 v191, v191, v223
    v_add_f32 v192, v192, v224
    v_add_f32 v193, v193, v225
    v_add_f32 v194, v194, v226
    v_add_f32 v195, v195, v227
    v_add_f32 v196, v196, v228
    v_add_f32 v197, v197, v229
    v_add_f32 v198, v198, v230
    v_add_f32 v199, v199, v231
    v_add_f32 v200, v200, v232
    v_add_f32 v201, v201, v233
    v_add_f32 v202, v202, v234
    v_add_f32 v203, v203, v235
    v_add_f32 v204, v204, v236
    v_add_f32 v205, v205, v237
    v_add_f32 v206, v206, v238
    v_add_f32 v207, v207, v239
    v_add_f32 v208, v208, v240
    v_add_f32 v209, v209, v241
    v_add_f32 v210, v210, v242
    v_add_f32 v211, v211, v243
    v_add_f32 v212, v212, v244
    v_add_f32 v213, v213, v245
    v_add_f32 v214, v214, v246
    v_add_f32 v215, v215, v247
    v_add_f32 v216, v216, v248
    v_add_f32 v217, v217, v249
    v_add_f32 v218, v218, v250
    v_add_f32 v219, v219, v251
    v_add_f32 v188, v188, v204
    v_add_f32 v189, v189, v205
    v_add_f32 v190, v190, v206
    v_add_f32 v191, v191, v207
    v_add_f32 v192, v192, v208
    v_add_f32 v193, v193, v209
    v_add_f32 v194, v194, v210
    v_add_f32 v195, v195, v211
    v_add_f32 v196, v196, v212
    v_add_f32 v197, v197, v213
    v_add_f32 v198, v198, v214
    v_add_f32 v199, v199, v215
    v_add_f32 v200, v200, v216
    v_add_f32 v201, v201, v217
    v_add_f32 v202, v202, v218
    v_add_f32 v203, v203, v219
    v_add_f32 v188, v188, v196
    v_add_f32 v189, v189, v197
    v_add_f32 v190, v190, v198
    v_add_f32 v191, v191, v199
    v_add_f32 v192, v192, v200
    v_add_f32 v193, v193, v201
    v_add_f32 v194, v194, v202
    v_add_f32 v195, v195, v203
    v_add_f32 v188, v188, v192
    v_add_f32 v189, v189, v193
    v_add_f32 v190, v190, v194
    v_add_f32 v191, v191, v195
    v_cvt_pk_bf16_f32 v188, v188, v189
    v_cvt_pk_bf16_f32 v189, v190, v191
    v_min_u32 v188, -2, v188
    v_min_u32 v189, -2, v189
    buffer_store_dwordx2 v[188:189], v253, s[12:15], 0 offen sc1
    buffer_store_dword v255, v254, s[12:15], 0 offen sc1
L_p2_nom:
    s_lshr_b32 s70, s54, 8
    s_mov_b32 s71, 0
    s_cmp_eq_u32 s70, 3
    s_cbranch_scc1 L_p2_in_ok
L_p2_in_spin:
    s_buffer_load_dwordx4 s[72:75], s[12:15], s55 glc
    s_add_u32 s71, s71, 1
    s_waitcnt lgkmcnt(0)
    s_bitcmp1_b32 s70, 0
    s_cbranch_scc1 L_p2_in_q
    s_min_u32 s72, s72, s73
    s_min_u32 s72, s72, s74
    s_cmp_eq_u32 s72, 0
    s_cbranch_scc1 L_p2_in_q
    ds_write_b32 v10, v10 offset:36
    s_or_b32 s70, s70, 1
L_p2_in_q:
    s_bitcmp1_b32 s70, 1
    s_cbranch_scc1 L_p2_in_next
    s_cmp_eq_u32 s75, 0
    s_cbranch_scc1 L_p2_in_next
    buffer_load_dwordx4 v[12:15], v3, s[12:15], s30 offen
    buffer_load_dwordx4 v[16:19], v4, s[12:15], s30 offen
    buffer_load_dwordx4 v[20:23], v5, s[12:15], s30 offen
    buffer_load_dwordx4 v[24:27], v6, s[12:15], s30 offen
    s_add_u32 s30, s30, 4096
    buffer_load_dwordx4 v[28:31], v3, s[12:15], s30 offen
    buffer_load_dwordx4 v[32:35], v4, s[12:15], s30 offen
    buffer_load_dwordx4 v[36:39], v5, s[12:15], s30 offen
    buffer_load_dwordx4 v[40:43], v6, s[12:15], s30 offen
    s_add_u32 s30, s30, 4096
    buffer_load_dwordx4 v[44:47], v3, s[12:15], s30 offen
    buffer_load_dwordx4 v[48:51], v4, s[12:15], s30 offen
    buffer_load_dwordx4 v[52:55], v5, s[12:15], s30 offen
    buffer_load_dwordx4 v[56:59], v6, s[12:15], s30 offen
    s_add_u32 s30, s30, 4096
    buffer_load_dwordx4 v[60:63], v3, s[12:15], s30 offen
    buffer_load_dwordx4 v[64:67], v4, s[12:15], s30 offen
    buffer_load_dwordx4 v[68:71], v5, s[12:15], s30 offen
    buffer_load_dwordx4 v[72:75], v6, s[12:15], s30 offen
    s_add_u32 s30, s30, 4096
    buffer_load_dwordx4 v[76:79], v3, s[12:15], s30 offen
    buffer_load_dwordx4 v[80:83], v4, s[12:15], s30 offen
    buffer_load_dwordx4 v[84:87], v5, s[12:15], s30 offen
    buffer_load_dwordx4 v[88:91], v6, s[12:15], s30 offen
    s_or_b32 s70, s70, 2
L_p2_in_next:
    s_cmp_eq_u32 s70, 3
    s_cbranch_scc1 L_p2_in_ok
    s_cmp_lt_u32 s71, 2097152
    s_cbranch_scc1 L_p2_in_spin
    ds_write_b32 v10, v10 offset:36
L_p2_in_ok:
L_p2_kload:
    s_and_b32 s34, s2, 0xfc
    s_add_u32 s34, s34, s28
    s_lshl_b32 s32, s34, 7
    s_add_u32 s32, s32, 17235968
    s_mov_b32 s71, 0
L_p2_fr_spin:
    ds_read_b32 v11, v10 offset:4
    s_add_u32 s71, s71, 1
    s_waitcnt lgkmcnt(0)
    v_readfirstlane_b32 s34, v11
    s_nop 1
    s_cmp_ge_u32 s34, 1
    s_cbranch_scc1 L_p2_fr_ok
    s_cmp_lt_u32 s71, 2097152
    s_cbranch_scc1 L_p2_fr_spin
L_p2_fr_ok:
    s_mov_b32 s71, 0
L_p2_kvh_spin:
    s_buffer_load_dwordx16 s[72:87], s[12:15], s32 glc
    s_add_u32 s71, s71, 1
    s_waitcnt lgkmcnt(0)
    s_min_u32 s72, s72, s73
    s_min_u32 s72, s72, s74
    s_min_u32 s72, s72, s75
    s_min_u32 s72, s72, s76
    s_min_u32 s72, s72, s77
    s_min_u32 s72, s72, s78
    s_min_u32 s72, s72, s79
    s_min_u32 s72, s72, s80
    s_min_u32 s72, s72, s81
    s_min_u32 s72, s72, s82
    s_min_u32 s72, s72, s83
    s_min_u32 s72, s72, s84
    s_min_u32 s72, s72, s85
    s_min_u32 s72, s72, s86
    s_min_u32 s72, s72, s87
    s_cmp_lg_u32 s72, 0
    s_cbranch_scc1 L_p2_kvh_ok
    s_cmp_lt_u32 s71, 2097152
    s_cbranch_scc1 L_p2_kvh_spin
L_p2_kvh_ok:
    s_lshl_b32 s32, s28, 12
    s_add_u32 s32, s32, 115712
    s_mov_b32 s33, s24
    s_add_u32 m0, s32, 0
    s_nop 0
    buffer_load_dwordx4 v2, s[12:15], s33 offen offset:0 sc1 lds
    buffer_load_dwordx4 v2, s[12:15], s33 offen offset:1024 sc1 lds
    buffer_load_dwordx4 v2, s[12:15], s33 offen offset:2048 sc1 lds
    buffer_load_dwordx4 v2, s[12:15], s33 offen offset:3072 sc1 lds
    s_add_u32 s33, s33, 4096
    s_add_u32 m0, s32, 16384
    s_nop 0
    buffer_load_dwordx4 v2, s[12:15], s33 offen offset:0 sc1 lds
    buffer_load_dwordx4 v2, s[12:15], s33 offen offset:1024 sc1 lds
    buffer_load_dwordx4 v2, s[12:15], s33 offen offset:2048 sc1 lds
    buffer_load_dwordx4 v2, s[12:15], s33 offen offset:3072 sc1 lds
    s_waitcnt vmcnt(0)
    ds_read2_b64 v[164:167], v164 offset1:1
    ds_read2_b64 v[168:171], v168 offset1:1
    ds_read2_b64 v[172:175], v172 offset1:1
    ds_read2_b64 v[176:179], v176 offset1:1
    ds_read2_b64 v[180:183], v180 offset1:1
    ds_read2_b64 v[184:187], v184 offset1:1
    ds_read2_b64 v[92:95], v92 offset1:1
    ds_read2_b64 v[96:99], v96 offset1:1
    ds_read2_b64 v[100:103], v100 offset1:1
    ds_read2_b64 v[104:107], v104 offset1:1
    ds_read2_b64 v[108:111], v108 offset1:1
    ds_read2_b64 v[112:115], v112 offset1:1
    ds_read2_b64 v[116:119], v116 offset1:1
    ds_read2_b64 v[120:123], v120 offset1:1
    ds_read2_b64 v[124:127], v124 offset1:1
    v_mov_b32 v252, 0x358637bd
    v_mov_b32 v253, 0x358637bd
    v_mov_b32 v254, 0x358637bd
    v_mov_b32 v255, 0x358637bd
    s_nop 1
    s_waitcnt lgkmcnt(14)
    ds_read2_b64 v[128:131], v128 offset1:1
    v_mfma_f32_16x16x32_bf16 v[188:191], v[164:167], v[12:15], v[252:255]
    v_mfma_f32_16x16x32_bf16 v[196:199], v[164:167], v[16:19], v[252:255]
    v_mfma_f32_16x16x32_bf16 v[204:207], v[164:167], v[20:23], v[252:255]
    v_mfma_f32_16x16x32_bf16 v[212:215], v[164:167], v[24:27], v[252:255]
    s_waitcnt lgkmcnt(14)
    ds_read2_b64 v[132:135], v132 offset1:1
    v_mfma_f32_16x16x32_bf16 v[188:191], v[168:171], v[28:31], v[188:191]
    v_mfma_f32_16x16x32_bf16 v[196:199], v[168:171], v[32:35], v[196:199]
    v_mfma_f32_16x16x32_bf16 v[204:207], v[168:171], v[36:39], v[204:207]
    v_mfma_f32_16x16x32_bf16 v[212:215], v[168:171], v[40:43], v[212:215]
    s_waitcnt lgkmcnt(14)
    ds_read2_b64 v[136:139], v136 offset1:1
    v_mfma_f32_16x16x32_bf16 v[188:191], v[172:175], v[44:47], v[188:191]
    v_mfma_f32_16x16x32_bf16 v[196:199], v[172:175], v[48:51], v[196:199]
    v_mfma_f32_16x16x32_bf16 v[204:207], v[172:175], v[52:55], v[204:207]
    v_mfma_f32_16x16x32_bf16 v[212:215], v[172:175], v[56:59], v[212:215]
    s_waitcnt lgkmcnt(14)
    ds_read2_b64 v[140:143], v140 offset1:1
    v_mfma_f32_16x16x32_bf16 v[192:195], v[176:179], v[44:47], v[252:255]
    v_mfma_f32_16x16x32_bf16 v[200:203], v[176:179], v[48:51], v[252:255]
    v_mfma_f32_16x16x32_bf16 v[208:211], v[176:179], v[52:55], v[252:255]
    v_mfma_f32_16x16x32_bf16 v[216:219], v[176:179], v[56:59], v[252:255]
    s_waitcnt lgkmcnt(14)
    ds_read2_b64 v[144:147], v144 offset1:1
    v_mfma_f32_16x16x32_bf16 v[192:195], v[180:183], v[60:63], v[192:195]
    v_mfma_f32_16x16x32_bf16 v[200:203], v[180:183], v[64:67], v[200:203]
    v_mfma_f32_16x16x32_bf16 v[208:211], v[180:183], v[68:71], v[208:211]
    v_mfma_f32_16x16x32_bf16 v[216:219], v[180:183], v[72:75], v[216:219]
    s_waitcnt lgkmcnt(14)
    ds_read2_b64 v[148:151], v148 offset1:1
    v_mfma_f32_16x16x32_bf16 v[192:195], v[184:187], v[76:79], v[192:195]
    v_mfma_f32_16x16x32_bf16 v[200:203], v[184:187], v[80:83], v[200:203]
    v_mfma_f32_16x16x32_bf16 v[208:211], v[184:187], v[84:87], v[208:211]
    v_mfma_f32_16x16x32_bf16 v[216:219], v[184:187], v[88:91], v[216:219]
    s_waitcnt lgkmcnt(12)
    ds_read2_b64 v[152:155], v152 offset1:1
    ds_read2_b64 v[156:159], v156 offset1:1
    ds_read2_b64 v[160:163], v160 offset1:1
    s_waitcnt lgkmcnt(0)
    v_mfma_f32_16x16x32_bf16 v[220:223], v[92:95], v[12:15], 0
    v_max3_u32 v255, v164, v165, v166
    v_max3_u32 v255, v255, v167, v168
    v_max3_u32 v255, v255, v169, v170
    v_mfma_f32_16x16x32_bf16 v[224:227], v[96:99], v[12:15], 0
    v_max3_u32 v255, v255, v171, v172
    v_max3_u32 v255, v255, v173, v174
    v_max3_u32 v255, v255, v175, v176
    v_mfma_f32_16x16x32_bf16 v[224:227], v[100:103], v[28:31], v[224:227]
    v_rcp_f32 v188, v188
    v_rcp_f32 v189, v189
    v_rcp_f32 v196, v196
    v_mfma_f32_16x16x32_bf16 v[228:231], v[92:95], v[16:19], 0
    v_rcp_f32 v197, v197
    v_max3_u32 v255, v255, v177, v178
    v_max3_u32 v255, v255, v179, v180
    v_mfma_f32_16x16x32_bf16 v[232:235], v[96:99], v[16:19], 0
    v_max3_u32 v255, v255, v181, v182
    v_max3_u32 v255, v255, v183, v184
    v_mfma_f32_16x16x32_bf16 v[232:235], v[100:103], v[32:35], v[232:235]
    v_max3_u32 v255, v255, v185, v186
    v_max_u32 v255, v255, v187
    v_mfma_f32_16x16x32_bf16 v[236:239], v[92:95], v[20:23], 0
    v_rcp_f32 v204, v204
    v_rcp_f32 v205, v205
    v_rcp_f32 v212, v212
    v_rcp_f32 v213, v213
    v_mul_f32 v220, v220, v188
    v_mul_f32 v221, v221, v188
    v_mul_f32 v222, v222, v188
    v_mfma_f32_16x16x32_bf16 v[240:243], v[96:99], v[20:23], 0
    v_mul_f32 v223, v223, v188
    v_cndmask_b32 v253, v188, v189, s[48:49]
    v_mul_f32 v224, v224, v253
    v_mul_f32 v225, v225, v253
    v_mul_f32 v226, v226, v253
    v_mul_f32 v227, v227, v253
    v_cvt_pk_bf16_f32 v220, v220, v221
    v_mfma_f32_16x16x32_bf16 v[240:243], v[100:103], v[36:39], v[240:243]
    v_cvt_pk_bf16_f32 v221, v222, v223
    v_cvt_pk_bf16_f32 v222, v224, v225
    v_cvt_pk_bf16_f32 v223, v226, v227
    ds_write_b128 v7, v[220:223] offset:0
    v_mul_f32 v228, v228, v196
    v_mul_f32 v229, v229, v196
    v_mul_f32 v230, v230, v196
    v_mfma_f32_16x16x32_bf16 v[244:247], v[92:95], v[24:27], 0
    v_mul_f32 v231, v231, v196
    v_cndmask_b32 v253, v196, v197, s[48:49]
    v_mul_f32 v232, v232, v253
    v_mul_f32 v233, v233, v253
    v_mul_f32 v234, v234, v253
    v_mul_f32 v235, v235, v253
    v_mfma_f32_16x16x32_bf16 v[248:251], v[96:99], v[24:27], 0
    v_cvt_pk_bf16_f32 v228, v228, v229
    v_cvt_pk_bf16_f32 v229, v230, v231
    v_cvt_pk_bf16_f32 v230, v232, v233
    v_cvt_pk_bf16_f32 v231, v234, v235
    ds_write_b128 v7, v[228:231] offset:1024
    v_max3_u32 v255, v255, v92, v93
    v_mfma_f32_16x16x32_bf16 v[248:251], v[100:103], v[40:43], v[248:251]
    v_max3_u32 v255, v255, v94, v95
    v_max3_u32 v255, v255, v96, v97
    v_max3_u32 v255, v255, v98, v99
    v_max3_u32 v255, v255, v100, v101
    v_max3_u32 v255, v255, v102, v103
    v_cmp_eq_u32 vcc, -1, v255
    v_mfma_f32_16x16x32_bf16 v[220:223], v[104:107], v[12:15], 0
    v_rcp_f32 v190, v190
    v_rcp_f32 v191, v191
    v_rcp_f32 v198, v198
    v_rcp_f32 v199, v199
    v_mul_f32 v236, v236, v204
    v_mfma_f32_16x16x32_bf16 v[220:223], v[108:111], v[28:31], v[220:223]
    v_mul_f32 v237, v237, v204
    v_mul_f32 v238, v238, v204
    v_mul_f32 v239, v239, v204
    v_cndmask_b32 v253, v204, v205, s[48:49]
    v_mfma_f32_16x16x32_bf16 v[224:227], v[112:115], v[28:31], 0
    v_mul_f32 v240, v240, v253
    v_mul_f32 v241, v241, v253
    v_mul_f32 v242, v242, v253
    v_mul_f32 v243, v243, v253
    v_mfma_f32_16x16x32_bf16 v[224:227], v[116:119], v[44:47], v[224:227]
    v_cvt_pk_bf16_f32 v236, v236, v237
    v_cvt_pk_bf16_f32 v237, v238, v239
    v_cvt_pk_bf16_f32 v238, v240, v241
    v_cvt_pk_bf16_f32 v239, v242, v243
    v_mfma_f32_16x16x32_bf16 v[228:231], v[104:107], v[16:19], 0
    ds_write_b128 v7, v[236:239] offset:2048
    v_mul_f32 v244, v244, v212
    v_mul_f32 v245, v245, v212
    v_mul_f32 v246, v246, v212
    v_mfma_f32_16x16x32_bf16 v[228:231], v[108:111], v[32:35], v[228:231]
    v_mul_f32 v247, v247, v212
    v_cndmask_b32 v253, v212, v213, s[48:49]
    v_mul_f32 v248, v248, v253
    v_mul_f32 v249, v249, v253
    v_mfma_f32_16x16x32_bf16 v[232:235], v[112:115], v[32:35], 0
    v_mul_f32 v250, v250, v253
    v_mul_f32 v251, v251, v253
    v_cvt_pk_bf16_f32 v244, v244, v245
    v_cvt_pk_bf16_f32 v245, v246, v247
    v_mfma_f32_16x16x32_bf16 v[232:235], v[116:119], v[48:51], v[232:235]
    v_cvt_pk_bf16_f32 v246, v248, v249
    v_cvt_pk_bf16_f32 v247, v250, v251
    ds_write_b128 v7, v[244:247] offset:12416
    s_cmp_eq_u64 vcc, 0
    s_cbranch_scc0 L_p2_kv_bad
    v_mov_b32 v11, 1
    ds_write_b32 v10, v11 offset:20
    v_mfma_f32_16x16x32_bf16 v[236:239], v[104:107], v[20:23], 0
    v_rcp_f32 v206, v206
    v_rcp_f32 v207, v207
    v_rcp_f32 v214, v214
    v_rcp_f32 v215, v215
    v_cndmask_b32 v252, v189, v190, s[50:51]
    v_mul_f32 v220, v220, v252
    v_mfma_f32_16x16x32_bf16 v[236:239], v[108:111], v[36:39], v[236:239]
    v_mul_f32 v221, v221, v252
    v_mul_f32 v222, v222, v252
    v_mul_f32 v223, v223, v252
    v_cndmask_b32 v253, v190, v191, s[52:53]
    v_mul_f32 v224, v224, v253
    v_mul_f32 v225, v225, v253
    v_mfma_f32_16x16x32_bf16 v[240:243], v[112:115], v[36:39], 0
    v_mul_f32 v226, v226, v253
    v_mul_f32 v227, v227, v253
    v_cvt_pk_bf16_f32 v220, v220, v221
    v_cvt_pk_bf16_f32 v221, v222, v223
    v_cvt_pk_bf16_f32 v222, v224, v225
    v_cvt_pk_bf16_f32 v223, v226, v227
    v_mfma_f32_16x16x32_bf16 v[240:243], v[116:119], v[52:55], v[240:243]
    ds_write_b128 v7, v[220:223] offset:13440
    v_cndmask_b32 v252, v197, v198, s[50:51]
    v_mul_f32 v228, v228, v252
    v_mul_f32 v229, v229, v252
    v_mul_f32 v230, v230, v252
    v_mfma_f32_16x16x32_bf16 v[244:247], v[104:107], v[24:27], 0
    v_mul_f32 v231, v231, v252
    v_cndmask_b32 v253, v198, v199, s[52:53]
    v_mul_f32 v232, v232, v253
    v_mul_f32 v233, v233, v253
    v_mul_f32 v234, v234, v253
    v_mfma_f32_16x16x32_bf16 v[244:247], v[108:111], v[40:43], v[244:247]
    v_mul_f32 v235, v235, v253
    v_cvt_pk_bf16_f32 v228, v228, v229
    v_cvt_pk_bf16_f32 v229, v230, v231
    v_cvt_pk_bf16_f32 v230, v232, v233
    v_cvt_pk_bf16_f32 v231, v234, v235
    v_mfma_f32_16x16x32_bf16 v[248:251], v[112:115], v[40:43], 0
    ds_write_b128 v7, v[228:231] offset:14464
    v_max3_u32 v255, v255, v104, v105
    v_max3_u32 v255, v255, v106, v107
    v_max3_u32 v255, v255, v108, v109
    v_max3_u32 v255, v255, v110, v111
    v_mfma_f32_16x16x32_bf16 v[248:251], v[116:119], v[56:59], v[248:251]
    v_max3_u32 v255, v255, v112, v113
    v_max3_u32 v255, v255, v114, v115
    v_max3_u32 v255, v255, v116, v117
    v_max3_u32 v255, v255, v118, v119
    v_cmp_eq_u32 vcc, -1, v255
    v_mfma_f32_16x16x32_bf16 v[220:223], v[120:123], v[28:31], 0
    v_rcp_f32 v192, v192
    v_rcp_f32 v200, v200
    v_cndmask_b32 v252, v205, v206, s[50:51]
    v_mul_f32 v236, v236, v252
    v_mul_f32 v237, v237, v252
    v_mfma_f32_16x16x32_bf16 v[220:223], v[124:127], v[44:47], v[220:223]
    v_mul_f32 v238, v238, v252
    v_mul_f32 v239, v239, v252
    v_cndmask_b32 v253, v206, v207, s[52:53]
    v_mul_f32 v240, v240, v253
    v_mfma_f32_16x16x32_bf16 v[224:227], v[128:131], v[44:47], 0
    v_mul_f32 v241, v241, v253
    v_mul_f32 v242, v242, v253
    v_mul_f32 v243, v243, v253
    v_cvt_pk_bf16_f32 v236, v236, v237
    v_mfma_f32_16x16x32_bf16 v[224:227], v[132:135], v[60:63], v[224:227]
    v_cvt_pk_bf16_f32 v237, v238, v239
    v_cvt_pk_bf16_f32 v238, v240, v241
    v_cvt_pk_bf16_f32 v239, v242, v243
    ds_write_b128 v7, v[236:239] offset:24832
    v_mfma_f32_16x16x32_bf16 v[228:231], v[120:123], v[32:35], 0
    v_cndmask_b32 v252, v213, v214, s[50:51]
    v_mul_f32 v244, v244, v252
    v_mul_f32 v245, v245, v252
    v_mul_f32 v246, v246, v252
    v_mfma_f32_16x16x32_bf16 v[228:231], v[124:127], v[48:51], v[228:231]
    v_mul_f32 v247, v247, v252
    v_cndmask_b32 v253, v214, v215, s[52:53]
    v_mul_f32 v248, v248, v253
    v_mul_f32 v249, v249, v253
    v_mfma_f32_16x16x32_bf16 v[232:235], v[128:131], v[48:51], 0
    v_mul_f32 v250, v250, v253
    v_mul_f32 v251, v251, v253
    v_cvt_pk_bf16_f32 v244, v244, v245
    v_cvt_pk_bf16_f32 v245, v246, v247
    v_mfma_f32_16x16x32_bf16 v[232:235], v[132:135], v[64:67], v[232:235]
    v_cvt_pk_bf16_f32 v246, v248, v249
    v_cvt_pk_bf16_f32 v247, v250, v251
    ds_write_b128 v7, v[244:247] offset:25856
    s_cmp_eq_u64 vcc, 0
    s_cbranch_scc0 L_p2_kv_bad
    v_mov_b32 v11, 2
    ds_write_b32 v10, v11 offset:20
    v_mfma_f32_16x16x32_bf16 v[236:239], v[120:123], v[36:39], 0
    v_rcp_f32 v208, v208
    v_rcp_f32 v216, v216
    v_mul_f32 v220, v220, v191
    v_mul_f32 v221, v221, v191
    v_mul_f32 v222, v222, v191
    v_mfma_f32_16x16x32_bf16 v[236:239], v[124:127], v[52:55], v[236:239]
    v_mul_f32 v223, v223, v191
    v_mul_f32 v224, v224, v192
    v_mul_f32 v225, v225, v192
    v_mul_f32 v226, v226, v192
    v_mul_f32 v227, v227, v192
    v_mfma_f32_16x16x32_bf16 v[240:243], v[128:131], v[52:55], 0
    v_cvt_pk_bf16_f32 v220, v220, v221
    v_cvt_pk_bf16_f32 v221, v222, v223
    v_cvt_pk_bf16_f32 v222, v224, v225
    v_cvt_pk_bf16_f32 v223, v226, v227
    ds_write_b128 v7, v[220:223] offset:26880
    v_mfma_f32_16x16x32_bf16 v[240:243], v[132:135], v[68:71], v[240:243]
    v_mul_f32 v228, v228, v199
    v_mul_f32 v229, v229, v199
    v_mul_f32 v230, v230, v199
    v_mul_f32 v231, v231, v199
    v_mul_f32 v232, v232, v200
    v_mfma_f32_16x16x32_bf16 v[244:247], v[120:123], v[40:43], 0
    v_mul_f32 v233, v233, v200
    v_mul_f32 v234, v234, v200
    v_mul_f32 v235, v235, v200
    v_cvt_pk_bf16_f32 v228, v228, v229
    v_cvt_pk_bf16_f32 v229, v230, v231
    v_mfma_f32_16x16x32_bf16 v[244:247], v[124:127], v[56:59], v[244:247]
    v_cvt_pk_bf16_f32 v230, v232, v233
    v_cvt_pk_bf16_f32 v231, v234, v235
    ds_write_b128 v7, v[228:231] offset:37248
    v_max3_u32 v255, v255, v120, v121
    v_mfma_f32_16x16x32_bf16 v[248:251], v[128:131], v[56:59], 0
    v_max3_u32 v255, v255, v122, v123
    v_max3_u32 v255, v255, v124, v125
    v_max3_u32 v255, v255, v126, v127
    v_max3_u32 v255, v255, v128, v129
    v_mfma_f32_16x16x32_bf16 v[248:251], v[132:135], v[72:75], v[248:251]
    v_max3_u32 v255, v255, v130, v131
    v_max3_u32 v255, v255, v132, v133
    v_max3_u32 v255, v255, v134, v135
    v_cmp_eq_u32 vcc, -1, v255
    v_mfma_f32_16x16x32_bf16 v[220:223], v[136:139], v[44:47], 0
    v_rcp_f32 v193, v193
    v_rcp_f32 v194, v194
    v_rcp_f32 v201, v201
    v_rcp_f32 v202, v202
    v_mfma_f32_16x16x32_bf16 v[220:223], v[140:143], v[60:63], v[220:223]
    v_mul_f32 v236, v236, v207
    v_mul_f32 v237, v237, v207
    v_mul_f32 v238, v238, v207
    v_mul_f32 v239, v239, v207
    v_mfma_f32_16x16x32_bf16 v[224:227], v[144:147], v[60:63], 0
    v_mul_f32 v240, v240, v208
    v_mul_f32 v241, v241, v208
    v_mul_f32 v242, v242, v208
    v_mul_f32 v243, v243, v208
    v_mfma_f32_16x16x32_bf16 v[224:227], v[148:151], v[76:79], v[224:227]
    v_cvt_pk_bf16_f32 v236, v236, v237
    v_cvt_pk_bf16_f32 v237, v238, v239
    v_cvt_pk_bf16_f32 v238, v240, v241
    v_cvt_pk_bf16_f32 v239, v242, v243
    v_mfma_f32_16x16x32_bf16 v[228:231], v[136:139], v[48:51], 0
    ds_write_b128 v7, v[236:239] offset:38272
    v_mul_f32 v244, v244, v215
    v_mul_f32 v245, v245, v215
    v_mul_f32 v246, v246, v215
    v_mfma_f32_16x16x32_bf16 v[228:231], v[140:143], v[64:67], v[228:231]
    v_mul_f32 v247, v247, v215
    v_mul_f32 v248, v248, v216
    v_mul_f32 v249, v249, v216
    v_mul_f32 v250, v250, v216
    v_mfma_f32_16x16x32_bf16 v[232:235], v[144:147], v[64:67], 0
    v_mul_f32 v251, v251, v216
    v_cvt_pk_bf16_f32 v244, v244, v245
    v_cvt_pk_bf16_f32 v245, v246, v247
    v_cvt_pk_bf16_f32 v246, v248, v249
    v_mfma_f32_16x16x32_bf16 v[232:235], v[148:151], v[80:83], v[232:235]
    v_cvt_pk_bf16_f32 v247, v250, v251
    ds_write_b128 v7, v[244:247] offset:39296
    s_cmp_eq_u64 vcc, 0
    s_cbranch_scc0 L_p2_kv_bad
    v_mov_b32 v11, 3
    ds_write_b32 v10, v11 offset:20
    v_mfma_f32_16x16x32_bf16 v[236:239], v[136:139], v[52:55], 0
    v_rcp_f32 v209, v209
    v_rcp_f32 v210, v210
    v_rcp_f32 v217, v217
    v_rcp_f32 v218, v218
    v_cndmask_b32 v252, v192, v193, s[48:49]
    v_mul_f32 v220, v220, v252
    v_mfma_f32_16x16x32_bf16 v[236:239], v[140:143], v[68:71], v[236:239]
    v_mul_f32 v221, v221, v252
    v_mul_f32 v222, v222, v252
    v_mul_f32 v223, v223, v252
    v_cndmask_b32 v253, v193, v194, s[50:51]
    v_mul_f32 v224, v224, v253
    v_mul_f32 v225, v225, v253
    v_mfma_f32_16x16x32_bf16 v[240:243], v[144:147], v[68:71], 0
    v_mul_f32 v226, v226, v253
    v_mul_f32 v227, v227, v253
    v_cvt_pk_bf16_f32 v220, v220, v221
    v_cvt_pk_bf16_f32 v221, v222, v223
    v_cvt_pk_bf16_f32 v222, v224, v225
    v_cvt_pk_bf16_f32 v223, v226, v227
    v_mfma_f32_16x16x32_bf16 v[240:243], v[148:151], v[84:87], v[240:243]
    ds_write_b128 v7, v[220:223] offset:49664
    v_cndmask_b32 v252, v200, v201, s[48:49]
    v_mul_f32 v228, v228, v252
    v_mul_f32 v229, v229, v252
    v_mul_f32 v230, v230, v252
    v_mfma_f32_16x16x32_bf16 v[244:247], v[136:139], v[56:59], 0
    v_mul_f32 v231, v231, v252
    v_cndmask_b32 v253, v201, v202, s[50:51]
    v_mul_f32 v232, v232, v253
    v_mul_f32 v233, v233, v253
    v_mul_f32 v234, v234, v253
    v_mfma_f32_16x16x32_bf16 v[244:247], v[140:143], v[72:75], v[244:247]
    v_mul_f32 v235, v235, v253
    v_cvt_pk_bf16_f32 v228, v228, v229
    v_cvt_pk_bf16_f32 v229, v230, v231
    v_cvt_pk_bf16_f32 v230, v232, v233
    v_cvt_pk_bf16_f32 v231, v234, v235
    v_mfma_f32_16x16x32_bf16 v[248:251], v[144:147], v[72:75], 0
    ds_write_b128 v7, v[228:231] offset:50688
    v_max3_u32 v255, v255, v136, v137
    v_max3_u32 v255, v255, v138, v139
    v_max3_u32 v255, v255, v140, v141
    v_max3_u32 v255, v255, v142, v143
    v_mfma_f32_16x16x32_bf16 v[248:251], v[148:151], v[88:91], v[248:251]
    v_max3_u32 v255, v255, v144, v145
    v_max3_u32 v255, v255, v146, v147
    v_max3_u32 v255, v255, v148, v149
    v_max3_u32 v255, v255, v150, v151
    v_cmp_eq_u32 vcc, -1, v255
    v_mfma_f32_16x16x32_bf16 v[220:223], v[152:155], v[60:63], 0
    v_rcp_f32 v195, v195
    v_rcp_f32 v203, v203
    v_cndmask_b32 v252, v208, v209, s[48:49]
    v_mul_f32 v236, v236, v252
    v_mul_f32 v237, v237, v252
    v_mul_f32 v238, v238, v252
    v_mfma_f32_16x16x32_bf16 v[220:223], v[156:159], v[76:79], v[220:223]
    v_mul_f32 v239, v239, v252
    v_cndmask_b32 v253, v209, v210, s[50:51]
    v_mul_f32 v240, v240, v253
    v_mul_f32 v241, v241, v253
    v_mul_f32 v242, v242, v253
    v_mul_f32 v243, v243, v253
    v_mfma_f32_16x16x32_bf16 v[224:227], v[160:163], v[76:79], 0
    v_cvt_pk_bf16_f32 v236, v236, v237
    v_cvt_pk_bf16_f32 v237, v238, v239
    v_cvt_pk_bf16_f32 v238, v240, v241
    v_cvt_pk_bf16_f32 v239, v242, v243
    ds_write_b128 v7, v[236:239] offset:51712
    v_cndmask_b32 v252, v216, v217, s[48:49]
    v_mfma_f32_16x16x32_bf16 v[228:231], v[152:155], v[64:67], 0
    v_mul_f32 v244, v244, v252
    v_mul_f32 v245, v245, v252
    v_mul_f32 v246, v246, v252
    v_mul_f32 v247, v247, v252
    v_cndmask_b32 v253, v217, v218, s[50:51]
    v_mfma_f32_16x16x32_bf16 v[228:231], v[156:159], v[80:83], v[228:231]
    v_mul_f32 v248, v248, v253
    v_mul_f32 v249, v249, v253
    v_mul_f32 v250, v250, v253
    v_mul_f32 v251, v251, v253
    v_cvt_pk_bf16_f32 v244, v244, v245
    v_mfma_f32_16x16x32_bf16 v[232:235], v[160:163], v[80:83], 0
    v_cvt_pk_bf16_f32 v245, v246, v247
    v_cvt_pk_bf16_f32 v246, v248, v249
    v_cvt_pk_bf16_f32 v247, v250, v251
    ds_write_b128 v7, v[244:247] offset:62080
    s_cmp_eq_u64 vcc, 0
    s_cbranch_scc0 L_p2_kv_bad
    v_mov_b32 v11, 4
    ds_write_b32 v10, v11 offset:20
    v_mfma_f32_16x16x32_bf16 v[236:239], v[152:155], v[68:71], 0
    v_rcp_f32 v211, v211
    v_rcp_f32 v219, v219
    v_cndmask_b32 v252, v194, v195, s[52:53]
    v_mul_f32 v220, v220, v252
    v_mul_f32 v221, v221, v252
    v_mul_f32 v222, v222, v252
    v_mul_f32 v223, v223, v252
    v_mfma_f32_16x16x32_bf16 v[236:239], v[156:159], v[84:87], v[236:239]
    v_mul_f32 v224, v224, v195
    v_mul_f32 v225, v225, v195
    v_mul_f32 v226, v226, v195
    v_mul_f32 v227, v227, v195
    v_cvt_pk_bf16_f32 v220, v220, v221
    v_cvt_pk_bf16_f32 v221, v222, v223
    v_mfma_f32_16x16x32_bf16 v[240:243], v[160:163], v[84:87], 0
    v_cvt_pk_bf16_f32 v222, v224, v225
    v_cvt_pk_bf16_f32 v223, v226, v227
    ds_write_b128 v7, v[220:223] offset:63104
    v_cndmask_b32 v252, v202, v203, s[52:53]
    v_mul_f32 v228, v228, v252
    v_mul_f32 v229, v229, v252
    v_mfma_f32_16x16x32_bf16 v[244:247], v[152:155], v[72:75], 0
    v_mul_f32 v230, v230, v252
    v_mul_f32 v231, v231, v252
    v_mul_f32 v232, v232, v203
    v_mul_f32 v233, v233, v203
    v_mul_f32 v234, v234, v203
    v_mul_f32 v235, v235, v203
    v_mfma_f32_16x16x32_bf16 v[244:247], v[156:159], v[88:91], v[244:247]
    v_cvt_pk_bf16_f32 v228, v228, v229
    v_cvt_pk_bf16_f32 v229, v230, v231
    v_cvt_pk_bf16_f32 v230, v232, v233
    v_cvt_pk_bf16_f32 v231, v234, v235
    ds_write_b128 v7, v[228:231] offset:64128
    v_max3_u32 v255, v255, v152, v153
    v_mfma_f32_16x16x32_bf16 v[248:251], v[160:163], v[88:91], 0
    v_max3_u32 v255, v255, v154, v155
    v_max3_u32 v255, v255, v156, v157
    v_max3_u32 v255, v255, v158, v159
    v_max3_u32 v255, v255, v160, v161
    v_max3_u32 v255, v255, v162, v163
    v_cmp_eq_u32 vcc, -1, v255
    s_nop 3
    v_cndmask_b32 v252, v210, v211, s[52:53]
    v_mul_f32 v236, v236, v252
    v_mul_f32 v237, v237, v252
    v_mul_f32 v238, v238, v252
    v_mul_f32 v239, v239, v252
    v_mul_f32 v240, v240, v211
    v_mul_f32 v241, v241, v211
    v_mul_f32 v242, v242, v211
    v_mul_f32 v243, v243, v211
    v_cvt_pk_bf16_f32 v236, v236, v237
    v_cvt_pk_bf16_f32 v237, v238, v239
    v_cvt_pk_bf16_f32 v238, v240, v241
    v_cvt_pk_bf16_f32 v239, v242, v243
    ds_write_b128 v8, v[236:239] offset:0
    v_cndmask_b32 v252, v218, v219, s[52:53]
    v_mul_f32 v244, v244, v252
    v_mul_f32 v245, v245, v252
    v_mul_f32 v246, v246, v252
    v_mul_f32 v247, v247, v252
    v_mul_f32 v248, v248, v219
    v_mul_f32 v249, v249, v219
    v_mul_f32 v250, v250, v219
    v_mul_f32 v251, v251, v219
    v_cvt_pk_bf16_f32 v244, v244, v245
    v_cvt_pk_bf16_f32 v245, v246, v247
    v_cvt_pk_bf16_f32 v246, v248, v249
    v_cvt_pk_bf16_f32 v247, v250, v251
    ds_write_b128 v8, v[244:247] offset:1024
    s_cmp_eq_u64 vcc, 0
    s_cbranch_scc0 L_p2_kv_bad
    v_mov_b32 v11, 5
    ds_write_b32 v10, v11 offset:20
    s_branch L_p2_kv_ok
L_p2_kv_bad:
    s_add_u32 s25, s25, 1
    s_cmp_lt_u32 s25, 8192
    s_cbranch_scc1 L_p2_kv_again
    v_mov_b32 v11, 5
    ds_write_b32 v10, v11 offset:20
L_p2_kv_ok:
    s_waitcnt lgkmcnt(0)
    s_endpgm
L_ev3_slow:
    s_mov_b32 s71, 0
L_ev3_spin:
    v_and_b32 v54, 31, v1
    s_lshl_b32 s34, s20, 7
    s_lshl_b32 s35, s50, 6
    s_add_u32 s34, s34, s35
    v_add_u32 v55, s34, v54
    v_lshlrev_b32 v55, 3, v55
    v_add_u32 v55, 16777216, v55
    v_lshlrev_b32 v54, 4, v54
    v_lshrrev_b32 v10, 5, v1
    v_lshl_add_u32 v54, v10, 11, v54
    s_mul_i32 s34, s21, 40
    s_lshr_b32 s35, s3, 1
    s_add_u32 s34, s34, s35
    s_lshl_b32 s34, s34, 9
    s_add_u32 s38, s34, 18874368
    buffer_load_dwordx2 v[2:3], v55, s[12:15], 0 offen sc1
    buffer_load_dwordx2 v[4:5], v55, s[12:15], 0 offen offset:256 sc1
    buffer_load_dwordx4 v[32:35], v54, s[12:15], s38 offen sc1
    s_add_u32 s38, s38, 4096
    buffer_load_dwordx4 v[36:39], v54, s[12:15], s38 offen sc1
    s_add_u32 s38, s38, 4096
    buffer_load_dwordx4 v[40:43], v54, s[12:15], s38 offen sc1
    s_add_u32 s38, s38, 4096
    buffer_load_dwordx4 v[44:47], v54, s[12:15], s38 offen sc1
    s_add_u32 s38, s38, 4096
    buffer_load_dwordx4 v[48:51], v54, s[12:15], s38 offen sc1
    s_waitcnt vmcnt(0)
    v_min3_u32 v6, v32, v33, v34
    v_min3_u32 v6, v6, v36, v37
    v_min3_u32 v6, v6, v38, v40
    v_min3_u32 v6, v6, v41, v42
    v_min3_u32 v6, v6, v44, v45
    v_min3_u32 v6, v6, v46, v48
    v_min3_u32 v6, v6, v49, v50
    v_cmp_eq_u32 vcc, 0, v6
    s_nop 4
    s_cmp_eq_u64 vcc, 0
    s_cbranch_scc1 L_ev3_ok
    s_add_u32 s71, s71, 1
    s_cmp_lt_u32 s71, 0x100000
    s_cbranch_scc1 L_ev3_spin
    s_branch L_ev3_ok
L_cnt3_slow:
    s_mov_b32 s71, 0
L_cnt3_spin:
    v_lshlrev_b32 v6, 6, v1
    buffer_load_dword v52, v6, s[16:19], 0 offen sc1
    s_waitcnt vmcnt(0)
    v_cmp_le_u32 s[68:69], 64, v52
    s_nop 1
    s_and_b32 s34, s68, 15
    s_cmp_eq_u32 s34, 15
    s_cbranch_scc1 L_cnt3_ok
    s_add_u32 s71, s71, 1
    s_cmp_lt_u32 s71, 0x100000
    s_cbranch_scc1 L_cnt3_spin
    s_branch L_cnt3_ok
L_fw3_slow:
    s_mov_b32 s71, 0
L_fw3_spin:
    v_lshlrev_b32 v6, 7, v1
    v_add_u32 v6, 17203200, v6
    buffer_load_dword v52, v6, s[12:15], 0 offen sc1
    s_waitcnt vmcnt(0)
    v_cmp_ne_u32 s[68:69], 0, v52
    s_mov_b32 s34, 0xf01fc07f
    s_mov_b32 s35, 0xfe07
    s_and_b64 s[68:69], s[68:69], s[34:35]
    s_cmp_eq_u64 s[68:69], s[34:35]
    s_cbranch_scc1 L_fw3_ok
    s_add_u32 s71, s71, 1
    s_cmp_lt_u32 s71, 0x100000
    s_cbranch_scc1 L_fw3_spin
    s_branch L_fw3_ok
L_fg3_slow:
    s_mov_b32 s71, 0
L_fg3_spin:
    v_lshlrev_b32 v6, 7, v1
    v_add_u32 v6, 17203200, v6
    buffer_load_dword v92, v6, s[12:15], 0 offen sc1
    v_add_u32 v6, 8192, v6
    s_mov_b64 exec, 1023
    buffer_load_dword v93, v6, s[12:15], 0 offen sc1
    s_mov_b64 exec, -1
    s_waitcnt vmcnt(0)
    v_cmp_ne_u32 s[68:69], 0, v92
    v_cmp_ne_u32 s[34:35], 0, v93
    s_nop 1
    s_and_b32 s34, s34, 1023
    s_cmp_eq_u64 s[68:69], -1
    s_cselect_b32 s34, s34, 0
    s_cmp_eq_u32 s34, 1023
    s_cbranch_scc1 L_fg3_ok
    s_add_u32 s71, s71, 1
    s_cmp_lt_u32 s71, 0x100000
    s_cbranch_scc1 L_fg3_spin
    s_branch L_fg3_ok
L_ev2_slow:
    s_mov_b32 s71, 0
L_ev2_spin:
    v_and_b32 v54, 31, v1
    s_lshl_b32 s34, s20, 7
    s_lshl_b32 s35, s50, 6
    s_add_u32 s34, s34, s35
    v_add_u32 v55, s34, v54
    v_lshlrev_b32 v55, 3, v55
    v_add_u32 v55, 16777216, v55
    v_lshlrev_b32 v54, 4, v54
    v_lshrrev_b32 v10, 5, v1
    v_lshl_add_u32 v54, v10, 11, v54
    s_mul_i32 s34, s21, 40
    s_lshr_b32 s35, s3, 1
    s_add_u32 s34, s34, s35
    s_lshl_b32 s34, s34, 9
    s_add_u32 s38, s34, 18874368
    buffer_load_dwordx2 v[2:3], v55, s[12:15], 0 offen sc1
    buffer_load_dwordx2 v[4:5], v55, s[12:15], 0 offen offset:256 sc1
    buffer_load_dwordx4 v[32:35], v54, s[12:15], s38 offen sc1
    s_add_u32 s38, s38, 4096
    buffer_load_dwordx4 v[36:39], v54, s[12:15], s38 offen sc1
    s_add_u32 s38, s38, 4096
    buffer_load_dwordx4 v[40:43], v54, s[12:15], s38 offen sc1
    s_add_u32 s38, s38, 4096
    buffer_load_dwordx4 v[44:47], v54, s[12:15], s38 offen sc1
    s_add_u32 s38, s38, 4096
    buffer_load_dwordx4 v[48:51], v54, s[12:15], s38 offen sc1
    s_waitcnt vmcnt(0)
    v_min3_u32 v6, v32, v33, v36
    v_min3_u32 v6, v6, v37, v40
    v_min3_u32 v6, v6, v41, v44
    v_min3_u32 v6, v6, v45, v48
    v_min_u32 v6, v6, v49
    v_cmp_eq_u32 vcc, 0, v6
    s_nop 4
    s_cmp_eq_u64 vcc, 0
    s_cbranch_scc1 L_ev2_ok
    s_add_u32 s71, s71, 1
    s_cmp_lt_u32 s71, 0x100000
    s_cbranch_scc1 L_ev2_spin
    s_branch L_ev2_ok
L_side:
    s_mov_b32 s8, s36
    s_mov_b32 s9, s37
    s_mov_b32 s10, 2621440
    s_mov_b32 s11, 0x20000
    s_mov_b32 s4, s62
    s_mov_b32 s5, s63
    s_mov_b32 s6, 2211840
    s_mov_b32 s7, 0x20000
    s_mov_b32 s52, 0x3f803f80
    s_mov_b32 s22, 3
    s_lshl_b32 s32, s2, 3
    s_add_u32 s32, s32, s3
    s_mul_i32 s33, s32, 1280
    v_lshlrev_b32 v6, 4, v1
    v_lshlrev_b32 v7, 2, v1
    buffer_load_dwordx4 v[32:35], v6, s[8:11], s33 offen
    buffer_load_dword v36, v7, s[8:11], s33 offen offset:1024
    s_add_u32 s33, s20, 0
    s_mov_b32 s24, s33
    s_cmp_ge_u32 s33, 7
    s_cselect_b32 s35, 7, 0
    s_add_u32 s24, s24, s35
    s_cmp_ge_u32 s33, 14
    s_cselect_b32 s35, 7, 0
    s_add_u32 s24, s24, s35
    s_cmp_ge_u32 s33, 21
    s_cselect_b32 s35, 6, 0
    s_add_u32 s24, s24, s35
    s_sub_u32 s35, s33, 21
    s_cmp_ge_u32 s33, 28
    s_cselect_b32 s24, s35, s24
    s_cmp_ge_u32 s33, 35
    s_cselect_b32 s35, 7, 0
    s_add_u32 s24, s24, s35
    s_cmp_ge_u32 s33, 42
    s_cselect_b32 s35, 7, 0
    s_add_u32 s24, s24, s35
    s_cmp_ge_u32 s33, 48
    s_cselect_b32 s35, 7, 0
    s_add_u32 s24, s24, s35
    s_add_u32 s33, s20, 16
    s_mov_b32 s25, s33
    s_cmp_ge_u32 s33, 7
    s_cselect_b32 s35, 7, 0
    s_add_u32 s25, s25, s35
    s_cmp_ge_u32 s33, 14
    s_cselect_b32 s35, 7, 0
    s_add_u32 s25, s25, s35
    s_cmp_ge_u32 s33, 21
    s_cselect_b32 s35, 6, 0
    s_add_u32 s25, s25, s35
    s_sub_u32 s35, s33, 21
    s_cmp_ge_u32 s33, 28
    s_cselect_b32 s25, s35, s25
    s_cmp_ge_u32 s33, 35
    s_cselect_b32 s35, 7, 0
    s_add_u32 s25, s25, s35
    s_cmp_ge_u32 s33, 42
    s_cselect_b32 s35, 7, 0
    s_add_u32 s25, s25, s35
    s_cmp_ge_u32 s33, 48
    s_cselect_b32 s35, 7, 0
    s_add_u32 s25, s25, s35
    s_add_u32 s33, s20, 32
    s_mov_b32 s26, s33
    s_cmp_ge_u32 s33, 7
    s_cselect_b32 s35, 7, 0
    s_add_u32 s26, s26, s35
    s_cmp_ge_u32 s33, 14
    s_cselect_b32 s35, 7, 0
    s_add_u32 s26, s26, s35
    s_cmp_ge_u32 s33, 21
    s_cselect_b32 s35, 6, 0
    s_add_u32 s26, s26, s35
    s_sub_u32 s35, s33, 21
    s_cmp_ge_u32 s33, 28
    s_cselect_b32 s26, s35, s26
    s_cmp_ge_u32 s33, 35
    s_cselect_b32 s35, 7, 0
    s_add_u32 s26, s26, s35
    s_cmp_ge_u32 s33, 42
    s_cselect_b32 s35, 7, 0
    s_add_u32 s26, s26, s35
    s_cmp_ge_u32 s33, 48
    s_cselect_b32 s35, 7, 0
    s_add_u32 s26, s26, s35
    s_add_u32 s33, s20, 48
    s_mov_b32 s27, s33
    s_cmp_ge_u32 s33, 7
    s_cselect_b32 s35, 7, 0
    s_add_u32 s27, s27, s35
    s_cmp_ge_u32 s33, 14
    s_cselect_b32 s35, 7, 0
    s_add_u32 s27, s27, s35
    s_cmp_ge_u32 s33, 21
    s_cselect_b32 s35, 6, 0
    s_add_u32 s27, s27, s35
    s_sub_u32 s35, s33, 21
    s_cmp_ge_u32 s33, 28
    s_cselect_b32 s27, s35, s27
    s_cmp_ge_u32 s33, 35
    s_cselect_b32 s35, 7, 0
    s_add_u32 s27, s27, s35
    s_cmp_ge_u32 s33, 42
    s_cselect_b32 s35, 7, 0
    s_add_u32 s27, s27, s35
    s_cmp_ge_u32 s33, 48
    s_cselect_b32 s35, 7, 0
    s_add_u32 s27, s27, s35
    s_cmp_ge_u32 s33, 54
    s_cselect_b32 s27, s33, s27
    s_cmp_ge_u32 s33, 74
    s_cselect_b32 s27, 79, s27
    s_add_u32 s33, s20, 64
    s_cmp_ge_u32 s33, 54
    s_cselect_b32 s28, s33, s28
    s_cmp_ge_u32 s33, 74
    s_cselect_b32 s28, 79, s28
    v_mov_b32 v8, 0
    v_mov_b32 v9, 0
    v_mov_b32 v10, 0
    v_mov_b32 v11, 0
    s_cmp_lg_u32 s3, 0
    s_cbranch_scc1 L_nf_55
    s_lshl_b32 s34, s2, 7
    s_add_u32 s34, s34, 17170432
    v_and_b32 v6, 3, v1
    v_lshlrev_b32 v6, 4, v6
    v_bfe_u32 v7, v1, 2, 1
    v_mul_u32_u24 v7, 65536, v7
    v_add_u32 v6, v6, v7
    s_mov_b64 exec, 0xff
    buffer_store_dwordx4 v[8:11], v6, s[12:15], s34 offen sc1
    s_mov_b64 exec, -1
L_nf_55:
    s_sub_u32 s34, s3, 1
    s_cmp_gt_u32 s34, 1
    s_cbranch_scc1 L_side_nzz
    s_lshl_b32 s34, s34, 10
    s_mul_i32 s33, s20, 2048
    s_add_u32 s33, s33, s34
    s_add_u32 s33, s33, 17104896
    v_lshlrev_b32 v6, 4, v1
    v_mul_u32_u24 v7, 43, v1
    v_lshrrev_b32 v7, 7, v7
    v_mul_u32_u24 v7, 3, v7
    v_cmp_ne_u32 vcc, v7, v1
    v_mov_b32 v18, -1
    v_mov_b32 v19, -1
    v_cndmask_b32 v16, 0, -1, vcc
    v_cndmask_b32 v17, 0, -1, vcc
    buffer_store_dwordx4 v[16:19], v6, s[12:15], s33 offen sc1
L_side_nzz:
    v_mov_b32 v6, s24
    v_writelane_b32 v6, s25, 1
    v_writelane_b32 v6, s26, 2
    v_writelane_b32 v6, s27, 3
    v_writelane_b32 v6, s28, 4
    v_lshlrev_b32 v6, 7, v6
    v_add_u32 v30, 17203200, v6
    v_mov_b32 v8, 0
    s_cmp_lg_u32 s3, 0
    s_cbranch_scc1 L_side_nz
    s_mov_b64 exec, 31
    buffer_store_dword v8, v30, s[12:15], 0 offen sc1
    s_mov_b64 exec, -1
L_side_nz:
    s_mul_i32 s32, s3, 320
    s_add_u32 s32, s32, 0
    v_add_u32 v2, s32, v1
    v_mul_u32_u24 v3, 3277, v2
    v_lshrrev_b32 v3, 18, v3
    v_mul_u32_u24 v4, 80, v3
    v_sub_u32 v4, v2, v4
    v_and_b32 v5, 3, v3
    v_lshlrev_b32 v6, 1, v5
    v_xor_b32 v4, v6, v4
    v_mul_u32_u24 v6, 1280, v3
    v_lshl_add_u32 v20, v4, 4, v6
    v_bfe_u32 v6, v3, 2, 1
    v_lshl_add_u32 v5, v6, 4, v5
    v_lshrrev_b32 v6, 3, v3
    v_lshl_add_u32 v5, v6, 2, v5
    v_mul_u32_u24 v5, 1280, v5
    v_lshl_add_u32 v40, v4, 4, v5
    s_mul_i32 s32, s3, 320
    s_add_u32 s32, s32, 64
    v_add_u32 v2, s32, v1
    v_mul_u32_u24 v3, 3277, v2
    v_lshrrev_b32 v3, 18, v3
    v_mul_u32_u24 v4, 80, v3
    v_sub_u32 v4, v2, v4
    v_and_b32 v5, 3, v3
    v_lshlrev_b32 v6, 1, v5
    v_xor_b32 v4, v6, v4
    v_mul_u32_u24 v6, 1280, v3
    v_lshl_add_u32 v21, v4, 4, v6
    v_bfe_u32 v6, v3, 2, 1
    v_lshl_add_u32 v5, v6, 4, v5
    v_lshrrev_b32 v6, 3, v3
    v_lshl_add_u32 v5, v6, 2, v5
    v_mul_u32_u24 v5, 1280, v5
    v_lshl_add_u32 v41, v4, 4, v5
    s_mul_i32 s32, s3, 320
    s_add_u32 s32, s32, 128
    v_add_u32 v2, s32, v1
    v_mul_u32_u24 v3, 3277, v2
    v_lshrrev_b32 v3, 18, v3
    v_mul_u32_u24 v4, 80, v3
    v_sub_u32 v4, v2, v4
    v_and_b32 v5, 3, v3
    v_lshlrev_b32 v6, 1, v5
    v_xor_b32 v4, v6, v4
    v_mul_u32_u24 v6, 1280, v3
    v_lshl_add_u32 v22, v4, 4, v6
    v_bfe_u32 v6, v3, 2, 1
    v_lshl_add_u32 v5, v6, 4, v5
    v_lshrrev_b32 v6, 3, v3
    v_lshl_add_u32 v5, v6, 2, v5
    v_mul_u32_u24 v5, 1280, v5
    v_lshl_add_u32 v42, v4, 4, v5
    s_mul_i32 s32, s3, 320
    s_add_u32 s32, s32, 192
    v_add_u32 v2, s32, v1
    v_mul_u32_u24 v3, 3277, v2
    v_lshrrev_b32 v3, 18, v3
    v_mul_u32_u24 v4, 80, v3
    v_sub_u32 v4, v2, v4
    v_and_b32 v5, 3, v3
    v_lshlrev_b32 v6, 1, v5
    v_xor_b32 v4, v6, v4
    v_mul_u32_u24 v6, 1280, v3
    v_lshl_add_u32 v23, v4, 4, v6
    v_bfe_u32 v6, v3, 2, 1
    v_lshl_add_u32 v5, v6, 4, v5
    v_lshrrev_b32 v6, 3, v3
    v_lshl_add_u32 v5, v6, 2, v5
    v_mul_u32_u24 v5, 1280, v5
    v_lshl_add_u32 v43, v4, 4, v5
    s_mul_i32 s32, s3, 320
    s_add_u32 s32, s32, 256
    v_add_u32 v2, s32, v1
    v_mul_u32_u24 v3, 3277, v2
    v_lshrrev_b32 v3, 18, v3
    v_mul_u32_u24 v4, 80, v3
    v_sub_u32 v4, v2, v4
    v_and_b32 v5, 3, v3
    v_lshlrev_b32 v6, 1, v5
    v_xor_b32 v4, v6, v4
    v_mul_u32_u24 v6, 1280, v3
    v_lshl_add_u32 v24, v4, 4, v6
    v_bfe_u32 v6, v3, 2, 1
    v_lshl_add_u32 v5, v6, 4, v5
    v_lshrrev_b32 v6, 3, v3
    v_lshl_add_u32 v5, v6, 2, v5
    v_mul_u32_u24 v5, 1280, v5
    v_lshl_add_u32 v44, v4, 4, v5
    s_mul_i32 s33, s3, 5120
    s_add_u32 s33, s33, 0
    s_mul_i32 s35, s24, 40960
    s_mov_b32 m0, s33
    s_add_u32 s33, s33, 1024
    buffer_load_dwordx4 v20, s[4:7], s35 offen lds
    s_mov_b32 m0, s33
    s_add_u32 s33, s33, 1024
    buffer_load_dwordx4 v21, s[4:7], s35 offen lds
    s_mov_b32 m0, s33
    s_add_u32 s33, s33, 1024
    buffer_load_dwordx4 v22, s[4:7], s35 offen lds
    s_mov_b32 m0, s33
    s_add_u32 s33, s33, 1024
    buffer_load_dwordx4 v23, s[4:7], s35 offen lds
    s_mov_b32 m0, s33
    s_add_u32 s33, s33, 1024
    buffer_load_dwordx4 v24, s[4:7], s35 offen lds
    s_mul_i32 s33, s3, 5120
    s_add_u32 s33, s33, 40960
    s_mul_i32 s35, s25, 40960
    s_mov_b32 m0, s33
    s_add_u32 s33, s33, 1024
    buffer_load_dwordx4 v20, s[4:7], s35 offen lds
    s_mov_b32 m0, s33
    s_add_u32 s33, s33, 1024
    buffer_load_dwordx4 v21, s[4:7], s35 offen lds
    s_mov_b32 m0, s33
    s_add_u32 s33, s33, 1024
    buffer_load_dwordx4 v22, s[4:7], s35 offen lds
    s_mov_b32 m0, s33
    s_add_u32 s33, s33, 1024
    buffer_load_dwordx4 v23, s[4:7], s35 offen lds
    s_mov_b32 m0, s33
    s_add_u32 s33, s33, 1024
    buffer_load_dwordx4 v24, s[4:7], s35 offen lds
    v_lshrrev_b32 v2, 4, v1
    v_bfe_u32 v3, v1, 2, 2
    v_lshl_add_u32 v4, v2, 3, v3
    v_mul_u32_u24 v4, 1280, v4
    v_and_b32 v5, 1, v1
    v_lshl_add_u32 v4, v5, 3, v4
    v_bfe_u32 v5, v1, 1, 1
    v_lshlrev_b32 v3, 1, v3
    s_mul_i32 s32, s3, 10
    s_add_u32 s32, s32, 0
    v_add_u32 v6, s32, v5
    v_xor_b32 v6, v6, v3
    v_lshl_add_u32 v12, v6, 4, v4
    s_mul_i32 s32, s3, 10
    s_add_u32 s32, s32, 2
    v_add_u32 v6, s32, v5
    v_xor_b32 v6, v6, v3
    v_lshl_add_u32 v13, v6, 4, v4
    s_mul_i32 s32, s3, 10
    s_add_u32 s32, s32, 4
    v_add_u32 v6, s32, v5
    v_xor_b32 v6, v6, v3
    v_lshl_add_u32 v14, v6, 4, v4
    s_mul_i32 s32, s3, 10
    s_add_u32 s32, s32, 6
    v_add_u32 v6, s32, v5
    v_xor_b32 v6, v6, v3
    v_lshl_add_u32 v15, v6, 4, v4
    s_mul_i32 s32, s3, 10
    s_add_u32 s32, s32, 8
    v_add_u32 v6, s32, v5
    v_xor_b32 v6, v6, v3
    v_lshl_add_u32 v16, v6, 4, v4
    v_lshlrev_b32 v31, 4, v1
    s_waitcnt vmcnt(10)
    v_mov_b32 v8, 0
    v_mov_b32 v9, 0
    v_dot2c_f32_bf16 v8, s52, v32
    v_dot2c_f32_bf16 v9, v32, v32
    v_dot2c_f32_bf16 v8, s52, v33
    v_dot2c_f32_bf16 v9, v33, v33
    v_dot2c_f32_bf16 v8, s52, v34
    v_dot2c_f32_bf16 v9, v34, v34
    v_dot2c_f32_bf16 v8, s52, v35
    v_dot2c_f32_bf16 v9, v35, v35
    v_dot2c_f32_bf16 v8, s52, v36
    v_dot2c_f32_bf16 v9, v36, v36
    s_nop 2
    v_add_f32_dpp v8, v8, v8 row_ror:8 row_mask:0xf bank_mask:0xf
    v_add_f32_dpp v9, v9, v9 row_ror:8 row_mask:0xf bank_mask:0xf
    s_nop 0
    v_add_f32_dpp v8, v8, v8 row_ror:4 row_mask:0xf bank_mask:0xf
    v_add_f32_dpp v9, v9, v9 row_ror:4 row_mask:0xf bank_mask:0xf
    s_nop 0
    v_add_f32_dpp v8, v8, v8 row_ror:2 row_mask:0xf bank_mask:0xf
    v_add_f32_dpp v9, v9, v9 row_ror:2 row_mask:0xf bank_mask:0xf
    s_nop 0
    v_add_f32_dpp v8, v8, v8 row_ror:1 row_mask:0xf bank_mask:0xf
    v_add_f32_dpp v9, v9, v9 row_ror:1 row_mask:0xf bank_mask:0xf
    s_nop 0
    v_mov_b32 v10, v8
    v_mov_b32 v11, v9
    s_nop 1
    v_permlane16_swap_b32 v8, v10
    v_permlane16_swap_b32 v9, v11
    s_nop 1
    v_add_f32 v8, v8, v10
    v_add_f32 v9, v9, v11
    v_mov_b32 v10, v8
    v_mov_b32 v11, v9
    s_nop 1
    v_permlane32_swap_b32 v8, v10
    v_permlane32_swap_b32 v9, v11
    s_nop 1
    v_add_f32 v8, v8, v10
    v_add_f32 v9, v9, v11
    s_mov_b32 s34, 0x3acccccd
    s_mov_b32 s35, 0x3727c5ac
    v_mul_f32 v8, s34, v8
    v_mul_f32 v9, s34, v9
    v_fma_f32 v9, -v8, v8, v9
    v_max_f32 v9, 0, v9
    v_cvt_pk_bf16_f32 v10, v8, v9
    v_lshlrev_b32 v8, 16, v10
    v_and_b32 v9, 0xffff0000, v10
    v_add_f32 v9, s35, v9
    v_cvt_pk_bf16_f32 v10, v9, v9
    v_lshlrev_b32 v10, 16, v10
    v_sqrt_f32 v10, v10
    s_nop 0
    v_cvt_pk_bf16_f32 v10, v10, v10
    v_lshlrev_b32 v10, 16, v10
    v_rcp_f32 v9, v10
    s_lshl_b32 s32, s2, 3
    s_add_u32 s32, s32, s3
    s_lshl_b32 s32, s32, 3
    s_add_u32 s32, s32, 16777216
    v_mov_b32 v6, 0
    s_mov_b64 exec, 1
    buffer_store_dwordx2 v[8:9], v6, s[12:15], s32 offen sc1
    s_mov_b64 exec, -1
    v_add_u32 v92, 81920, v12
    v_add_u32 v93, 81920, v13
    v_add_u32 v94, 81920, v14
    v_add_u32 v95, 81920, v15
    v_add_u32 v96, 81920, v16
    s_waitcnt vmcnt(6)
    s_barrier
    ds_read_b64_tr_b16 v[48:49], v12 offset:0
    ds_read_b64_tr_b16 v[50:51], v12 offset:5120
    ds_read_b64_tr_b16 v[52:53], v13 offset:0
    ds_read_b64_tr_b16 v[54:55], v13 offset:5120
    ds_read_b64_tr_b16 v[56:57], v14 offset:0
    ds_read_b64_tr_b16 v[58:59], v14 offset:5120
    ds_read_b64_tr_b16 v[60:61], v15 offset:0
    ds_read_b64_tr_b16 v[62:63], v15 offset:5120
    ds_read_b64_tr_b16 v[64:65], v16 offset:0
    ds_read_b64_tr_b16 v[66:67], v16 offset:5120
    s_mul_i32 s34, s3, 74
    s_add_u32 s34, s34, s24
    s_mul_i32 s34, s34, 5120
    s_add_u32 s34, s34, 10485760
    s_cmp_ge_u32 s24, 74
    s_cselect_b32 s34, 0x7f000000, s34
    s_waitcnt lgkmcnt(0)
    buffer_store_dwordx4 v[48:51], v31, s[12:15], s34 offen sc1
    s_add_u32 s34, s34, 1024
    buffer_store_dwordx4 v[52:55], v31, s[12:15], s34 offen sc1
    s_add_u32 s34, s34, 1024
    buffer_store_dwordx4 v[56:59], v31, s[12:15], s34 offen sc1
    s_add_u32 s34, s34, 1024
    buffer_store_dwordx4 v[60:63], v31, s[12:15], s34 offen sc1
    s_add_u32 s34, s34, 1024
    buffer_store_dwordx4 v[64:67], v31, s[12:15], s34 offen sc1
    s_nop 1
    s_waitcnt vmcnt(5)
    s_barrier
    s_cmp_lg_u32 s3, 0
    s_cbranch_scc1 L_cnt_56
    s_lshr_b32 s34, s2, 3
    s_and_b32 s34, s34, 3
    s_lshl_b32 s34, s34, 6
    v_mov_b32 v6, s34
    v_mov_b32 v7, 1
    s_mov_b64 exec, 1
    buffer_atomic_add v7, v6, s[16:19], 0 offen sc1
    s_mov_b64 exec, -1
L_cnt_56:
    ds_read_b64_tr_b16 v[48:49], v12 offset:40960
    ds_read_b64_tr_b16 v[50:51], v12 offset:46080
    ds_read_b64_tr_b16 v[52:53], v13 offset:40960
    ds_read_b64_tr_b16 v[54:55], v13 offset:46080
    ds_read_b64_tr_b16 v[56:57], v14 offset:40960
    ds_read_b64_tr_b16 v[58:59], v14 offset:46080
    ds_read_b64_tr_b16 v[60:61], v15 offset:40960
    ds_read_b64_tr_b16 v[62:63], v15 offset:46080
    ds_read_b64_tr_b16 v[64:65], v16 offset:40960
    ds_read_b64_tr_b16 v[66:67], v16 offset:46080
    s_mul_i32 s34, s3, 74
    s_add_u32 s34, s34, s25
    s_mul_i32 s34, s34, 5120
    s_add_u32 s34, s34, 10485760
    s_cmp_ge_u32 s25, 74
    s_cselect_b32 s34, 0x7f000000, s34
    s_waitcnt lgkmcnt(0)
    buffer_store_dwordx4 v[48:51], v31, s[12:15], s34 offen sc1
    s_add_u32 s34, s34, 1024
    buffer_store_dwordx4 v[52:55], v31, s[12:15], s34 offen sc1
    s_add_u32 s34, s34, 1024
    buffer_store_dwordx4 v[56:59], v31, s[12:15], s34 offen sc1
    s_add_u32 s34, s34, 1024
    buffer_store_dwordx4 v[60:63], v31, s[12:15], s34 offen sc1
    s_add_u32 s34, s34, 1024
    buffer_store_dwordx4 v[64:67], v31, s[12:15], s34 offen sc1
    s_nop 1
    s_mul_i32 s33, s3, 5120
    s_add_u32 s33, s33, 81920
    s_mul_i32 s35, s26, 40960
    s_mov_b32 m0, s33
    s_add_u32 s33, s33, 1024
    buffer_load_dwordx4 v20, s[4:7], s35 offen lds
    s_mov_b32 m0, s33
    s_add_u32 s33, s33, 1024
    buffer_load_dwordx4 v21, s[4:7], s35 offen lds
    s_mov_b32 m0, s33
    s_add_u32 s33, s33, 1024
    buffer_load_dwordx4 v22, s[4:7], s35 offen lds
    s_mov_b32 m0, s33
    s_add_u32 s33, s33, 1024
    buffer_load_dwordx4 v23, s[4:7], s35 offen lds
    s_mov_b32 m0, s33
    s_add_u32 s33, s33, 1024
    buffer_load_dwordx4 v24, s[4:7], s35 offen lds
    s_mul_i32 s33, s3, 5120
    s_add_u32 s33, s33, 122880
    s_cmp_ge_u32 s27, 54
    s_cbranch_scc1 L_side_wo3
    s_mul_i32 s35, s27, 40960
    s_mov_b32 m0, s33
    s_add_u32 s33, s33, 1024
    buffer_load_dwordx4 v20, s[4:7], s35 offen lds
    s_mov_b32 m0, s33
    s_add_u32 s33, s33, 1024
    buffer_load_dwordx4 v21, s[4:7], s35 offen lds
    s_mov_b32 m0, s33
    s_add_u32 s33, s33, 1024
    buffer_load_dwordx4 v22, s[4:7], s35 offen lds
    s_mov_b32 m0, s33
    s_add_u32 s33, s33, 1024
    buffer_load_dwordx4 v23, s[4:7], s35 offen lds
    s_mov_b32 m0, s33
    s_add_u32 s33, s33, 1024
    buffer_load_dwordx4 v24, s[4:7], s35 offen lds
    s_branch L_side_wo3_done
L_side_wo3:
    s_mov_b32 s4, s60
    s_mov_b32 s5, s61
    s_mov_b32 s6, 819200
    s_sub_u32 s35, s27, 54
    s_mul_i32 s35, s35, 40960
    s_cmp_ge_u32 s27, 74
    s_cselect_b32 s35, 0x7f000000, s35
    s_mov_b32 m0, s33
    s_add_u32 s33, s33, 1024
    buffer_load_dwordx4 v40, s[4:7], s35 offen lds
    s_mov_b32 m0, s33
    s_add_u32 s33, s33, 1024
    buffer_load_dwordx4 v41, s[4:7], s35 offen lds
    s_mov_b32 m0, s33
    s_add_u32 s33, s33, 1024
    buffer_load_dwordx4 v42, s[4:7], s35 offen lds
    s_mov_b32 m0, s33
    s_add_u32 s33, s33, 1024
    buffer_load_dwordx4 v43, s[4:7], s35 offen lds
    s_mov_b32 m0, s33
    s_add_u32 s33, s33, 1024
    buffer_load_dwordx4 v44, s[4:7], s35 offen lds
L_side_wo3_done:
    s_waitcnt vmcnt(10)
    s_barrier
    s_cmp_lg_u32 s3, 0
    s_cbranch_scc1 L_sf_57
    v_mov_b32 v7, 1
    s_mov_b64 exec, 3
    buffer_store_dword v7, v30, s[12:15], 0 offen sc1
    s_mov_b64 exec, -1
L_sf_57:
    s_waitcnt vmcnt(5)
    s_barrier
    ds_read_b64_tr_b16 v[48:49], v92 offset:0
    ds_read_b64_tr_b16 v[50:51], v92 offset:5120
    ds_read_b64_tr_b16 v[52:53], v93 offset:0
    ds_read_b64_tr_b16 v[54:55], v93 offset:5120
    ds_read_b64_tr_b16 v[56:57], v94 offset:0
    ds_read_b64_tr_b16 v[58:59], v94 offset:5120
    ds_read_b64_tr_b16 v[60:61], v95 offset:0
    ds_read_b64_tr_b16 v[62:63], v95 offset:5120
    ds_read_b64_tr_b16 v[64:65], v96 offset:0
    ds_read_b64_tr_b16 v[66:67], v96 offset:5120
    s_mul_i32 s34, s3, 74
    s_add_u32 s34, s34, s26
    s_mul_i32 s34, s34, 5120
    s_add_u32 s34, s34, 10485760
    s_cmp_ge_u32 s26, 74
    s_cselect_b32 s34, 0x7f000000, s34
    s_waitcnt lgkmcnt(0)
    buffer_store_dwordx4 v[48:51], v31, s[12:15], s34 offen sc1
    s_add_u32 s34, s34, 1024
    buffer_store_dwordx4 v[52:55], v31, s[12:15], s34 offen sc1
    s_add_u32 s34, s34, 1024
    buffer_store_dwordx4 v[56:59], v31, s[12:15], s34 offen sc1
    s_add_u32 s34, s34, 1024
    buffer_store_dwordx4 v[60:63], v31, s[12:15], s34 offen sc1
    s_add_u32 s34, s34, 1024
    buffer_store_dwordx4 v[64:67], v31, s[12:15], s34 offen sc1
    s_nop 1
    s_waitcnt vmcnt(5)
    s_barrier
    s_mul_i32 s33, s3, 5120
    s_add_u32 s33, s33, 0
L_side_wo4:
    s_mov_b32 s4, s60
    s_mov_b32 s5, s61
    s_mov_b32 s6, 819200
    s_sub_u32 s35, s28, 54
    s_mul_i32 s35, s35, 40960
    s_cmp_ge_u32 s28, 74
    s_cselect_b32 s35, 0x7f000000, s35
    s_mov_b32 m0, s33
    s_add_u32 s33, s33, 1024
    buffer_load_dwordx4 v40, s[4:7], s35 offen lds
    s_mov_b32 m0, s33
    s_add_u32 s33, s33, 1024
    buffer_load_dwordx4 v41, s[4:7], s35 offen lds
    s_mov_b32 m0, s33
    s_add_u32 s33, s33, 1024
    buffer_load_dwordx4 v42, s[4:7], s35 offen lds
    s_mov_b32 m0, s33
    s_add_u32 s33, s33, 1024
    buffer_load_dwordx4 v43, s[4:7], s35 offen lds
    s_mov_b32 m0, s33
    s_add_u32 s33, s33, 1024
    buffer_load_dwordx4 v44, s[4:7], s35 offen lds
L_side_wo4_done:
    ds_read_b64_tr_b16 v[48:49], v92 offset:40960
    ds_read_b64_tr_b16 v[50:51], v92 offset:46080
    ds_read_b64_tr_b16 v[52:53], v93 offset:40960
    ds_read_b64_tr_b16 v[54:55], v93 offset:46080
    ds_read_b64_tr_b16 v[56:57], v94 offset:40960
    ds_read_b64_tr_b16 v[58:59], v94 offset:46080
    ds_read_b64_tr_b16 v[60:61], v95 offset:40960
    ds_read_b64_tr_b16 v[62:63], v95 offset:46080
    ds_read_b64_tr_b16 v[64:65], v96 offset:40960
    ds_read_b64_tr_b16 v[66:67], v96 offset:46080
    s_mul_i32 s34, s3, 74
    s_add_u32 s34, s34, s27
    s_mul_i32 s34, s34, 5120
    s_add_u32 s34, s34, 10485760
    s_cmp_ge_u32 s27, 74
    s_cselect_b32 s34, 0x7f000000, s34
    s_waitcnt lgkmcnt(0)
    buffer_store_dwordx4 v[48:51], v31, s[12:15], s34 offen sc1
    s_add_u32 s34, s34, 1024
    buffer_store_dwordx4 v[52:55], v31, s[12:15], s34 offen sc1
    s_add_u32 s34, s34, 1024
    buffer_store_dwordx4 v[56:59], v31, s[12:15], s34 offen sc1
    s_add_u32 s34, s34, 1024
    buffer_store_dwordx4 v[60:63], v31, s[12:15], s34 offen sc1
    s_add_u32 s34, s34, 1024
    buffer_store_dwordx4 v[64:67], v31, s[12:15], s34 offen sc1
    s_nop 1
    s_waitcnt vmcnt(0)
    s_barrier
    s_cmp_lg_u32 s3, 0
    s_cbranch_scc1 L_sf_58
    v_mov_b32 v7, 1
    s_mov_b64 exec, 12
    buffer_store_dword v7, v30, s[12:15], 0 offen sc1
    s_mov_b64 exec, -1
L_sf_58:
    ds_read_b64_tr_b16 v[48:49], v12 offset:0
    ds_read_b64_tr_b16 v[50:51], v12 offset:5120
    ds_read_b64_tr_b16 v[52:53], v13 offset:0
    ds_read_b64_tr_b16 v[54:55], v13 offset:5120
    ds_read_b64_tr_b16 v[56:57], v14 offset:0
    ds_read_b64_tr_b16 v[58:59], v14 offset:5120
    ds_read_b64_tr_b16 v[60:61], v15 offset:0
    ds_read_b64_tr_b16 v[62:63], v15 offset:5120
    ds_read_b64_tr_b16 v[64:65], v16 offset:0
    ds_read_b64_tr_b16 v[66:67], v16 offset:5120
    s_mul_i32 s34, s3, 74
    s_add_u32 s34, s34, s28
    s_mul_i32 s34, s34, 5120
    s_add_u32 s34, s34, 10485760
    s_cmp_ge_u32 s28, 74
    s_cselect_b32 s34, 0x7f000000, s34
    s_waitcnt lgkmcnt(0)
    buffer_store_dwordx4 v[48:51], v31, s[12:15], s34 offen sc1
    s_add_u32 s34, s34, 1024
    buffer_store_dwordx4 v[52:55], v31, s[12:15], s34 offen sc1
    s_add_u32 s34, s34, 1024
    buffer_store_dwordx4 v[56:59], v31, s[12:15], s34 offen sc1
    s_add_u32 s34, s34, 1024
    buffer_store_dwordx4 v[60:63], v31, s[12:15], s34 offen sc1
    s_add_u32 s34, s34, 1024
    buffer_store_dwordx4 v[64:67], v31, s[12:15], s34 offen sc1
    s_nop 1
    s_waitcnt vmcnt(0)
    s_barrier
    s_cmp_lg_u32 s3, 0
    s_cbranch_scc1 L_sf_59
    v_mov_b32 v7, 1
    s_mov_b64 exec, 16
    buffer_store_dword v7, v30, s[12:15], 0 offen sc1
    s_mov_b64 exec, -1
L_sf_59:
    s_mov_b32 s71, 0
L_p2_cnt_spin:
    v_lshlrev_b32 v6, 6, v1
    buffer_load_dword v93, v6, s[16:19], 0 offen sc1
    s_add_u32 s71, s71, 1
    s_waitcnt vmcnt(0)
    v_cmp_le_u32 s[68:69], 64, v93
    s_nop 1
    s_and_b32 s34, s68, 15
    s_cmp_eq_u32 s34, 15
    s_cbranch_scc1 L_p2_cnt_ok
    s_cmp_lt_u32 s71, 2097152
    s_cbranch_scc1 L_p2_cnt_spin
L_p2_cnt_ok:
    v_lshlrev_b32 v92, 2, v1
    v_add_u32 v92, 163584, v92
    v_mov_b32 v93, 0
    ds_write_b32 v92, v93
    s_and_b32 s28, s3, 3
    s_mov_b32 s27, 0x7f000000
    v_lshlrev_b32 v2, 4, v1
    s_mul_i32 s34, s28, 3072
    v_add_u32 v7, s34, v2
    v_add_u32 v8, 74496, v7
    s_lshl_b32 s34, s28, 12
    s_add_u32 s34, s34, 99328
    v_add_u32 v9, s34, v2
    s_lshl_b32 s34, s28, 2
    s_add_u32 s34, s34, 163584
    v_mov_b32 v10, s34
    s_add_u32 s34, s28, 0
    s_and_b32 s34, s34, 3
    s_lshl_b32 s34, s34, 10
    v_add_u32 v3, s34, v2
    s_add_u32 s34, s28, 1
    s_and_b32 s34, s34, 3
    s_lshl_b32 s34, s34, 10
    v_add_u32 v4, s34, v2
    s_add_u32 s34, s28, 2
    s_and_b32 s34, s34, 3
    s_lshl_b32 s34, s34, 10
    v_add_u32 v5, s34, v2
    s_add_u32 s34, s28, 3
    s_and_b32 s34, s34, 3
    s_lshl_b32 s34, s34, 10
    v_add_u32 v6, s34, v2
    s_waitcnt vmcnt(0) lgkmcnt(0)
    s_barrier
    s_branch L_p2_go
L_end_parallel_sum__linear_attn_block__glu_gated_bilinear__prompt_kernel:
    s_endpgm
.section .rodata,"a"
.p2align 6
.amdhsa_kernel parallel_sum__linear_attn_block__glu_gated_bilinear__prompt_kernel
  .amdhsa_next_free_vgpr 256
  .amdhsa_next_free_sgpr 96
  .amdhsa_accum_offset 256
  .amdhsa_group_segment_fixed_size 0
  .amdhsa_kernarg_size 80
  .amdhsa_user_sgpr_count 2
  .amdhsa_user_sgpr_kernarg_segment_ptr 1
  .amdhsa_system_sgpr_workgroup_id_x 1
  .amdhsa_float_denorm_mode_32 3
.end_amdhsa_kernel
```
